```python
import torch

def _softmax(x, axis=-1):
    return torch.softmax(x, dim=axis)

def _gelu(x):
    return torch.nn.functional.gelu(x, approximate='tanh')

def _silu(x):
    return torch.nn.functional.silu(x)

def _sigmoid(x):
    return torch.sigmoid(x)

def _layernorm(x, axis=-1, eps=1e-05):
    m = x.mean(dim=axis, keepdim=True)
    v = x.var(dim=axis, keepdim=True, unbiased=False)
    return (x - m) / torch.sqrt(v + eps)

def _scatter_add(tgt, idx, src, axis=0):
    return tgt.clone().index_add_(axis, idx, src)

def _segment_sum(src, seg, n):
    out = torch.zeros((n,) + src.shape[1:], dtype=src.dtype)
    return out.index_add_(0, seg, src)

def _pad(x, pw):
    flat = tuple((v for pair in reversed(pw) for v in pair))
    return torch.nn.functional.pad(x, flat)
kernel_name = 'adaLN_cond__mha_block__mixer_gmlp__prompt'

def setup_inputs():

    _w = lambda a: (lambda t: t.to(torch.bfloat16) if t.is_floating_point() else t)(torch.as_tensor(a))

    def _A_setup():
        B, S, D, H = (1, 2048, 1024, 32)
        return {'x': _w((lambda *s: torch.randn(*s, dtype=torch.bfloat16) * 0.05)(B, S, D)), 'wqkv': _w((lambda *s: torch.randn(*s, dtype=torch.bfloat16) * 0.05)(D, 3 * D)), 'wo': _w((lambda *s: torch.randn(*s, dtype=torch.bfloat16) * 0.05)(D, D))}
    _A_in = _A_setup()

    def _B_setup():
        B, S, D, F = (1, 2048, 1024, 3584)
        Fh = F // 2
        return {'x': _w((lambda *s: torch.randn(*s, dtype=torch.bfloat16) * 0.05)(B, S, D)), 'w_in': _w((lambda *s: torch.randn(*s, dtype=torch.bfloat16) * 0.8)(D, 2 * Fh)), 'w_sp': _w(0.01 * (lambda *s: torch.randn(*s, dtype=torch.bfloat16) * 0.8)(S, S)), 'b_sp': _w(1.0 + 0.01 * (lambda *s: torch.randn(*s, dtype=torch.bfloat16) * 0.05)(S)), 'w_out': _w((lambda *s: torch.randn(*s, dtype=torch.bfloat16) * 0.05)(Fh, D))}
    _B_in = _B_setup()
    return {'A_x': _A_in['x'], 'A_wqkv': _A_in['wqkv'], 'A_wo': _A_in['wo'], 'B_x': _B_in['x'], 'B_w_in': _B_in['w_in'], 'B_w_sp': _B_in['w_sp'], 'B_b_sp': _B_in['b_sp'], 'B_w_out': _B_in['w_out'], 'c': _w((lambda *s: torch.randn(*s, dtype=torch.bfloat16) * 0.2)(1, 1024) * 8.0), 'w_mod': _w((lambda *s: torch.randn(*s, dtype=torch.bfloat16) * 0.2)(1024, 6 * 1024) * 1024 ** (-0.5) * 8.0)}

def reference(A_x, A_wqkv, A_wo, B_x, B_w_in, B_w_sp, B_b_sp, B_w_out, c, w_mod):

    def _A_ref(x, wqkv, wo):
        B, S, D = x.shape
        H = 32
        Dh = D // H
        qkv = (lambda x, *d: x.permute(*d))((x @ wqkv).reshape(B, S, 3, H, Dh), 2, 0, 3, 1, 4)
        q, k, v = (qkv[0], qkv[1], qkv[2])
        scores = torch.einsum('bhqd,bhkd->bhqk', q, k) * Dh ** (-0.5)
        p = _softmax(scores, axis=-1)
        o = torch.einsum('bhqk,bhkd->bhqd', p, v)
        return (lambda x, *d: x.permute(*d))(o, 0, 2, 1, 3).reshape(B, S, D) @ wo

    def _B_ref(x, w_in, w_sp, b_sp, w_out):
        B, S, D = x.shape
        F = w_in.shape[-1]
        Fh = F // 2
        z = _gelu(torch.einsum('bsd,df->bsf', x, w_in))
        z1 = z[..., :Fh].clone()
        z2 = _layernorm(z[..., Fh:], axis=-1)
        g = torch.einsum('ts,bsf->btf', w_sp, z2) + b_sp[None, :, None]
        return torch.einsum('bsf,fd->bsd', z1 * g, w_out)
    x = A_x
    mod = (_silu(c) @ w_mod).reshape(c.shape[0], 6, 1, -1)
    sa, ca, ga, sb, cb, gb = (mod[:, 0].clone(), mod[:, 1].clone(), mod[:, 2].clone(), mod[:, 3].clone(), mod[:, 4].clone(), mod[:, 5].clone())
    h = _layernorm(x, axis=-1) * (1 + ca) + sa
    x = x + ga * _A_ref(h, A_wqkv, A_wo)
    h = _layernorm(x, axis=-1) * (1 + cb) + sb
    x = x + gb * _B_ref(h, B_w_in, B_w_sp, B_b_sp, B_w_out)
    return x
```

```asm
; @launch grid=(256,1,1) block=(512,1,1) lds=163840
.amdgcn_target "amdgcn-amd-amdhsa--gfx950"
.text
.p2align 8
.globl adaLN_cond__mha_block__mixer_gmlp__prompt_kernel
.type adaLN_cond__mha_block__mixer_gmlp__prompt_kernel,@function
adaLN_cond__mha_block__mixer_gmlp__prompt_kernel:
    s_cmp_ge_u32 s2, 256
    s_cbranch_scc1 adaLN_cond__mha_block__mixer_gmlp__prompt_kernel_exit
    s_load_dwordx2 s[4:5], s[0:1], 96
    s_load_dwordx2 s[6:7], s[0:1], 0
    s_load_dwordx2 s[8:9], s[0:1], 8
    s_load_dwordx2 s[10:11], s[0:1], 16
    s_load_dwordx2 s[12:13], s[0:1], 32
    s_load_dwordx2 s[14:15], s[0:1], 40
    s_load_dwordx2 s[16:17], s[0:1], 48
    s_load_dwordx2 s[18:19], s[0:1], 56
    s_load_dwordx2 s[20:21], s[0:1], 80
    s_load_dwordx2 s[22:23], s[0:1], 64
    s_load_dwordx2 s[98:99], s[0:1], 72
    s_load_dwordx2 s[100:101], s[0:1], 88
    v_lshrrev_b32 v2, 6, v0
    v_and_b32 v1, 63, v0
    s_and_b32 s43, s2, 7
    s_lshr_b32 s44, s2, 3
    v_readfirstlane_b32 s42, v2
    s_waitcnt lgkmcnt(0)
    s_cmp_ge_u32 s42, 4
    s_cbranch_scc1 mega_L
    v_lshrrev_b32 v2, 6, v0
    v_and_b32 v3, 7, v1
    v_lshrrev_b32 v4, 3, v1
    v_lshl_add_u32 v4, v2, 5, v4
    v_lshlrev_b32 v5, 11, v3
    v_lshl_add_u32 v5, v4, 4, v5
    s_lshl_b32 s55, s2, 14
    v_lshlrev_b32 v6, 4, v0
    s_mov_b32 s24, s6
    s_mov_b32 s25, s7
    s_mov_b32 s26, 4194304
    s_mov_b32 s27, 0x20000
    s_and_b32 s91, s2, 127
    s_cmp_ge_u32 s2, 128
    s_cbranch_scc1 h1_noncrit
    s_mov_b32 s36, s22
    s_mov_b32 s37, s23
    s_mov_b32 s38, 2048
    s_mov_b32 s39, 0x20000
    s_and_b32 s57, s91, 3
    s_lshl_b32 s57, s57, 9
    s_lshl_b32 s58, s42, 7
    s_add_u32 s57, s57, s58
    v_lshrrev_b32 v138, 4, v1
    v_lshlrev_b32 v138, 4, v138
    buffer_load_dwordx4 v[140:143], v138, s[36:39], s57 offen
    buffer_load_dwordx4 v[144:147], v138, s[36:39], s57 offen offset:64
    s_mov_b32 s84, s98
    s_mov_b32 s85, s99
    s_mov_b32 s86, 12582912
    s_mov_b32 s87, 0x20000
    s_and_b32 s57, s91, 3
    s_lshl_b32 s57, s57, 8
    s_lshl_b32 s58, s42, 6
    s_add_u32 s57, s57, s58
    s_mul_i32 s57, s57, 12288
    s_lshr_b32 s58, s91, 2
    s_lshl_b32 s58, s58, 7
    s_add_u32 s57, s57, s58
    s_add_u32 s57, s57, 0
    v_bfe_u32 v136, v1, 4, 1
    v_lshlrev_b32 v136, 1, v136
    v_and_b32 v137, 7, v1
    v_xor_b32 v136, v136, v137
    v_lshrrev_b32 v137, 3, v1
    v_mul_u32_u24 v137, 12288, v137
    v_lshl_add_u32 v136, v136, 4, v137
    v_xor_b32 v137, 64, v136
    s_lshl_b32 s58, s42, 13
    s_add_u32 s58, s58, 81920
    s_add_u32 m0, s58, 0
    s_nop 0
    buffer_load_dwordx4 v136, s[84:87], s57 offen nt lds
    s_add_u32 s57, s57, 98304
    s_add_u32 m0, s58, 1024
    s_nop 0
    buffer_load_dwordx4 v137, s[84:87], s57 offen nt lds
    s_add_u32 s57, s57, 98304
    s_add_u32 m0, s58, 2048
    s_nop 0
    buffer_load_dwordx4 v136, s[84:87], s57 offen nt lds
    s_add_u32 s57, s57, 98304
    s_add_u32 m0, s58, 3072
    s_nop 0
    buffer_load_dwordx4 v137, s[84:87], s57 offen nt lds
    s_add_u32 s57, s57, 98304
    s_add_u32 m0, s58, 4096
    s_nop 0
    buffer_load_dwordx4 v136, s[84:87], s57 offen nt lds
    s_add_u32 s57, s57, 98304
    s_add_u32 m0, s58, 5120
    s_nop 0
    buffer_load_dwordx4 v137, s[84:87], s57 offen nt lds
    s_add_u32 s57, s57, 98304
    s_add_u32 m0, s58, 6144
    s_nop 0
    buffer_load_dwordx4 v136, s[84:87], s57 offen nt lds
    s_add_u32 s57, s57, 98304
    s_add_u32 m0, s58, 7168
    s_nop 0
    buffer_load_dwordx4 v137, s[84:87], s57 offen nt lds
    s_add_u32 s57, s57, 98304
    s_add_u32 s72, s4, 655360
    s_addc_u32 s73, s5, 0
    s_mov_b32 s74, 32768
    s_mov_b32 s75, 0x20000
    v_mov_b32 v28, 0
    v_lshlrev_b32 v7, 2, v1
    s_lshl_b32 s59, s91, 8
    buffer_store_dword v28, v7, s[72:75], s59 offen sc1
    buffer_load_dwordx4 v[8:11], v5, s[24:27], s55 offen offset:0 nt
    buffer_load_dwordx4 v[12:15], v5, s[24:27], s55 offen offset:128 nt
    buffer_load_dwordx4 v[16:19], v5, s[24:27], s55 offen offset:256 nt
    buffer_load_dwordx4 v[20:23], v5, s[24:27], s55 offen offset:384 nt
    s_waitcnt vmcnt(13)
    v_lshlrev_b32 v148, 16, v140
    v_and_b32 v149, 0xffff0000, v140
    v_lshlrev_b32 v150, 16, v141
    v_and_b32 v151, 0xffff0000, v141
    v_lshlrev_b32 v152, 16, v142
    v_and_b32 v153, 0xffff0000, v142
    v_lshlrev_b32 v154, 16, v143
    v_and_b32 v155, 0xffff0000, v143
    v_lshlrev_b32 v156, 16, v144
    v_and_b32 v157, 0xffff0000, v144
    v_lshlrev_b32 v158, 16, v145
    v_and_b32 v159, 0xffff0000, v145
    v_lshlrev_b32 v160, 16, v146
    v_and_b32 v161, 0xffff0000, v146
    v_lshlrev_b32 v162, 16, v147
    v_and_b32 v163, 0xffff0000, v147
    v_mul_f32 v164, 0xbfb8aa3b, v148
    v_mul_f32 v165, 0xbfb8aa3b, v149
    v_mul_f32 v166, 0xbfb8aa3b, v150
    v_mul_f32 v167, 0xbfb8aa3b, v151
    v_mul_f32 v168, 0xbfb8aa3b, v152
    v_mul_f32 v169, 0xbfb8aa3b, v153
    v_mul_f32 v170, 0xbfb8aa3b, v154
    v_mul_f32 v171, 0xbfb8aa3b, v155
    v_mul_f32 v172, 0xbfb8aa3b, v156
    v_mul_f32 v173, 0xbfb8aa3b, v157
    v_mul_f32 v174, 0xbfb8aa3b, v158
    v_mul_f32 v175, 0xbfb8aa3b, v159
    v_mul_f32 v176, 0xbfb8aa3b, v160
    v_mul_f32 v177, 0xbfb8aa3b, v161
    v_mul_f32 v178, 0xbfb8aa3b, v162
    v_mul_f32 v179, 0xbfb8aa3b, v163
    v_exp_f32 v164, v164
    v_exp_f32 v165, v165
    v_exp_f32 v166, v166
    v_exp_f32 v167, v167
    v_exp_f32 v168, v168
    v_exp_f32 v169, v169
    v_exp_f32 v170, v170
    v_exp_f32 v171, v171
    v_exp_f32 v172, v172
    v_exp_f32 v173, v173
    v_exp_f32 v174, v174
    v_exp_f32 v175, v175
    v_exp_f32 v176, v176
    v_exp_f32 v177, v177
    v_exp_f32 v178, v178
    v_exp_f32 v179, v179
    v_add_f32 v164, 1.0, v164
    v_add_f32 v165, 1.0, v165
    v_add_f32 v166, 1.0, v166
    v_add_f32 v167, 1.0, v167
    v_add_f32 v168, 1.0, v168
    v_add_f32 v169, 1.0, v169
    v_add_f32 v170, 1.0, v170
    v_add_f32 v171, 1.0, v171
    v_add_f32 v172, 1.0, v172
    v_add_f32 v173, 1.0, v173
    v_add_f32 v174, 1.0, v174
    v_add_f32 v175, 1.0, v175
    v_add_f32 v176, 1.0, v176
    v_add_f32 v177, 1.0, v177
    v_add_f32 v178, 1.0, v178
    v_add_f32 v179, 1.0, v179
    v_rcp_f32 v164, v164
    v_rcp_f32 v165, v165
    v_rcp_f32 v166, v166
    v_rcp_f32 v167, v167
    v_rcp_f32 v168, v168
    v_rcp_f32 v169, v169
    v_rcp_f32 v170, v170
    v_rcp_f32 v171, v171
    v_rcp_f32 v172, v172
    v_rcp_f32 v173, v173
    v_rcp_f32 v174, v174
    v_rcp_f32 v175, v175
    v_rcp_f32 v176, v176
    v_rcp_f32 v177, v177
    v_rcp_f32 v178, v178
    v_rcp_f32 v179, v179
    v_mul_f32 v148, v148, v164
    v_mul_f32 v149, v149, v165
    v_mul_f32 v150, v150, v166
    v_mul_f32 v151, v151, v167
    v_mul_f32 v152, v152, v168
    v_mul_f32 v153, v153, v169
    v_mul_f32 v154, v154, v170
    v_mul_f32 v155, v155, v171
    v_mul_f32 v156, v156, v172
    v_mul_f32 v157, v157, v173
    v_mul_f32 v158, v158, v174
    v_mul_f32 v159, v159, v175
    v_mul_f32 v160, v160, v176
    v_mul_f32 v161, v161, v177
    v_mul_f32 v162, v162, v178
    v_mul_f32 v163, v163, v179
    v_cvt_pk_bf16_f32 v224, v148, v149
    v_cvt_pk_bf16_f32 v225, v150, v151
    v_cvt_pk_bf16_f32 v226, v152, v153
    v_cvt_pk_bf16_f32 v227, v154, v155
    v_cvt_pk_bf16_f32 v228, v156, v157
    v_cvt_pk_bf16_f32 v229, v158, v159
    v_cvt_pk_bf16_f32 v230, v160, v161
    v_cvt_pk_bf16_f32 v231, v162, v163
    v_lshrrev_b32 v148, 4, v1
    v_bfe_u32 v149, v1, 2, 2
    v_and_b32 v150, 3, v1
    v_lshl_add_u32 v151, v148, 3, v149
    v_lshlrev_b32 v151, 7, v151
    v_lshl_add_u32 v151, v150, 3, v151
    s_lshl_b32 s58, s42, 13
    s_add_u32 s58, s58, 81920
    v_add_u32 v151, s58, v151
    v_and_b32 v150, 1, v148
    v_lshrrev_b32 v149, 1, v149
    v_lshl_add_u32 v149, v150, 1, v149
    v_xor_b32 v150, 0, v149
    v_lshl_add_u32 v152, v150, 5, v151
    v_xor_b32 v150, 1, v149
    v_lshl_add_u32 v153, v150, 5, v151
    v_xor_b32 v150, 2, v149
    v_lshl_add_u32 v154, v150, 5, v151
    v_xor_b32 v150, 3, v149
    v_lshl_add_u32 v155, v150, 5, v151
    s_lshl_b32 s58, s42, 8
    s_add_u32 s58, s58, 140288
    v_lshl_add_u32 v148, v148, 4, s58
    s_waitcnt vmcnt(5)
    ds_read_b64_tr_b16 v[172:173], v152 offset:0
    ds_read_b64_tr_b16 v[174:175], v152 offset:512
    ds_read_b64_tr_b16 v[176:177], v153 offset:0
    ds_read_b64_tr_b16 v[178:179], v153 offset:512
    ds_read_b64_tr_b16 v[180:181], v154 offset:0
    ds_read_b64_tr_b16 v[182:183], v154 offset:512
    ds_read_b64_tr_b16 v[184:185], v155 offset:0
    ds_read_b64_tr_b16 v[186:187], v155 offset:512
    ds_read_b64_tr_b16 v[188:189], v152 offset:4096
    ds_read_b64_tr_b16 v[190:191], v152 offset:4608
    ds_read_b64_tr_b16 v[192:193], v153 offset:4096
    ds_read_b64_tr_b16 v[194:195], v153 offset:4608
    ds_read_b64_tr_b16 v[196:197], v154 offset:4096
    ds_read_b64_tr_b16 v[198:199], v154 offset:4608
    ds_read_b64_tr_b16 v[200:201], v155 offset:4096
    ds_read_b64_tr_b16 v[202:203], v155 offset:4608
    s_waitcnt lgkmcnt(8)
    v_mfma_f32_16x16x32_bf16 v[156:159], v[172:175], v[224:227], 0
    v_mfma_f32_16x16x32_bf16 v[160:163], v[176:179], v[224:227], 0
    v_mfma_f32_16x16x32_bf16 v[164:167], v[180:183], v[224:227], 0
    v_mfma_f32_16x16x32_bf16 v[168:171], v[184:187], v[224:227], 0
    s_waitcnt lgkmcnt(0)
    v_mfma_f32_16x16x32_bf16 v[156:159], v[188:191], v[228:231], v[156:159]
    v_mfma_f32_16x16x32_bf16 v[160:163], v[192:195], v[228:231], v[160:163]
    v_mfma_f32_16x16x32_bf16 v[164:167], v[196:199], v[228:231], v[164:167]
    v_mfma_f32_16x16x32_bf16 v[168:171], v[200:203], v[228:231], v[168:171]
    s_mov_b32 exec_lo, 0x00010001
    s_mov_b32 exec_hi, 0x00010001
    s_nop 2
    ds_write_b128 v148, v[156:159] offset:0
    ds_write_b128 v148, v[160:163] offset:64
    ds_write_b128 v148, v[164:167] offset:128
    ds_write_b128 v148, v[168:171] offset:192
    s_mov_b64 exec, -1
    s_waitcnt vmcnt(4) lgkmcnt(0)
    s_barrier
    s_cmp_lg_u32 s42, 0
    s_cbranch_scc1 h1_nosig
    s_add_u32 s36, s4, 65536
    s_addc_u32 s37, s5, 0
    s_mov_b32 s38, 32768
    s_mov_b32 s39, 0x20000
    v_lshlrev_b32 v138, 2, v1
    v_add_u32 v137, 140288, v138
    ds_read_b32 v140, v137 offset:0
    ds_read_b32 v141, v137 offset:256
    ds_read_b32 v142, v137 offset:512
    ds_read_b32 v143, v137 offset:768
    s_and_b32 s59, s91, 3
    s_mul_i32 s59, s59, 8192
    s_lshr_b32 s58, s91, 2
    s_lshl_b32 s58, s58, 8
    s_add_u32 s57, s59, s58
    s_waitcnt lgkmcnt(0)
    v_add_f32 v140, v140, v141
    v_add_f32 v142, v142, v143
    v_add_f32 v140, v140, v142
    buffer_store_dword v140, v138, s[36:39], s57 offen sc1
    s_mov_b32 s68, s100
    s_mov_b32 s69, s101
    s_mov_b32 s70, 256
    s_mov_b32 s71, 0x20000
    v_mov_b32 v137, 1
    v_mov_b32 v138, 0
    s_waitcnt vmcnt(0)
    s_mov_b64 exec, 1
    buffer_atomic_add v137, v138, s[68:71], 0 offen sc0 sc1
    s_waitcnt vmcnt(0)
    v_cmp_eq_u32 vcc, 0x7f, v137
    s_nop 0
    s_and_b64 exec, exec, vcc
    s_cbranch_execz h1_notlast
    buffer_store_dword v137, v138, s[68:71], 0 offen offset:128 sc1
h1_notlast:
    s_mov_b64 exec, -1
h1_nosig:
    s_waitcnt vmcnt(0)
    v_lshlrev_b32 v40, 16, v8
    v_and_b32 v41, 0xffff0000, v8
    v_lshlrev_b32 v42, 16, v9
    v_and_b32 v43, 0xffff0000, v9
    v_lshlrev_b32 v44, 16, v10
    v_and_b32 v45, 0xffff0000, v10
    v_lshlrev_b32 v46, 16, v11
    v_and_b32 v47, 0xffff0000, v11
    v_lshlrev_b32 v48, 16, v12
    v_and_b32 v49, 0xffff0000, v12
    v_lshlrev_b32 v50, 16, v13
    v_and_b32 v51, 0xffff0000, v13
    v_lshlrev_b32 v52, 16, v14
    v_and_b32 v53, 0xffff0000, v14
    v_lshlrev_b32 v54, 16, v15
    v_and_b32 v55, 0xffff0000, v15
    v_lshlrev_b32 v56, 16, v16
    v_and_b32 v57, 0xffff0000, v16
    v_lshlrev_b32 v58, 16, v17
    v_and_b32 v59, 0xffff0000, v17
    v_lshlrev_b32 v60, 16, v18
    v_and_b32 v61, 0xffff0000, v18
    v_lshlrev_b32 v62, 16, v19
    v_and_b32 v63, 0xffff0000, v19
    v_lshlrev_b32 v64, 16, v20
    v_and_b32 v65, 0xffff0000, v20
    v_lshlrev_b32 v66, 16, v21
    v_and_b32 v67, 0xffff0000, v21
    v_lshlrev_b32 v68, 16, v22
    v_and_b32 v69, 0xffff0000, v22
    v_lshlrev_b32 v70, 16, v23
    v_and_b32 v71, 0xffff0000, v23
    v_pk_add_f32 v[8:9], v[40:41], v[42:43]
    v_pk_mul_f32 v[10:11], v[40:41], v[40:41]
    v_pk_fma_f32 v[10:11], v[42:43], v[42:43], v[10:11]
    v_pk_add_f32 v[8:9], v[8:9], v[44:45]
    v_pk_fma_f32 v[10:11], v[44:45], v[44:45], v[10:11]
    v_pk_add_f32 v[8:9], v[8:9], v[46:47]
    v_pk_fma_f32 v[10:11], v[46:47], v[46:47], v[10:11]
    v_pk_add_f32 v[8:9], v[8:9], v[48:49]
    v_pk_fma_f32 v[10:11], v[48:49], v[48:49], v[10:11]
    v_pk_add_f32 v[8:9], v[8:9], v[50:51]
    v_pk_fma_f32 v[10:11], v[50:51], v[50:51], v[10:11]
    v_pk_add_f32 v[8:9], v[8:9], v[52:53]
    v_pk_fma_f32 v[10:11], v[52:53], v[52:53], v[10:11]
    v_pk_add_f32 v[8:9], v[8:9], v[54:55]
    v_pk_fma_f32 v[10:11], v[54:55], v[54:55], v[10:11]
    v_pk_add_f32 v[8:9], v[8:9], v[56:57]
    v_pk_fma_f32 v[10:11], v[56:57], v[56:57], v[10:11]
    v_pk_add_f32 v[8:9], v[8:9], v[58:59]
    v_pk_fma_f32 v[10:11], v[58:59], v[58:59], v[10:11]
    v_pk_add_f32 v[8:9], v[8:9], v[60:61]
    v_pk_fma_f32 v[10:11], v[60:61], v[60:61], v[10:11]
    v_pk_add_f32 v[8:9], v[8:9], v[62:63]
    v_pk_fma_f32 v[10:11], v[62:63], v[62:63], v[10:11]
    v_pk_add_f32 v[8:9], v[8:9], v[64:65]
    v_pk_fma_f32 v[10:11], v[64:65], v[64:65], v[10:11]
    v_pk_add_f32 v[8:9], v[8:9], v[66:67]
    v_pk_fma_f32 v[10:11], v[66:67], v[66:67], v[10:11]
    v_pk_add_f32 v[8:9], v[8:9], v[68:69]
    v_pk_fma_f32 v[10:11], v[68:69], v[68:69], v[10:11]
    v_pk_add_f32 v[8:9], v[8:9], v[70:71]
    v_pk_fma_f32 v[10:11], v[70:71], v[70:71], v[10:11]
    v_add_f32 v8, v8, v9
    v_add_f32 v9, v10, v11
    s_nop 0
    v_add_f32_dpp v8, v8, v8 row_ror:8 row_mask:0xf bank_mask:0xf
    v_add_f32_dpp v9, v9, v9 row_ror:8 row_mask:0xf bank_mask:0xf
    s_nop 1
    v_permlane16_swap_b32 v8, v9
    v_add_f32 v8, v8, v9
    v_mov_b32 v9, v8
    s_nop 1
    v_permlane32_swap_b32 v8, v9
    v_add_f32 v8, v8, v9
    v_bfe_u32 v10, v1, 4, 1
    v_lshlrev_b32 v10, 2, v10
    v_lshl_add_u32 v10, v3, 5, v10
    v_lshl_add_u32 v10, v2, 3, v10
    v_add_u32 v10, 122880, v10
    ds_write_b32 v10, v8 offset:16384
    s_waitcnt lgkmcnt(0)
    s_barrier
    s_branch h1_join
h1_noncrit:
    buffer_load_dwordx4 v[8:11], v5, s[24:27], s55 offen offset:0 nt
    buffer_load_dwordx4 v[12:15], v5, s[24:27], s55 offen offset:128 nt
    buffer_load_dwordx4 v[16:19], v5, s[24:27], s55 offen offset:256 nt
    buffer_load_dwordx4 v[20:23], v5, s[24:27], s55 offen offset:384 nt
    s_add_u32 s68, s4, 131072
    s_addc_u32 s69, s5, 0
    s_mov_b32 s70, 524288
    s_mov_b32 s71, 0x20000
    v_mov_b32 v24, -1
    v_mov_b32 v25, -1
    v_mov_b32 v26, -1
    v_mov_b32 v27, -1
    s_lshl_b32 s56, s91, 12
    buffer_store_dwordx4 v[24:27], v6, s[68:71], s56 offen sc1
    s_barrier
    s_waitcnt vmcnt(1)
    v_lshlrev_b32 v40, 16, v8
    v_and_b32 v41, 0xffff0000, v8
    v_lshlrev_b32 v42, 16, v9
    v_and_b32 v43, 0xffff0000, v9
    v_lshlrev_b32 v44, 16, v10
    v_and_b32 v45, 0xffff0000, v10
    v_lshlrev_b32 v46, 16, v11
    v_and_b32 v47, 0xffff0000, v11
    v_lshlrev_b32 v48, 16, v12
    v_and_b32 v49, 0xffff0000, v12
    v_lshlrev_b32 v50, 16, v13
    v_and_b32 v51, 0xffff0000, v13
    v_lshlrev_b32 v52, 16, v14
    v_and_b32 v53, 0xffff0000, v14
    v_lshlrev_b32 v54, 16, v15
    v_and_b32 v55, 0xffff0000, v15
    v_lshlrev_b32 v56, 16, v16
    v_and_b32 v57, 0xffff0000, v16
    v_lshlrev_b32 v58, 16, v17
    v_and_b32 v59, 0xffff0000, v17
    v_lshlrev_b32 v60, 16, v18
    v_and_b32 v61, 0xffff0000, v18
    v_lshlrev_b32 v62, 16, v19
    v_and_b32 v63, 0xffff0000, v19
    v_lshlrev_b32 v64, 16, v20
    v_and_b32 v65, 0xffff0000, v20
    v_lshlrev_b32 v66, 16, v21
    v_and_b32 v67, 0xffff0000, v21
    v_lshlrev_b32 v68, 16, v22
    v_and_b32 v69, 0xffff0000, v22
    v_lshlrev_b32 v70, 16, v23
    v_and_b32 v71, 0xffff0000, v23
    v_pk_add_f32 v[8:9], v[40:41], v[42:43]
    v_pk_mul_f32 v[10:11], v[40:41], v[40:41]
    v_pk_fma_f32 v[10:11], v[42:43], v[42:43], v[10:11]
    v_pk_add_f32 v[8:9], v[8:9], v[44:45]
    v_pk_fma_f32 v[10:11], v[44:45], v[44:45], v[10:11]
    v_pk_add_f32 v[8:9], v[8:9], v[46:47]
    v_pk_fma_f32 v[10:11], v[46:47], v[46:47], v[10:11]
    v_pk_add_f32 v[8:9], v[8:9], v[48:49]
    v_pk_fma_f32 v[10:11], v[48:49], v[48:49], v[10:11]
    v_pk_add_f32 v[8:9], v[8:9], v[50:51]
    v_pk_fma_f32 v[10:11], v[50:51], v[50:51], v[10:11]
    v_pk_add_f32 v[8:9], v[8:9], v[52:53]
    v_pk_fma_f32 v[10:11], v[52:53], v[52:53], v[10:11]
    v_pk_add_f32 v[8:9], v[8:9], v[54:55]
    v_pk_fma_f32 v[10:11], v[54:55], v[54:55], v[10:11]
    v_pk_add_f32 v[8:9], v[8:9], v[56:57]
    v_pk_fma_f32 v[10:11], v[56:57], v[56:57], v[10:11]
    v_pk_add_f32 v[8:9], v[8:9], v[58:59]
    v_pk_fma_f32 v[10:11], v[58:59], v[58:59], v[10:11]
    v_pk_add_f32 v[8:9], v[8:9], v[60:61]
    v_pk_fma_f32 v[10:11], v[60:61], v[60:61], v[10:11]
    v_pk_add_f32 v[8:9], v[8:9], v[62:63]
    v_pk_fma_f32 v[10:11], v[62:63], v[62:63], v[10:11]
    v_pk_add_f32 v[8:9], v[8:9], v[64:65]
    v_pk_fma_f32 v[10:11], v[64:65], v[64:65], v[10:11]
    v_pk_add_f32 v[8:9], v[8:9], v[66:67]
    v_pk_fma_f32 v[10:11], v[66:67], v[66:67], v[10:11]
    v_pk_add_f32 v[8:9], v[8:9], v[68:69]
    v_pk_fma_f32 v[10:11], v[68:69], v[68:69], v[10:11]
    v_pk_add_f32 v[8:9], v[8:9], v[70:71]
    v_pk_fma_f32 v[10:11], v[70:71], v[70:71], v[10:11]
    v_add_f32 v8, v8, v9
    v_add_f32 v9, v10, v11
    s_nop 0
    v_add_f32_dpp v8, v8, v8 row_ror:8 row_mask:0xf bank_mask:0xf
    v_add_f32_dpp v9, v9, v9 row_ror:8 row_mask:0xf bank_mask:0xf
    s_nop 1
    v_permlane16_swap_b32 v8, v9
    v_add_f32 v8, v8, v9
    v_mov_b32 v9, v8
    s_nop 1
    v_permlane32_swap_b32 v8, v9
    v_add_f32 v8, v8, v9
    v_bfe_u32 v10, v1, 4, 1
    v_lshlrev_b32 v10, 2, v10
    v_lshl_add_u32 v10, v3, 5, v10
    v_lshl_add_u32 v10, v2, 3, v10
    v_add_u32 v10, 122880, v10
    ds_write_b32 v10, v8 offset:16384
    s_waitcnt lgkmcnt(0)
    s_barrier
h1_join:
    s_add_u32 s32, s4, 1048576
    s_addc_u32 s33, s5, 0
    s_mov_b32 s34, 4227072
    s_mov_b32 s35, 0x20000
    s_add_u32 s28, s4, 65536
    s_addc_u32 s29, s5, 0
    s_mov_b32 s30, 32768
    s_mov_b32 s31, 0x20000
    v_lshlrev_b32 v10, 5, v3
    v_add_u32 v10, 122880, v10
    ds_read_b128 v[12:15], v10 offset:16384
    ds_read_b128 v[16:19], v10 offset:16400
    v_lshlrev_b32 v11, 5, v4
    v_add_u32 v11, 122880, v11
    v_add_u32 v7, 122880, v6
    v_mul_u32_u24 v5, 33024, v4
    v_lshl_add_u32 v5, v3, 4, v5
    s_lshl_b32 s55, s2, 7
    s_waitcnt lgkmcnt(0)
    v_pk_add_f32 v[12:13], v[12:13], v[14:15]
    v_pk_add_f32 v[16:17], v[16:17], v[18:19]
    v_pk_add_f32 v[12:13], v[12:13], v[16:17]
    v_mul_f32 v12, 0x3a800000, v12
    v_mul_f32 v13, 0x3a800000, v13
    v_fma_f32 v13, -v12, v12, v13
    v_max_f32 v13, 0, v13
    v_add_f32 v13, 0x3727c5ac, v13
    v_rsq_f32 v13, v13
    s_nop 0
    v_mul_f32 v12, v12, v13
    v_sub_f32 v12, 0, v12
    v_mov_b32 v14, v13
    v_mov_b32 v15, v13
    v_mov_b32 v13, v12
    v_pk_fma_f32 v[40:41], v[40:41], v[14:15], v[12:13]
    v_pk_fma_f32 v[42:43], v[42:43], v[14:15], v[12:13]
    v_pk_fma_f32 v[44:45], v[44:45], v[14:15], v[12:13]
    v_pk_fma_f32 v[46:47], v[46:47], v[14:15], v[12:13]
    v_pk_fma_f32 v[48:49], v[48:49], v[14:15], v[12:13]
    v_pk_fma_f32 v[50:51], v[50:51], v[14:15], v[12:13]
    v_pk_fma_f32 v[52:53], v[52:53], v[14:15], v[12:13]
    v_pk_fma_f32 v[54:55], v[54:55], v[14:15], v[12:13]
    v_pk_fma_f32 v[56:57], v[56:57], v[14:15], v[12:13]
    v_pk_fma_f32 v[58:59], v[58:59], v[14:15], v[12:13]
    v_pk_fma_f32 v[60:61], v[60:61], v[14:15], v[12:13]
    v_pk_fma_f32 v[62:63], v[62:63], v[14:15], v[12:13]
    v_pk_fma_f32 v[64:65], v[64:65], v[14:15], v[12:13]
    v_pk_fma_f32 v[66:67], v[66:67], v[14:15], v[12:13]
    v_pk_fma_f32 v[68:69], v[68:69], v[14:15], v[12:13]
    v_pk_fma_f32 v[70:71], v[70:71], v[14:15], v[12:13]
    s_mov_b32 s56, 0
    s_barrier
    buffer_load_dwordx4 v[72:75], v6, s[28:31], s56 offen sc1
    s_add_u32 s56, s56, 4096
    buffer_load_dwordx4 v[76:79], v6, s[28:31], s56 offen sc1
    s_add_u32 s56, s56, 4096
    buffer_load_dwordx4 v[80:83], v6, s[28:31], s56 offen sc1
    s_add_u32 s56, s56, 4096
    buffer_load_dwordx4 v[84:87], v6, s[28:31], s56 offen sc1
    s_add_u32 s56, s56, 4096
    buffer_load_dwordx4 v[88:91], v6, s[28:31], s56 offen sc1
    s_add_u32 s56, s56, 4096
    buffer_load_dwordx4 v[92:95], v6, s[28:31], s56 offen sc1
    s_add_u32 s56, s56, 4096
    buffer_load_dwordx4 v[96:99], v6, s[28:31], s56 offen sc1
    s_add_u32 s56, s56, 4096
    buffer_load_dwordx4 v[100:103], v6, s[28:31], s56 offen sc1
    s_add_u32 s56, s56, 4096
    s_waitcnt vmcnt(4)
    v_pk_add_f32 v[72:73], v[72:73], v[80:81]
    v_pk_add_f32 v[74:75], v[74:75], v[82:83]
    v_pk_add_f32 v[76:77], v[76:77], v[84:85]
    v_pk_add_f32 v[78:79], v[78:79], v[86:87]
    s_waitcnt vmcnt(0)
    v_pk_add_f32 v[88:89], v[88:89], v[96:97]
    v_pk_add_f32 v[90:91], v[90:91], v[98:99]
    v_pk_add_f32 v[92:93], v[92:93], v[100:101]
    v_pk_add_f32 v[94:95], v[94:95], v[102:103]
    v_pk_add_f32 v[72:73], v[72:73], v[88:89]
    v_pk_add_f32 v[74:75], v[74:75], v[90:91]
    v_pk_add_f32 v[76:77], v[76:77], v[92:93]
    v_pk_add_f32 v[78:79], v[78:79], v[94:95]
    v_pk_add_f32 v[76:77], v[76:77], 1.0 op_sel_hi:[1,0]
    v_pk_add_f32 v[78:79], v[78:79], 1.0 op_sel_hi:[1,0]
    ds_write_b128 v7, v[72:75]
    ds_write_b128 v7, v[76:79] offset:4096
    s_waitcnt lgkmcnt(0)
    s_barrier
    ds_read_b128 v[72:75], v11 offset:0
    ds_read_b128 v[76:79], v11 offset:16
    ds_read_b128 v[80:83], v11 offset:4096
    ds_read_b128 v[84:87], v11 offset:4112
    ds_read_b128 v[88:91], v11 offset:256
    ds_read_b128 v[92:95], v11 offset:272
    ds_read_b128 v[96:99], v11 offset:4352
    ds_read_b128 v[100:103], v11 offset:4368
    ds_read_b128 v[104:107], v11 offset:512
    ds_read_b128 v[108:111], v11 offset:528
    ds_read_b128 v[112:115], v11 offset:4608
    ds_read_b128 v[116:119], v11 offset:4624
    ds_read_b128 v[120:123], v11 offset:768
    ds_read_b128 v[124:127], v11 offset:784
    ds_read_b128 v[128:131], v11 offset:4864
    ds_read_b128 v[132:135], v11 offset:4880
    s_waitcnt lgkmcnt(12)
    v_pk_fma_f32 v[40:41], v[40:41], v[80:81], v[72:73]
    v_pk_fma_f32 v[42:43], v[42:43], v[82:83], v[74:75]
    v_pk_fma_f32 v[44:45], v[44:45], v[84:85], v[76:77]
    v_pk_fma_f32 v[46:47], v[46:47], v[86:87], v[78:79]
    v_cvt_pk_bf16_f32 v16, v40, v41
    v_cvt_pk_bf16_f32 v17, v42, v43
    v_cvt_pk_bf16_f32 v18, v44, v45
    v_cvt_pk_bf16_f32 v19, v46, v47
    buffer_store_dwordx4 v[16:19], v5, s[32:35], s55 offen sc1
    s_add_u32 s55, s55, 264192
    s_waitcnt lgkmcnt(8)
    v_pk_fma_f32 v[48:49], v[48:49], v[96:97], v[88:89]
    v_pk_fma_f32 v[50:51], v[50:51], v[98:99], v[90:91]
    v_pk_fma_f32 v[52:53], v[52:53], v[100:101], v[92:93]
    v_pk_fma_f32 v[54:55], v[54:55], v[102:103], v[94:95]
    v_cvt_pk_bf16_f32 v20, v48, v49
    v_cvt_pk_bf16_f32 v21, v50, v51
    v_cvt_pk_bf16_f32 v22, v52, v53
    v_cvt_pk_bf16_f32 v23, v54, v55
    buffer_store_dwordx4 v[20:23], v5, s[32:35], s55 offen sc1
    s_add_u32 s55, s55, 264192
    s_waitcnt lgkmcnt(4)
    v_pk_fma_f32 v[56:57], v[56:57], v[112:113], v[104:105]
    v_pk_fma_f32 v[58:59], v[58:59], v[114:115], v[106:107]
    v_pk_fma_f32 v[60:61], v[60:61], v[116:117], v[108:109]
    v_pk_fma_f32 v[62:63], v[62:63], v[118:119], v[110:111]
    v_cvt_pk_bf16_f32 v24, v56, v57
    v_cvt_pk_bf16_f32 v25, v58, v59
    v_cvt_pk_bf16_f32 v26, v60, v61
    v_cvt_pk_bf16_f32 v27, v62, v63
    buffer_store_dwordx4 v[24:27], v5, s[32:35], s55 offen sc1
    s_add_u32 s55, s55, 264192
    s_waitcnt lgkmcnt(0)
    v_pk_fma_f32 v[64:65], v[64:65], v[128:129], v[120:121]
    v_pk_fma_f32 v[66:67], v[66:67], v[130:131], v[122:123]
    v_pk_fma_f32 v[68:69], v[68:69], v[132:133], v[124:125]
    v_pk_fma_f32 v[70:71], v[70:71], v[134:135], v[126:127]
    v_cvt_pk_bf16_f32 v28, v64, v65
    v_cvt_pk_bf16_f32 v29, v66, v67
    v_cvt_pk_bf16_f32 v30, v68, v69
    v_cvt_pk_bf16_f32 v31, v70, v71
    buffer_store_dwordx4 v[28:31], v5, s[32:35], s55 offen sc1
    s_waitcnt vmcnt(0)
    s_barrier
    s_lshr_b32 s40, s43, 2
    s_and_b32 s41, s43, 3
    s_lshl_b32 s40, s40, 3
    s_lshl_b32 s41, s41, 2
    s_lshr_b32 s46, s44, 2
    s_and_b32 s47, s44, 3
    s_add_u32 s40, s40, s46
    s_add_u32 s41, s41, s47
    s_and_b32 s41, s43, 3
    s_lshl_b32 s47, s47, 2
    s_add_u32 s41, s41, s47
    s_and_b32 s54, s42, 1
    s_lshr_b32 s53, s42, 1
    s_lshl_b32 s53, s53, 6
    v_and_b32 v3, 15, v1
    v_lshrrev_b32 v4, 4, v1
    v_add_u32 v5, s53, v3
    v_mul_u32_u24 v6, 2048, v4
    v_lshl_add_u32 v192, v5, 4, v6
    v_lshrrev_b32 v4, 4, v1
    v_bfe_u32 v6, v1, 2, 2
    v_and_b32 v7, 3, v1
    v_lshl_add_u32 v8, v4, 3, v6
    v_and_b32 v9, 1, v4
    v_lshrrev_b32 v10, 1, v6
    v_lshl_add_u32 v10, v9, 1, v10
    v_lshlrev_b32 v11, 7, v8
    v_lshl_add_u32 v11, v7, 3, v11
    s_lshl_b32 s48, s54, 1
    s_add_u32 s48, s48, 0
    v_xor_b32 v12, s48, v10
    v_lshl_add_u32 v12, v12, 5, v11
    v_add_u32 v193, 16384, v12
    s_lshl_b32 s48, s54, 1
    s_add_u32 s48, s48, 1
    v_xor_b32 v12, s48, v10
    v_lshl_add_u32 v12, v12, 5, v11
    v_add_u32 v194, 16384, v12
    v_mov_b32 v16, 0
    v_mov_b32 v17, 0
    v_mov_b32 v18, 0
    v_mov_b32 v19, 0
    v_mov_b32 v20, 0
    v_mov_b32 v21, 0
    v_mov_b32 v22, 0
    v_mov_b32 v23, 0
    v_mov_b32 v24, 0
    v_mov_b32 v25, 0
    v_mov_b32 v26, 0
    v_mov_b32 v27, 0
    v_mov_b32 v28, 0
    v_mov_b32 v29, 0
    v_mov_b32 v30, 0
    v_mov_b32 v31, 0
    v_mov_b32 v32, 0
    v_mov_b32 v33, 0
    v_mov_b32 v34, 0
    v_mov_b32 v35, 0
    v_mov_b32 v36, 0
    v_mov_b32 v37, 0
    v_mov_b32 v38, 0
    v_mov_b32 v39, 0
    v_mov_b32 v40, 0
    v_mov_b32 v41, 0
    v_mov_b32 v42, 0
    v_mov_b32 v43, 0
    v_mov_b32 v44, 0
    v_mov_b32 v45, 0
    v_mov_b32 v46, 0
    v_mov_b32 v47, 0
    v_mov_b32 v48, 0
    v_mov_b32 v49, 0
    v_mov_b32 v50, 0
    v_mov_b32 v51, 0
    v_mov_b32 v52, 0
    v_mov_b32 v53, 0
    v_mov_b32 v54, 0
    v_mov_b32 v55, 0
    v_mov_b32 v56, 0
    v_mov_b32 v57, 0
    v_mov_b32 v58, 0
    v_mov_b32 v59, 0
    v_mov_b32 v60, 0
    v_mov_b32 v61, 0
    v_mov_b32 v62, 0
    v_mov_b32 v63, 0
    v_mov_b32 v64, 0
    v_mov_b32 v65, 0
    v_mov_b32 v66, 0
    v_mov_b32 v67, 0
    v_mov_b32 v68, 0
    v_mov_b32 v69, 0
    v_mov_b32 v70, 0
    v_mov_b32 v71, 0
    v_mov_b32 v72, 0
    v_mov_b32 v73, 0
    v_mov_b32 v74, 0
    v_mov_b32 v75, 0
    v_mov_b32 v76, 0
    v_mov_b32 v77, 0
    v_mov_b32 v78, 0
    v_mov_b32 v79, 0
    v_mov_b32 v80, 0
    v_mov_b32 v81, 0
    v_mov_b32 v82, 0
    v_mov_b32 v83, 0
    v_mov_b32 v84, 0
    v_mov_b32 v85, 0
    v_mov_b32 v86, 0
    v_mov_b32 v87, 0
    v_mov_b32 v88, 0
    v_mov_b32 v89, 0
    v_mov_b32 v90, 0
    v_mov_b32 v91, 0
    v_mov_b32 v92, 0
    v_mov_b32 v93, 0
    v_mov_b32 v94, 0
    v_mov_b32 v95, 0
    v_mov_b32 v96, 0
    v_mov_b32 v97, 0
    v_mov_b32 v98, 0
    v_mov_b32 v99, 0
    v_mov_b32 v100, 0
    v_mov_b32 v101, 0
    v_mov_b32 v102, 0
    v_mov_b32 v103, 0
    v_mov_b32 v104, 0
    v_mov_b32 v105, 0
    v_mov_b32 v106, 0
    v_mov_b32 v107, 0
    v_mov_b32 v108, 0
    v_mov_b32 v109, 0
    v_mov_b32 v110, 0
    v_mov_b32 v111, 0
    s_mov_b32 s46, 0
    s_mov_b32 s47, 15
    s_mov_b32 s49, 40960
    s_barrier
    s_add_u32 s46, s46, 40960
    s_cmp_eq_u32 s46, 122880
    s_cselect_b32 s48, 4294885376, s49
    s_cselect_b32 s46, 0, s46
    s_barrier
    ds_read_b128 v[112:115], v192 offset:0
    ds_read_b64_tr_b16 v[128:129], v193 offset:0
    ds_read_b64_tr_b16 v[130:131], v193 offset:512
    ds_read_b128 v[116:119], v192 offset:256
    ds_read_b128 v[120:123], v192 offset:512
    ds_read_b128 v[124:127], v192 offset:768
    ds_read_b64_tr_b16 v[132:133], v194 offset:0
    ds_read_b64_tr_b16 v[134:135], v194 offset:512
    ds_read_b64_tr_b16 v[136:137], v193 offset:8192
    ds_read_b64_tr_b16 v[138:139], v193 offset:8704
    ds_read_b64_tr_b16 v[140:141], v194 offset:8192
    ds_read_b64_tr_b16 v[142:143], v194 offset:8704
    ds_read_b64_tr_b16 v[144:145], v193 offset:16384
    ds_read_b64_tr_b16 v[146:147], v193 offset:16896
    ds_read_b64_tr_b16 v[148:149], v194 offset:16384
    ds_read_b64_tr_b16 v[150:151], v194 offset:16896
    s_mov_b32 s47, 7
qkv_loop:
    s_waitcnt lgkmcnt(0)
    v_mfma_f32_16x16x32_bf16 v[16:19], v[128:131], v[112:115], v[16:19]
    ds_read_b128 v[152:155], v192 offset:8192
    v_mfma_f32_16x16x32_bf16 v[40:43], v[128:131], v[116:119], v[40:43]
    ds_read_b64_tr_b16 v[168:169], v193 offset:4096
    v_mfma_f32_16x16x32_bf16 v[64:67], v[128:131], v[120:123], v[64:67]
    ds_read_b64_tr_b16 v[170:171], v193 offset:4608
    v_mfma_f32_16x16x32_bf16 v[88:91], v[128:131], v[124:127], v[88:91]
    ds_read_b128 v[156:159], v192 offset:8448
    v_mfma_f32_16x16x32_bf16 v[92:95], v[132:135], v[124:127], v[92:95]
    ds_read_b128 v[160:163], v192 offset:8704
    v_mfma_f32_16x16x32_bf16 v[68:71], v[132:135], v[120:123], v[68:71]
    ds_read_b128 v[164:167], v192 offset:8960
    v_mfma_f32_16x16x32_bf16 v[44:47], v[132:135], v[116:119], v[44:47]
    ds_read_b64_tr_b16 v[172:173], v194 offset:4096
    v_mfma_f32_16x16x32_bf16 v[20:23], v[132:135], v[112:115], v[20:23]
    ds_read_b64_tr_b16 v[174:175], v194 offset:4608
    v_mfma_f32_16x16x32_bf16 v[24:27], v[136:139], v[112:115], v[24:27]
    ds_read_b64_tr_b16 v[176:177], v193 offset:12288
    v_mfma_f32_16x16x32_bf16 v[48:51], v[136:139], v[116:119], v[48:51]
    ds_read_b64_tr_b16 v[178:179], v193 offset:12800
    v_mfma_f32_16x16x32_bf16 v[72:75], v[136:139], v[120:123], v[72:75]
    ds_read_b64_tr_b16 v[180:181], v194 offset:12288
    v_mfma_f32_16x16x32_bf16 v[96:99], v[136:139], v[124:127], v[96:99]
    ds_read_b64_tr_b16 v[182:183], v194 offset:12800
    v_mfma_f32_16x16x32_bf16 v[100:103], v[140:143], v[124:127], v[100:103]
    ds_read_b64_tr_b16 v[184:185], v193 offset:20480
    v_mfma_f32_16x16x32_bf16 v[76:79], v[140:143], v[120:123], v[76:79]
    ds_read_b64_tr_b16 v[186:187], v193 offset:20992
    v_mfma_f32_16x16x32_bf16 v[52:55], v[140:143], v[116:119], v[52:55]
    ds_read_b64_tr_b16 v[188:189], v194 offset:20480
    v_mfma_f32_16x16x32_bf16 v[28:31], v[140:143], v[112:115], v[28:31]
    ds_read_b64_tr_b16 v[190:191], v194 offset:20992
    v_mfma_f32_16x16x32_bf16 v[32:35], v[112:115], v[144:147], v[32:35]
    v_add_u32 v195, s48, v192
    v_mfma_f32_16x16x32_bf16 v[56:59], v[116:119], v[144:147], v[56:59]
    v_add_u32 v196, s48, v193
    v_mfma_f32_16x16x32_bf16 v[80:83], v[120:123], v[144:147], v[80:83]
    v_add_u32 v197, s48, v194
    v_mfma_f32_16x16x32_bf16 v[104:107], v[124:127], v[144:147], v[104:107]
    v_mfma_f32_16x16x32_bf16 v[108:111], v[124:127], v[148:151], v[108:111]
    v_mfma_f32_16x16x32_bf16 v[84:87], v[120:123], v[148:151], v[84:87]
    v_mfma_f32_16x16x32_bf16 v[60:63], v[116:119], v[148:151], v[60:63]
    v_mfma_f32_16x16x32_bf16 v[36:39], v[112:115], v[148:151], v[36:39]
    s_waitcnt lgkmcnt(0)
    s_barrier
    v_mfma_f32_16x16x32_bf16 v[16:19], v[168:171], v[152:155], v[16:19]
    ds_read_b128 v[112:115], v195 offset:0
    v_mfma_f32_16x16x32_bf16 v[40:43], v[168:171], v[156:159], v[40:43]
    ds_read_b64_tr_b16 v[128:129], v196 offset:0
    v_mfma_f32_16x16x32_bf16 v[64:67], v[168:171], v[160:163], v[64:67]
    ds_read_b64_tr_b16 v[130:131], v196 offset:512
    v_mfma_f32_16x16x32_bf16 v[88:91], v[168:171], v[164:167], v[88:91]
    ds_read_b128 v[116:119], v195 offset:256
    v_mfma_f32_16x16x32_bf16 v[92:95], v[172:175], v[164:167], v[92:95]
    ds_read_b128 v[120:123], v195 offset:512
    v_mfma_f32_16x16x32_bf16 v[68:71], v[172:175], v[160:163], v[68:71]
    ds_read_b128 v[124:127], v195 offset:768
    v_mfma_f32_16x16x32_bf16 v[44:47], v[172:175], v[156:159], v[44:47]
    ds_read_b64_tr_b16 v[132:133], v197 offset:0
    v_mfma_f32_16x16x32_bf16 v[20:23], v[172:175], v[152:155], v[20:23]
    ds_read_b64_tr_b16 v[134:135], v197 offset:512
    v_mfma_f32_16x16x32_bf16 v[24:27], v[176:179], v[152:155], v[24:27]
    ds_read_b64_tr_b16 v[136:137], v196 offset:8192
    v_mfma_f32_16x16x32_bf16 v[48:51], v[176:179], v[156:159], v[48:51]
    ds_read_b64_tr_b16 v[138:139], v196 offset:8704
    v_mfma_f32_16x16x32_bf16 v[72:75], v[176:179], v[160:163], v[72:75]
    ds_read_b64_tr_b16 v[140:141], v197 offset:8192
    v_mfma_f32_16x16x32_bf16 v[96:99], v[176:179], v[164:167], v[96:99]
    ds_read_b64_tr_b16 v[142:143], v197 offset:8704
    v_mfma_f32_16x16x32_bf16 v[100:103], v[180:183], v[164:167], v[100:103]
    ds_read_b64_tr_b16 v[144:145], v196 offset:16384
    v_mfma_f32_16x16x32_bf16 v[76:79], v[180:183], v[160:163], v[76:79]
    ds_read_b64_tr_b16 v[146:147], v196 offset:16896
    v_mfma_f32_16x16x32_bf16 v[52:55], v[180:183], v[156:159], v[52:55]
    ds_read_b64_tr_b16 v[148:149], v197 offset:16384
    v_mfma_f32_16x16x32_bf16 v[28:31], v[180:183], v[152:155], v[28:31]
    ds_read_b64_tr_b16 v[150:151], v197 offset:16896
    v_mfma_f32_16x16x32_bf16 v[32:35], v[152:155], v[184:187], v[32:35]
    s_add_u32 s46, s46, 40960
    v_mfma_f32_16x16x32_bf16 v[56:59], v[156:159], v[184:187], v[56:59]
    s_cmp_eq_u32 s46, 122880
    v_mfma_f32_16x16x32_bf16 v[80:83], v[160:163], v[184:187], v[80:83]
    s_cselect_b32 s48, 4294885376, s49
    v_mfma_f32_16x16x32_bf16 v[104:107], v[164:167], v[184:187], v[104:107]
    s_cselect_b32 s46, 0, s46
    v_mfma_f32_16x16x32_bf16 v[108:111], v[164:167], v[188:191], v[108:111]
    v_mfma_f32_16x16x32_bf16 v[84:87], v[160:163], v[188:191], v[84:87]
    v_mfma_f32_16x16x32_bf16 v[60:63], v[156:159], v[188:191], v[60:63]
    v_mfma_f32_16x16x32_bf16 v[36:39], v[152:155], v[188:191], v[36:39]
    s_waitcnt lgkmcnt(0)
    v_mfma_f32_16x16x32_bf16 v[16:19], v[128:131], v[112:115], v[16:19]
    ds_read_b128 v[152:155], v195 offset:8192
    v_mfma_f32_16x16x32_bf16 v[40:43], v[128:131], v[116:119], v[40:43]
    ds_read_b64_tr_b16 v[168:169], v196 offset:4096
    v_mfma_f32_16x16x32_bf16 v[64:67], v[128:131], v[120:123], v[64:67]
    ds_read_b64_tr_b16 v[170:171], v196 offset:4608
    v_mfma_f32_16x16x32_bf16 v[88:91], v[128:131], v[124:127], v[88:91]
    ds_read_b128 v[156:159], v195 offset:8448
    v_mfma_f32_16x16x32_bf16 v[92:95], v[132:135], v[124:127], v[92:95]
    ds_read_b128 v[160:163], v195 offset:8704
    v_mfma_f32_16x16x32_bf16 v[68:71], v[132:135], v[120:123], v[68:71]
    ds_read_b128 v[164:167], v195 offset:8960
    v_mfma_f32_16x16x32_bf16 v[44:47], v[132:135], v[116:119], v[44:47]
    ds_read_b64_tr_b16 v[172:173], v197 offset:4096
    v_mfma_f32_16x16x32_bf16 v[20:23], v[132:135], v[112:115], v[20:23]
    ds_read_b64_tr_b16 v[174:175], v197 offset:4608
    v_mfma_f32_16x16x32_bf16 v[24:27], v[136:139], v[112:115], v[24:27]
    ds_read_b64_tr_b16 v[176:177], v196 offset:12288
    v_mfma_f32_16x16x32_bf16 v[48:51], v[136:139], v[116:119], v[48:51]
    ds_read_b64_tr_b16 v[178:179], v196 offset:12800
    v_mfma_f32_16x16x32_bf16 v[72:75], v[136:139], v[120:123], v[72:75]
    ds_read_b64_tr_b16 v[180:181], v197 offset:12288
    v_mfma_f32_16x16x32_bf16 v[96:99], v[136:139], v[124:127], v[96:99]
    ds_read_b64_tr_b16 v[182:183], v197 offset:12800
    v_mfma_f32_16x16x32_bf16 v[100:103], v[140:143], v[124:127], v[100:103]
    ds_read_b64_tr_b16 v[184:185], v196 offset:20480
    v_mfma_f32_16x16x32_bf16 v[76:79], v[140:143], v[120:123], v[76:79]
    ds_read_b64_tr_b16 v[186:187], v196 offset:20992
    v_mfma_f32_16x16x32_bf16 v[52:55], v[140:143], v[116:119], v[52:55]
    ds_read_b64_tr_b16 v[188:189], v197 offset:20480
    v_mfma_f32_16x16x32_bf16 v[28:31], v[140:143], v[112:115], v[28:31]
    ds_read_b64_tr_b16 v[190:191], v197 offset:20992
    v_mfma_f32_16x16x32_bf16 v[32:35], v[112:115], v[144:147], v[32:35]
    v_add_u32 v192, s48, v195
    v_mfma_f32_16x16x32_bf16 v[56:59], v[116:119], v[144:147], v[56:59]
    v_add_u32 v193, s48, v196
    v_mfma_f32_16x16x32_bf16 v[80:83], v[120:123], v[144:147], v[80:83]
    v_add_u32 v194, s48, v197
    v_mfma_f32_16x16x32_bf16 v[104:107], v[124:127], v[144:147], v[104:107]
    v_mfma_f32_16x16x32_bf16 v[108:111], v[124:127], v[148:151], v[108:111]
    v_mfma_f32_16x16x32_bf16 v[84:87], v[120:123], v[148:151], v[84:87]
    v_mfma_f32_16x16x32_bf16 v[60:63], v[116:119], v[148:151], v[60:63]
    v_mfma_f32_16x16x32_bf16 v[36:39], v[112:115], v[148:151], v[36:39]
    s_waitcnt lgkmcnt(0)
    s_barrier
    v_mfma_f32_16x16x32_bf16 v[16:19], v[168:171], v[152:155], v[16:19]
    ds_read_b128 v[112:115], v192 offset:0
    v_mfma_f32_16x16x32_bf16 v[40:43], v[168:171], v[156:159], v[40:43]
    ds_read_b64_tr_b16 v[128:129], v193 offset:0
    v_mfma_f32_16x16x32_bf16 v[64:67], v[168:171], v[160:163], v[64:67]
    ds_read_b64_tr_b16 v[130:131], v193 offset:512
    v_mfma_f32_16x16x32_bf16 v[88:91], v[168:171], v[164:167], v[88:91]
    ds_read_b128 v[116:119], v192 offset:256
    v_mfma_f32_16x16x32_bf16 v[92:95], v[172:175], v[164:167], v[92:95]
    ds_read_b128 v[120:123], v192 offset:512
    v_mfma_f32_16x16x32_bf16 v[68:71], v[172:175], v[160:163], v[68:71]
    ds_read_b128 v[124:127], v192 offset:768
    v_mfma_f32_16x16x32_bf16 v[44:47], v[172:175], v[156:159], v[44:47]
    ds_read_b64_tr_b16 v[132:133], v194 offset:0
    v_mfma_f32_16x16x32_bf16 v[20:23], v[172:175], v[152:155], v[20:23]
    ds_read_b64_tr_b16 v[134:135], v194 offset:512
    v_mfma_f32_16x16x32_bf16 v[24:27], v[176:179], v[152:155], v[24:27]
    ds_read_b64_tr_b16 v[136:137], v193 offset:8192
    v_mfma_f32_16x16x32_bf16 v[48:51], v[176:179], v[156:159], v[48:51]
    ds_read_b64_tr_b16 v[138:139], v193 offset:8704
    v_mfma_f32_16x16x32_bf16 v[72:75], v[176:179], v[160:163], v[72:75]
    ds_read_b64_tr_b16 v[140:141], v194 offset:8192
    v_mfma_f32_16x16x32_bf16 v[96:99], v[176:179], v[164:167], v[96:99]
    ds_read_b64_tr_b16 v[142:143], v194 offset:8704
    v_mfma_f32_16x16x32_bf16 v[100:103], v[180:183], v[164:167], v[100:103]
    ds_read_b64_tr_b16 v[144:145], v193 offset:16384
    v_mfma_f32_16x16x32_bf16 v[76:79], v[180:183], v[160:163], v[76:79]
    ds_read_b64_tr_b16 v[146:147], v193 offset:16896
    v_mfma_f32_16x16x32_bf16 v[52:55], v[180:183], v[156:159], v[52:55]
    ds_read_b64_tr_b16 v[148:149], v194 offset:16384
    v_mfma_f32_16x16x32_bf16 v[28:31], v[180:183], v[152:155], v[28:31]
    ds_read_b64_tr_b16 v[150:151], v194 offset:16896
    v_mfma_f32_16x16x32_bf16 v[32:35], v[152:155], v[184:187], v[32:35]
    s_add_u32 s46, s46, 40960
    v_mfma_f32_16x16x32_bf16 v[56:59], v[156:159], v[184:187], v[56:59]
    s_cmp_eq_u32 s46, 122880
    v_mfma_f32_16x16x32_bf16 v[80:83], v[160:163], v[184:187], v[80:83]
    s_cselect_b32 s48, 4294885376, s49
    v_mfma_f32_16x16x32_bf16 v[104:107], v[164:167], v[184:187], v[104:107]
    s_cselect_b32 s46, 0, s46
    v_mfma_f32_16x16x32_bf16 v[108:111], v[164:167], v[188:191], v[108:111]
    s_sub_u32 s47, s47, 1
    v_mfma_f32_16x16x32_bf16 v[84:87], v[160:163], v[188:191], v[84:87]
    s_cmp_lg_u32 s47, 0
    v_mfma_f32_16x16x32_bf16 v[60:63], v[156:159], v[188:191], v[60:63]
    v_mfma_f32_16x16x32_bf16 v[36:39], v[152:155], v[188:191], v[36:39]
    s_cbranch_scc1 qkv_loop
    s_waitcnt lgkmcnt(0)
    v_mfma_f32_16x16x32_bf16 v[16:19], v[128:131], v[112:115], v[16:19]
    ds_read_b128 v[152:155], v192 offset:8192
    v_mfma_f32_16x16x32_bf16 v[40:43], v[128:131], v[116:119], v[40:43]
    ds_read_b64_tr_b16 v[168:169], v193 offset:4096
    v_mfma_f32_16x16x32_bf16 v[64:67], v[128:131], v[120:123], v[64:67]
    ds_read_b64_tr_b16 v[170:171], v193 offset:4608
    v_mfma_f32_16x16x32_bf16 v[88:91], v[128:131], v[124:127], v[88:91]
    ds_read_b128 v[156:159], v192 offset:8448
    v_mfma_f32_16x16x32_bf16 v[92:95], v[132:135], v[124:127], v[92:95]
    ds_read_b128 v[160:163], v192 offset:8704
    v_mfma_f32_16x16x32_bf16 v[68:71], v[132:135], v[120:123], v[68:71]
    ds_read_b128 v[164:167], v192 offset:8960
    v_mfma_f32_16x16x32_bf16 v[44:47], v[132:135], v[116:119], v[44:47]
    ds_read_b64_tr_b16 v[172:173], v194 offset:4096
    v_mfma_f32_16x16x32_bf16 v[20:23], v[132:135], v[112:115], v[20:23]
    ds_read_b64_tr_b16 v[174:175], v194 offset:4608
    v_mfma_f32_16x16x32_bf16 v[24:27], v[136:139], v[112:115], v[24:27]
    ds_read_b64_tr_b16 v[176:177], v193 offset:12288
    v_mfma_f32_16x16x32_bf16 v[48:51], v[136:139], v[116:119], v[48:51]
    ds_read_b64_tr_b16 v[178:179], v193 offset:12800
    v_mfma_f32_16x16x32_bf16 v[72:75], v[136:139], v[120:123], v[72:75]
    ds_read_b64_tr_b16 v[180:181], v194 offset:12288
    v_mfma_f32_16x16x32_bf16 v[96:99], v[136:139], v[124:127], v[96:99]
    ds_read_b64_tr_b16 v[182:183], v194 offset:12800
    v_mfma_f32_16x16x32_bf16 v[100:103], v[140:143], v[124:127], v[100:103]
    ds_read_b64_tr_b16 v[184:185], v193 offset:20480
    v_mfma_f32_16x16x32_bf16 v[76:79], v[140:143], v[120:123], v[76:79]
    ds_read_b64_tr_b16 v[186:187], v193 offset:20992
    v_mfma_f32_16x16x32_bf16 v[52:55], v[140:143], v[116:119], v[52:55]
    ds_read_b64_tr_b16 v[188:189], v194 offset:20480
    v_mfma_f32_16x16x32_bf16 v[28:31], v[140:143], v[112:115], v[28:31]
    ds_read_b64_tr_b16 v[190:191], v194 offset:20992
    v_mfma_f32_16x16x32_bf16 v[32:35], v[112:115], v[144:147], v[32:35]
    v_add_u32 v195, s48, v192
    v_mfma_f32_16x16x32_bf16 v[56:59], v[116:119], v[144:147], v[56:59]
    v_add_u32 v196, s48, v193
    v_mfma_f32_16x16x32_bf16 v[80:83], v[120:123], v[144:147], v[80:83]
    v_add_u32 v197, s48, v194
    v_mfma_f32_16x16x32_bf16 v[104:107], v[124:127], v[144:147], v[104:107]
    v_mfma_f32_16x16x32_bf16 v[108:111], v[124:127], v[148:151], v[108:111]
    v_mfma_f32_16x16x32_bf16 v[84:87], v[120:123], v[148:151], v[84:87]
    v_mfma_f32_16x16x32_bf16 v[60:63], v[116:119], v[148:151], v[60:63]
    v_mfma_f32_16x16x32_bf16 v[36:39], v[112:115], v[148:151], v[36:39]
    s_waitcnt lgkmcnt(0)
    s_barrier
    v_mfma_f32_16x16x32_bf16 v[16:19], v[168:171], v[152:155], v[16:19]
    ds_read_b128 v[112:115], v195 offset:0
    v_mfma_f32_16x16x32_bf16 v[40:43], v[168:171], v[156:159], v[40:43]
    ds_read_b64_tr_b16 v[128:129], v196 offset:0
    v_mfma_f32_16x16x32_bf16 v[64:67], v[168:171], v[160:163], v[64:67]
    ds_read_b64_tr_b16 v[130:131], v196 offset:512
    v_mfma_f32_16x16x32_bf16 v[88:91], v[168:171], v[164:167], v[88:91]
    ds_read_b128 v[116:119], v195 offset:256
    v_mfma_f32_16x16x32_bf16 v[92:95], v[172:175], v[164:167], v[92:95]
    ds_read_b128 v[120:123], v195 offset:512
    v_mfma_f32_16x16x32_bf16 v[68:71], v[172:175], v[160:163], v[68:71]
    ds_read_b128 v[124:127], v195 offset:768
    v_mfma_f32_16x16x32_bf16 v[44:47], v[172:175], v[156:159], v[44:47]
    ds_read_b64_tr_b16 v[132:133], v197 offset:0
    v_mfma_f32_16x16x32_bf16 v[20:23], v[172:175], v[152:155], v[20:23]
    ds_read_b64_tr_b16 v[134:135], v197 offset:512
    v_mfma_f32_16x16x32_bf16 v[24:27], v[176:179], v[152:155], v[24:27]
    ds_read_b64_tr_b16 v[136:137], v196 offset:8192
    v_mfma_f32_16x16x32_bf16 v[48:51], v[176:179], v[156:159], v[48:51]
    ds_read_b64_tr_b16 v[138:139], v196 offset:8704
    v_mfma_f32_16x16x32_bf16 v[72:75], v[176:179], v[160:163], v[72:75]
    ds_read_b64_tr_b16 v[140:141], v197 offset:8192
    v_mfma_f32_16x16x32_bf16 v[96:99], v[176:179], v[164:167], v[96:99]
    ds_read_b64_tr_b16 v[142:143], v197 offset:8704
    v_mfma_f32_16x16x32_bf16 v[100:103], v[180:183], v[164:167], v[100:103]
    ds_read_b64_tr_b16 v[144:145], v196 offset:16384
    v_mfma_f32_16x16x32_bf16 v[76:79], v[180:183], v[160:163], v[76:79]
    ds_read_b64_tr_b16 v[146:147], v196 offset:16896
    v_mfma_f32_16x16x32_bf16 v[52:55], v[180:183], v[156:159], v[52:55]
    ds_read_b64_tr_b16 v[148:149], v197 offset:16384
    v_mfma_f32_16x16x32_bf16 v[28:31], v[180:183], v[152:155], v[28:31]
    ds_read_b64_tr_b16 v[150:151], v197 offset:16896
    v_mfma_f32_16x16x32_bf16 v[32:35], v[152:155], v[184:187], v[32:35]
    s_add_u32 s46, s46, 40960
    v_mfma_f32_16x16x32_bf16 v[56:59], v[156:159], v[184:187], v[56:59]
    s_cmp_eq_u32 s46, 122880
    v_mfma_f32_16x16x32_bf16 v[80:83], v[160:163], v[184:187], v[80:83]
    s_cselect_b32 s48, 4294885376, s49
    v_mfma_f32_16x16x32_bf16 v[104:107], v[164:167], v[184:187], v[104:107]
    s_cselect_b32 s46, 0, s46
    v_mfma_f32_16x16x32_bf16 v[108:111], v[164:167], v[188:191], v[108:111]
    v_mfma_f32_16x16x32_bf16 v[84:87], v[160:163], v[188:191], v[84:87]
    v_mfma_f32_16x16x32_bf16 v[60:63], v[156:159], v[188:191], v[60:63]
    v_mfma_f32_16x16x32_bf16 v[36:39], v[152:155], v[188:191], v[36:39]
    s_waitcnt lgkmcnt(0)
    v_mfma_f32_16x16x32_bf16 v[16:19], v[128:131], v[112:115], v[16:19]
    ds_read_b128 v[152:155], v195 offset:8192
    v_mfma_f32_16x16x32_bf16 v[40:43], v[128:131], v[116:119], v[40:43]
    ds_read_b64_tr_b16 v[168:169], v196 offset:4096
    v_mfma_f32_16x16x32_bf16 v[64:67], v[128:131], v[120:123], v[64:67]
    ds_read_b64_tr_b16 v[170:171], v196 offset:4608
    v_mfma_f32_16x16x32_bf16 v[88:91], v[128:131], v[124:127], v[88:91]
    ds_read_b128 v[156:159], v195 offset:8448
    v_mfma_f32_16x16x32_bf16 v[92:95], v[132:135], v[124:127], v[92:95]
    ds_read_b128 v[160:163], v195 offset:8704
    v_mfma_f32_16x16x32_bf16 v[68:71], v[132:135], v[120:123], v[68:71]
    ds_read_b128 v[164:167], v195 offset:8960
    v_mfma_f32_16x16x32_bf16 v[44:47], v[132:135], v[116:119], v[44:47]
    ds_read_b64_tr_b16 v[172:173], v197 offset:4096
    v_mfma_f32_16x16x32_bf16 v[20:23], v[132:135], v[112:115], v[20:23]
    ds_read_b64_tr_b16 v[174:175], v197 offset:4608
    v_mfma_f32_16x16x32_bf16 v[24:27], v[136:139], v[112:115], v[24:27]
    ds_read_b64_tr_b16 v[176:177], v196 offset:12288
    v_mfma_f32_16x16x32_bf16 v[48:51], v[136:139], v[116:119], v[48:51]
    ds_read_b64_tr_b16 v[178:179], v196 offset:12800
    v_mfma_f32_16x16x32_bf16 v[72:75], v[136:139], v[120:123], v[72:75]
    ds_read_b64_tr_b16 v[180:181], v197 offset:12288
    v_mfma_f32_16x16x32_bf16 v[96:99], v[136:139], v[124:127], v[96:99]
    ds_read_b64_tr_b16 v[182:183], v197 offset:12800
    v_mfma_f32_16x16x32_bf16 v[100:103], v[140:143], v[124:127], v[100:103]
    ds_read_b64_tr_b16 v[184:185], v196 offset:20480
    v_mfma_f32_16x16x32_bf16 v[76:79], v[140:143], v[120:123], v[76:79]
    ds_read_b64_tr_b16 v[186:187], v196 offset:20992
    v_mfma_f32_16x16x32_bf16 v[52:55], v[140:143], v[116:119], v[52:55]
    ds_read_b64_tr_b16 v[188:189], v197 offset:20480
    v_mfma_f32_16x16x32_bf16 v[28:31], v[140:143], v[112:115], v[28:31]
    ds_read_b64_tr_b16 v[190:191], v197 offset:20992
    v_mfma_f32_16x16x32_bf16 v[32:35], v[112:115], v[144:147], v[32:35]
    v_mfma_f32_16x16x32_bf16 v[56:59], v[116:119], v[144:147], v[56:59]
    v_mfma_f32_16x16x32_bf16 v[80:83], v[120:123], v[144:147], v[80:83]
    v_mfma_f32_16x16x32_bf16 v[104:107], v[124:127], v[144:147], v[104:107]
    v_mfma_f32_16x16x32_bf16 v[108:111], v[124:127], v[148:151], v[108:111]
    v_mfma_f32_16x16x32_bf16 v[84:87], v[120:123], v[148:151], v[84:87]
    v_mfma_f32_16x16x32_bf16 v[60:63], v[116:119], v[148:151], v[60:63]
    v_mfma_f32_16x16x32_bf16 v[36:39], v[112:115], v[148:151], v[36:39]
    s_waitcnt lgkmcnt(0)
    v_mfma_f32_16x16x32_bf16 v[16:19], v[168:171], v[152:155], v[16:19]
    v_mfma_f32_16x16x32_bf16 v[40:43], v[168:171], v[156:159], v[40:43]
    v_mfma_f32_16x16x32_bf16 v[64:67], v[168:171], v[160:163], v[64:67]
    v_mfma_f32_16x16x32_bf16 v[88:91], v[168:171], v[164:167], v[88:91]
    v_mfma_f32_16x16x32_bf16 v[92:95], v[172:175], v[164:167], v[92:95]
    v_mfma_f32_16x16x32_bf16 v[68:71], v[172:175], v[160:163], v[68:71]
    v_mfma_f32_16x16x32_bf16 v[44:47], v[172:175], v[156:159], v[44:47]
    v_mfma_f32_16x16x32_bf16 v[20:23], v[172:175], v[152:155], v[20:23]
    v_mfma_f32_16x16x32_bf16 v[24:27], v[176:179], v[152:155], v[24:27]
    v_mfma_f32_16x16x32_bf16 v[48:51], v[176:179], v[156:159], v[48:51]
    v_mfma_f32_16x16x32_bf16 v[72:75], v[176:179], v[160:163], v[72:75]
    v_mfma_f32_16x16x32_bf16 v[96:99], v[176:179], v[164:167], v[96:99]
    v_mfma_f32_16x16x32_bf16 v[100:103], v[180:183], v[164:167], v[100:103]
    v_mfma_f32_16x16x32_bf16 v[76:79], v[180:183], v[160:163], v[76:79]
    v_mfma_f32_16x16x32_bf16 v[52:55], v[180:183], v[156:159], v[52:55]
    v_mfma_f32_16x16x32_bf16 v[28:31], v[180:183], v[152:155], v[28:31]
    v_mfma_f32_16x16x32_bf16 v[32:35], v[152:155], v[184:187], v[32:35]
    v_mfma_f32_16x16x32_bf16 v[56:59], v[156:159], v[184:187], v[56:59]
    v_mfma_f32_16x16x32_bf16 v[80:83], v[160:163], v[184:187], v[80:83]
    v_mfma_f32_16x16x32_bf16 v[104:107], v[164:167], v[184:187], v[104:107]
    v_mfma_f32_16x16x32_bf16 v[108:111], v[164:167], v[188:191], v[108:111]
    v_mfma_f32_16x16x32_bf16 v[84:87], v[160:163], v[188:191], v[84:87]
    v_mfma_f32_16x16x32_bf16 v[60:63], v[156:159], v[188:191], v[60:63]
    v_mfma_f32_16x16x32_bf16 v[36:39], v[152:155], v[188:191], v[36:39]
    s_add_u32 s24, s4, 6291456
    s_addc_u32 s25, s5, 0
    s_mov_b32 s26, 8454144
    s_mov_b32 s27, 0x20000
    s_add_u32 s28, s4, 15728640
    s_addc_u32 s29, s5, 0
    s_mov_b32 s30, 4194304
    s_mov_b32 s31, 0x20000
    s_lshl_b32 s56, s40, 7
    s_add_u32 s56, s56, s53
    s_add_u32 s55, s41, 0
    s_and_b32 s55, s55, 15
    s_lshl_b32 s55, s55, 1
    s_add_u32 s55, s55, s54
    s_mul_i32 s57, s55, 132096
    s_lshl_b32 s58, s56, 4
    s_add_u32 s57, s57, s58
    s_add_u32 s55, s41, 1
    s_and_b32 s55, s55, 15
    s_lshl_b32 s55, s55, 1
    s_add_u32 s55, s55, s54
    s_mul_i32 s63, s55, 132096
    s_lshl_b32 s58, s56, 4
    s_add_u32 s63, s63, s58
    s_add_u32 s55, s41, 2
    s_and_b32 s55, s55, 15
    s_lshl_b32 s55, s55, 1
    s_add_u32 s55, s55, s54
    s_lshl_b32 s59, s55, 17
    s_lshl_b32 s58, s56, 6
    s_add_u32 s59, s59, s58
    v_and_b32 v3, 31, v1
    v_lshrrev_b32 v4, 5, v1
    v_mul_u32_u24 v5, 33024, v4
    v_lshl_add_u32 v3, v3, 4, v5
    v_and_b32 v5, 15, v1
    v_lshl_add_u32 v5, v4, 4, v5
    v_bfe_u32 v4, v1, 4, 1
    v_lshl_add_u32 v4, v4, 5, v5
    v_lshlrev_b32 v4, 4, v4
    s_mov_b32 s60, 0x3e8293ee
    s_mov_b32 s61, s60
    s_add_u32 s62, s63, 4227072
    v_cvt_pk_bf16_f32 v112, v24, v25
    v_cvt_pk_bf16_f32 v113, v26, v27
    v_cvt_pk_bf16_f32 v114, v48, v49
    v_cvt_pk_bf16_f32 v115, v50, v51
    s_nop 0
    v_permlane16_swap_b32 v112, v114
    v_permlane16_swap_b32 v113, v115
    buffer_store_dwordx4 v[112:115], v3, s[24:27], s62 offen offset:0 sc1
    v_cvt_pk_bf16_f32 v116, v72, v73
    v_cvt_pk_bf16_f32 v117, v74, v75
    v_cvt_pk_bf16_f32 v118, v96, v97
    v_cvt_pk_bf16_f32 v119, v98, v99
    s_nop 0
    v_permlane16_swap_b32 v116, v118
    v_permlane16_swap_b32 v117, v119
    buffer_store_dwordx4 v[116:119], v3, s[24:27], s62 offen offset:512 sc1
    s_add_u32 s62, s63, 4293120
    v_cvt_pk_bf16_f32 v120, v28, v29
    v_cvt_pk_bf16_f32 v121, v30, v31
    v_cvt_pk_bf16_f32 v122, v52, v53
    v_cvt_pk_bf16_f32 v123, v54, v55
    s_nop 0
    v_permlane16_swap_b32 v120, v122
    v_permlane16_swap_b32 v121, v123
    buffer_store_dwordx4 v[120:123], v3, s[24:27], s62 offen offset:0 sc1
    v_cvt_pk_bf16_f32 v124, v76, v77
    v_cvt_pk_bf16_f32 v125, v78, v79
    v_cvt_pk_bf16_f32 v126, v100, v101
    v_cvt_pk_bf16_f32 v127, v102, v103
    s_nop 0
    v_permlane16_swap_b32 v124, v126
    v_permlane16_swap_b32 v125, v127
    buffer_store_dwordx4 v[124:127], v3, s[24:27], s62 offen offset:512 sc1
    v_cvt_pk_bf16_f32 v128, v32, v33
    v_cvt_pk_bf16_f32 v129, v34, v35
    v_cvt_pk_bf16_f32 v130, v36, v37
    v_cvt_pk_bf16_f32 v131, v38, v39
    s_nop 0
    v_permlane32_swap_b32 v128, v130
    v_permlane32_swap_b32 v129, v131
    buffer_store_dwordx4 v[128:131], v4, s[28:31], s59 offen offset:0 sc1
    v_cvt_pk_bf16_f32 v132, v56, v57
    v_cvt_pk_bf16_f32 v133, v58, v59
    v_cvt_pk_bf16_f32 v134, v60, v61
    v_cvt_pk_bf16_f32 v135, v62, v63
    s_nop 0
    v_permlane32_swap_b32 v132, v134
    v_permlane32_swap_b32 v133, v135
    buffer_store_dwordx4 v[132:135], v4, s[28:31], s59 offen offset:1024 sc1
    v_cvt_pk_bf16_f32 v136, v80, v81
    v_cvt_pk_bf16_f32 v137, v82, v83
    v_cvt_pk_bf16_f32 v138, v84, v85
    v_cvt_pk_bf16_f32 v139, v86, v87
    s_nop 0
    v_permlane32_swap_b32 v136, v138
    v_permlane32_swap_b32 v137, v139
    buffer_store_dwordx4 v[136:139], v4, s[28:31], s59 offen offset:2048 sc1
    v_cvt_pk_bf16_f32 v140, v104, v105
    v_cvt_pk_bf16_f32 v141, v106, v107
    v_cvt_pk_bf16_f32 v142, v108, v109
    v_cvt_pk_bf16_f32 v143, v110, v111
    s_nop 0
    v_permlane32_swap_b32 v140, v142
    v_permlane32_swap_b32 v141, v143
    buffer_store_dwordx4 v[140:143], v4, s[28:31], s59 offen offset:3072 sc1
    s_add_u32 s62, s57, 0
    v_pk_mul_f32 v[16:17], v[16:17], s[60:61]
    v_pk_mul_f32 v[18:19], v[18:19], s[60:61]
    v_pk_mul_f32 v[40:41], v[40:41], s[60:61]
    v_pk_mul_f32 v[42:43], v[42:43], s[60:61]
    v_cvt_pk_bf16_f32 v200, v16, v17
    v_cvt_pk_bf16_f32 v201, v18, v19
    v_cvt_pk_bf16_f32 v202, v40, v41
    v_cvt_pk_bf16_f32 v203, v42, v43
    s_nop 0
    v_permlane16_swap_b32 v200, v202
    v_permlane16_swap_b32 v201, v203
    v_pk_mul_f32 v[64:65], v[64:65], s[60:61]
    v_pk_mul_f32 v[66:67], v[66:67], s[60:61]
    v_pk_mul_f32 v[88:89], v[88:89], s[60:61]
    v_pk_mul_f32 v[90:91], v[90:91], s[60:61]
    v_cvt_pk_bf16_f32 v208, v64, v65
    v_cvt_pk_bf16_f32 v209, v66, v67
    v_cvt_pk_bf16_f32 v210, v88, v89
    v_cvt_pk_bf16_f32 v211, v90, v91
    s_nop 0
    v_permlane16_swap_b32 v208, v210
    v_permlane16_swap_b32 v209, v211
    s_add_u32 s62, s57, 66048
    v_pk_mul_f32 v[20:21], v[20:21], s[60:61]
    v_pk_mul_f32 v[22:23], v[22:23], s[60:61]
    v_pk_mul_f32 v[44:45], v[44:45], s[60:61]
    v_pk_mul_f32 v[46:47], v[46:47], s[60:61]
    v_cvt_pk_bf16_f32 v204, v20, v21
    v_cvt_pk_bf16_f32 v205, v22, v23
    v_cvt_pk_bf16_f32 v206, v44, v45
    v_cvt_pk_bf16_f32 v207, v46, v47
    s_nop 0
    v_permlane16_swap_b32 v204, v206
    v_permlane16_swap_b32 v205, v207
    v_pk_mul_f32 v[68:69], v[68:69], s[60:61]
    v_pk_mul_f32 v[70:71], v[70:71], s[60:61]
    v_pk_mul_f32 v[92:93], v[92:93], s[60:61]
    v_pk_mul_f32 v[94:95], v[94:95], s[60:61]
    v_cvt_pk_bf16_f32 v212, v68, v69
    v_cvt_pk_bf16_f32 v213, v70, v71
    v_cvt_pk_bf16_f32 v214, v92, v93
    v_cvt_pk_bf16_f32 v215, v94, v95
    s_nop 0
    v_permlane16_swap_b32 v212, v214
    v_permlane16_swap_b32 v213, v215
    s_waitcnt vmcnt(0)
    s_barrier
    s_add_u32 s24, s4, 6291456
    s_addc_u32 s25, s5, 0
    s_mov_b32 s26, 8454144
    s_mov_b32 s27, 0x20000
    s_add_u32 s28, s4, 15728640
    s_addc_u32 s29, s5, 0
    s_mov_b32 s30, 4194304
    s_mov_b32 s31, 0x20000
    s_add_u32 s32, s4, 19922944
    s_addc_u32 s33, s5, 0
    s_mov_b32 s34, 4227072
    s_mov_b32 s35, 0x20000
    v_and_b32 v3, 31, v1
    v_lshrrev_b32 v4, 5, v1
    v_lshlrev_b32 v5, 4, v1
    v_mul_u32_u24 v6, 33024, v4
    v_lshl_add_u32 v6, v3, 4, v6
    s_lshl_b32 s46, s41, 1
    s_add_u32 s46, s46, s54
    s_mul_i32 s52, s46, 132096
    s_lshl_b32 s50, s46, 17
    s_lshl_b32 s51, s40, 7
    s_add_u32 s51, s51, s53
    s_lshl_b32 s51, s51, 4
    s_add_u32 s51, s51, s52
    s_add_u32 s52, s52, 4227072
    s_lshl_b32 s46, s54, 14
    s_add_u32 s46, s46, 61440
    v_lshlrev_b32 v156, 11, v4
    v_lshl_add_u32 v156, v3, 4, v156
    v_add_u32 v156, s46, v156
    s_add_u32 s46, s46, 8192
    v_add_u32 v157, s46, v5
    v_lshrrev_b32 v160, 2, v1
    v_xor_b32 v160, v160, v1
    v_and_b32 v160, 4, v160
    v_cmp_eq_u32 vcc, 0, v160
    v_mov_b32 v160, 0x3f803f80
    s_nop 0
    v_cndmask_b32 v136, 0, v160, vcc
    v_mov_b32 v137, v136
    v_mov_b32 v138, v136
    v_mov_b32 v139, v136
    v_mov_b32 v96, 0
    v_mov_b32 v97, 0
    v_mov_b32 v98, 0
    v_mov_b32 v99, 0
    v_mov_b32 v100, 0
    v_mov_b32 v101, 0
    v_mov_b32 v102, 0
    v_mov_b32 v103, 0
    v_mov_b32 v104, 0
    v_mov_b32 v105, 0
    v_mov_b32 v106, 0
    v_mov_b32 v107, 0
    v_mov_b32 v108, 0
    v_mov_b32 v109, 0
    v_mov_b32 v110, 0
    v_mov_b32 v111, 0
    v_mov_b32 v112, 0
    v_mov_b32 v113, 0
    v_mov_b32 v114, 0
    v_mov_b32 v115, 0
    v_mov_b32 v116, 0
    v_mov_b32 v117, 0
    v_mov_b32 v118, 0
    v_mov_b32 v119, 0
    v_mov_b32 v120, 0
    v_mov_b32 v121, 0
    v_mov_b32 v122, 0
    v_mov_b32 v123, 0
    v_mov_b32 v124, 0
    v_mov_b32 v125, 0
    v_mov_b32 v126, 0
    v_mov_b32 v127, 0
    v_mov_b32 v128, 0
    v_mov_b32 v129, 0
    v_mov_b32 v130, 0
    v_mov_b32 v131, 0
    v_mov_b32 v132, 0
    v_mov_b32 v133, 0
    v_mov_b32 v134, 0
    v_mov_b32 v135, 0
    v_mov_b32 v92, 0
    v_mov_b32 v152, 0
    v_mov_b32 v93, 0
    v_mov_b32 v153, 0
    v_mov_b32 v94, 0
    v_mov_b32 v154, 0
    v_mov_b32 v95, 0
    v_mov_b32 v155, 0
    s_mov_b32 s59, 0
    s_mov_b32 s60, 0
    s_mov_b32 s61, 32768
    s_barrier
    s_barrier
    ds_read_b128 v[140:143], v156
    ds_read_b128 v[144:147], v156 offset:4096
    s_waitcnt lgkmcnt(0)
    v_mfma_f32_32x32x16_bf16 v[56:71], v[140:143], v[200:203], 0
    v_mfma_f32_32x32x16_bf16 v[56:71], v[144:147], v[204:207], v[56:71]
    v_mfma_f32_32x32x16_bf16 v[72:87], v[140:143], v[208:211], 0
    v_mfma_f32_32x32x16_bf16 v[72:87], v[144:147], v[212:215], v[72:87]
    s_nop 9
    v_max3_f32 v160, v56, v57, v58
    v_max3_f32 v161, v59, v60, v61
    v_max3_f32 v160, v160, v62, v63
    v_max3_f32 v161, v161, v64, v65
    v_max3_f32 v160, v160, v66, v67
    v_max3_f32 v161, v161, v68, v69
    v_max3_f32 v160, v160, v70, v71
    v_max_f32 v160, v160, v161
    v_mov_b32 v161, v160
    s_nop 1
    v_permlane32_swap_b32 v160, v161
    v_max_f32 v160, v160, v161
    v_sub_f32 v24, 0xc2c80000, v160
    v_mov_b32 v25, v24
    v_mov_b32 v26, v24
    v_mov_b32 v27, v24
    v_mov_b32 v28, v24
    v_mov_b32 v29, v24
    v_mov_b32 v30, v24
    v_mov_b32 v31, v24
    v_mov_b32 v32, v24
    v_mov_b32 v33, v24
    v_mov_b32 v34, v24
    v_mov_b32 v35, v24
    v_mov_b32 v36, v24
    v_mov_b32 v37, v24
    v_mov_b32 v38, v24
    v_mov_b32 v39, v24
    v_max3_f32 v160, v72, v73, v74
    v_max3_f32 v161, v75, v76, v77
    v_max3_f32 v160, v160, v78, v79
    v_max3_f32 v161, v161, v80, v81
    v_max3_f32 v160, v160, v82, v83
    v_max3_f32 v161, v161, v84, v85
    v_max3_f32 v160, v160, v86, v87
    v_max_f32 v160, v160, v161
    v_mov_b32 v161, v160
    s_nop 1
    v_permlane32_swap_b32 v160, v161
    v_max_f32 v160, v160, v161
    v_sub_f32 v40, 0xc2c80000, v160
    v_mov_b32 v41, v40
    v_mov_b32 v42, v40
    v_mov_b32 v43, v40
    v_mov_b32 v44, v40
    v_mov_b32 v45, v40
    v_mov_b32 v46, v40
    v_mov_b32 v47, v40
    v_mov_b32 v48, v40
    v_mov_b32 v49, v40
    v_mov_b32 v50, v40
    v_mov_b32 v51, v40
    v_mov_b32 v52, v40
    v_mov_b32 v53, v40
    v_mov_b32 v54, v40
    v_mov_b32 v55, v40
    v_pk_add_f32 v[56:57], v[56:57], v[24:25]
    v_pk_add_f32 v[58:59], v[58:59], v[24:25]
    v_pk_add_f32 v[60:61], v[60:61], v[24:25]
    v_pk_add_f32 v[62:63], v[62:63], v[24:25]
    v_pk_add_f32 v[64:65], v[64:65], v[24:25]
    v_pk_add_f32 v[66:67], v[66:67], v[24:25]
    v_pk_add_f32 v[68:69], v[68:69], v[24:25]
    v_pk_add_f32 v[70:71], v[70:71], v[24:25]
    s_barrier
    ds_read_b128 v[148:151], v157
    ds_read_b128 v[152:155], v157 offset:1024
    ds_read_b128 v[184:187], v156 offset:512
    ds_read_b128 v[188:191], v156 offset:4608
    v_mov_b32 v196, 0
    v_mov_b32 v197, 0
    v_mov_b32 v198, 0
    v_mov_b32 v199, 0
    s_waitcnt lgkmcnt(0)
attn_loop:
    v_mfma_f32_32x32x16_bf16 v[72:87], v[140:143], v[208:211], v[40:55]
    ds_read_b128 v[192:195], v157 offset:2048
    v_exp_f32 v56, v56
    v_exp_f32 v57, v57
    v_exp_f32 v58, v58
    v_mfma_f32_32x32x16_bf16 v[112:127], v[196:199], v[92:95], v[112:127]
    v_exp_f32 v59, v59
    v_exp_f32 v60, v60
    v_exp_f32 v61, v61
    v_mfma_f32_16x16x32_bf16 v[132:135], v[136:139], v[92:95], v[132:135]
    ds_read_b128 v[196:199], v157 offset:3072
    v_exp_f32 v62, v62
    v_exp_f32 v63, v63
    v_cvt_pk_bf16_f32 v88, v56, v57
    v_cvt_pk_bf16_f32 v89, v58, v59
    v_mfma_f32_32x32x16_bf16 v[72:87], v[144:147], v[212:215], v[72:87]
    v_exp_f32 v64, v64
    v_cvt_pk_bf16_f32 v90, v60, v61
    v_cvt_pk_bf16_f32 v91, v62, v63
    v_exp_f32 v65, v65
    v_exp_f32 v66, v66
    v_mfma_f32_32x32x16_bf16 v[96:111], v[148:151], v[88:91], v[96:111]
    v_exp_f32 v67, v67
    v_exp_f32 v68, v68
    v_exp_f32 v69, v69
    v_mfma_f32_16x16x32_bf16 v[128:131], v[136:139], v[88:91], v[128:131]
    v_exp_f32 v70, v70
    v_exp_f32 v71, v71
    v_cvt_pk_bf16_f32 v92, v64, v65
    v_cvt_pk_bf16_f32 v93, v66, v67
    v_cvt_pk_bf16_f32 v94, v68, v69
    v_cvt_pk_bf16_f32 v95, v70, v71
    s_waitcnt lgkmcnt(0)
    v_mfma_f32_32x32x16_bf16 v[56:71], v[184:187], v[200:203], v[24:39]
    v_exp_f32 v72, v72
    v_exp_f32 v73, v73
    v_exp_f32 v74, v74
    v_mfma_f32_32x32x16_bf16 v[96:111], v[152:155], v[92:95], v[96:111]
    ds_read_b128 v[140:143], v156 offset:1024
    v_exp_f32 v75, v75
    v_exp_f32 v76, v76
    v_exp_f32 v77, v77
    v_mfma_f32_16x16x32_bf16 v[128:131], v[136:139], v[92:95], v[128:131]
    v_exp_f32 v78, v78
    v_exp_f32 v79, v79
    v_cvt_pk_bf16_f32 v88, v72, v73
    v_cvt_pk_bf16_f32 v89, v74, v75
    v_mfma_f32_32x32x16_bf16 v[56:71], v[188:191], v[204:207], v[56:71]
    v_exp_f32 v80, v80
    v_cvt_pk_bf16_f32 v90, v76, v77
    v_cvt_pk_bf16_f32 v91, v78, v79
    v_exp_f32 v81, v81
    v_exp_f32 v82, v82
    v_mfma_f32_32x32x16_bf16 v[112:127], v[148:151], v[88:91], v[112:127]
    ds_read_b128 v[144:147], v156 offset:5120
    v_exp_f32 v83, v83
    v_exp_f32 v84, v84
    v_exp_f32 v85, v85
    v_mfma_f32_16x16x32_bf16 v[132:135], v[136:139], v[88:91], v[132:135]
    v_exp_f32 v86, v86
    v_exp_f32 v87, v87
    v_cvt_pk_bf16_f32 v92, v80, v81
    v_cvt_pk_bf16_f32 v93, v82, v83
    v_cvt_pk_bf16_f32 v94, v84, v85
    v_cvt_pk_bf16_f32 v95, v86, v87
    v_mfma_f32_32x32x16_bf16 v[72:87], v[184:187], v[208:211], v[40:55]
    ds_read_b128 v[148:151], v157 offset:4096
    v_exp_f32 v56, v56
    v_exp_f32 v57, v57
    v_exp_f32 v58, v58
    v_mfma_f32_32x32x16_bf16 v[112:127], v[152:155], v[92:95], v[112:127]
    v_exp_f32 v59, v59
    v_exp_f32 v60, v60
    v_exp_f32 v61, v61
    v_mfma_f32_16x16x32_bf16 v[132:135], v[136:139], v[92:95], v[132:135]
    ds_read_b128 v[152:155], v157 offset:5120
    v_exp_f32 v62, v62
    v_exp_f32 v63, v63
    v_cvt_pk_bf16_f32 v88, v56, v57
    v_cvt_pk_bf16_f32 v89, v58, v59
    v_mfma_f32_32x32x16_bf16 v[72:87], v[188:191], v[212:215], v[72:87]
    v_exp_f32 v64, v64
    v_cvt_pk_bf16_f32 v90, v60, v61
    v_cvt_pk_bf16_f32 v91, v62, v63
    v_exp_f32 v65, v65
    v_exp_f32 v66, v66
    v_mfma_f32_32x32x16_bf16 v[96:111], v[192:195], v[88:91], v[96:111]
    v_exp_f32 v67, v67
    v_exp_f32 v68, v68
    v_exp_f32 v69, v69
    v_mfma_f32_16x16x32_bf16 v[128:131], v[136:139], v[88:91], v[128:131]
    v_exp_f32 v70, v70
    v_exp_f32 v71, v71
    v_cvt_pk_bf16_f32 v92, v64, v65
    v_cvt_pk_bf16_f32 v93, v66, v67
    v_cvt_pk_bf16_f32 v94, v68, v69
    v_cvt_pk_bf16_f32 v95, v70, v71
    s_waitcnt lgkmcnt(0)
    v_mfma_f32_32x32x16_bf16 v[56:71], v[140:143], v[200:203], v[24:39]
    v_exp_f32 v72, v72
    v_exp_f32 v73, v73
    v_exp_f32 v74, v74
    v_mfma_f32_32x32x16_bf16 v[96:111], v[196:199], v[92:95], v[96:111]
    ds_read_b128 v[184:187], v156 offset:1536
    v_exp_f32 v75, v75
    v_exp_f32 v76, v76
    v_exp_f32 v77, v77
    v_mfma_f32_16x16x32_bf16 v[128:131], v[136:139], v[92:95], v[128:131]
    v_exp_f32 v78, v78
    v_exp_f32 v79, v79
    v_cvt_pk_bf16_f32 v88, v72, v73
    v_cvt_pk_bf16_f32 v89, v74, v75
    v_mfma_f32_32x32x16_bf16 v[56:71], v[144:147], v[204:207], v[56:71]
    v_exp_f32 v80, v80
    v_cvt_pk_bf16_f32 v90, v76, v77
    v_cvt_pk_bf16_f32 v91, v78, v79
    v_exp_f32 v81, v81
    v_exp_f32 v82, v82
    v_mfma_f32_32x32x16_bf16 v[112:127], v[192:195], v[88:91], v[112:127]
    ds_read_b128 v[188:191], v156 offset:5632
    v_exp_f32 v83, v83
    v_exp_f32 v84, v84
    v_exp_f32 v85, v85
    v_mfma_f32_16x16x32_bf16 v[132:135], v[136:139], v[88:91], v[132:135]
    v_exp_f32 v86, v86
    v_exp_f32 v87, v87
    v_cvt_pk_bf16_f32 v92, v80, v81
    v_cvt_pk_bf16_f32 v93, v82, v83
    v_cvt_pk_bf16_f32 v94, v84, v85
    v_cvt_pk_bf16_f32 v95, v86, v87
    v_mfma_f32_32x32x16_bf16 v[72:87], v[140:143], v[208:211], v[40:55]
    ds_read_b128 v[192:195], v157 offset:6144
    s_add_u32 s60, s60, 32768
    s_cmp_eq_u32 s60, 98304
    s_cselect_b32 s62, -65536, s61
    s_cselect_b32 s60, 0, s60
    v_exp_f32 v56, v56
    v_exp_f32 v57, v57
    v_exp_f32 v58, v58
    v_mfma_f32_32x32x16_bf16 v[112:127], v[196:199], v[92:95], v[112:127]
    v_exp_f32 v59, v59
    v_exp_f32 v60, v60
    v_exp_f32 v61, v61
    v_mfma_f32_16x16x32_bf16 v[132:135], v[136:139], v[92:95], v[132:135]
    ds_read_b128 v[196:199], v157 offset:7168
    v_exp_f32 v62, v62
    v_exp_f32 v63, v63
    v_cvt_pk_bf16_f32 v88, v56, v57
    v_cvt_pk_bf16_f32 v89, v58, v59
    v_mfma_f32_32x32x16_bf16 v[72:87], v[144:147], v[212:215], v[72:87]
    v_exp_f32 v64, v64
    v_cvt_pk_bf16_f32 v90, v60, v61
    v_cvt_pk_bf16_f32 v91, v62, v63
    v_exp_f32 v65, v65
    v_exp_f32 v66, v66
    v_mfma_f32_32x32x16_bf16 v[96:111], v[148:151], v[88:91], v[96:111]
    v_exp_f32 v67, v67
    v_exp_f32 v68, v68
    v_exp_f32 v69, v69
    v_mfma_f32_16x16x32_bf16 v[128:131], v[136:139], v[88:91], v[128:131]
    v_exp_f32 v70, v70
    v_exp_f32 v71, v71
    v_cvt_pk_bf16_f32 v92, v64, v65
    v_cvt_pk_bf16_f32 v93, v66, v67
    v_cvt_pk_bf16_f32 v94, v68, v69
    v_cvt_pk_bf16_f32 v95, v70, v71
    s_waitcnt lgkmcnt(0)
    v_mfma_f32_32x32x16_bf16 v[56:71], v[184:187], v[200:203], v[24:39]
    v_exp_f32 v72, v72
    v_exp_f32 v73, v73
    v_exp_f32 v74, v74
    v_mfma_f32_32x32x16_bf16 v[96:111], v[152:155], v[92:95], v[96:111]
    s_barrier
    v_add_u32 v156, s62, v156
    ds_read_b128 v[140:143], v156 offset:0
    v_exp_f32 v75, v75
    v_exp_f32 v76, v76
    v_exp_f32 v77, v77
    v_mfma_f32_16x16x32_bf16 v[128:131], v[136:139], v[92:95], v[128:131]
    v_exp_f32 v78, v78
    v_exp_f32 v79, v79
    v_cvt_pk_bf16_f32 v88, v72, v73
    v_cvt_pk_bf16_f32 v89, v74, v75
    v_mfma_f32_32x32x16_bf16 v[56:71], v[188:191], v[204:207], v[56:71]
    v_exp_f32 v80, v80
    v_cvt_pk_bf16_f32 v90, v76, v77
    v_cvt_pk_bf16_f32 v91, v78, v79
    v_exp_f32 v81, v81
    v_exp_f32 v82, v82
    v_mfma_f32_32x32x16_bf16 v[112:127], v[148:151], v[88:91], v[112:127]
    ds_read_b128 v[144:147], v156 offset:4096
    v_exp_f32 v83, v83
    v_exp_f32 v84, v84
    v_exp_f32 v85, v85
    v_mfma_f32_16x16x32_bf16 v[132:135], v[136:139], v[88:91], v[132:135]
    v_exp_f32 v86, v86
    v_exp_f32 v87, v87
    v_cvt_pk_bf16_f32 v92, v80, v81
    v_cvt_pk_bf16_f32 v93, v82, v83
    v_cvt_pk_bf16_f32 v94, v84, v85
    v_cvt_pk_bf16_f32 v95, v86, v87
    v_mfma_f32_32x32x16_bf16 v[72:87], v[184:187], v[208:211], v[40:55]
    v_add_u32 v157, s62, v157
    ds_read_b128 v[148:151], v157 offset:0
    v_exp_f32 v56, v56
    v_exp_f32 v57, v57
    v_exp_f32 v58, v58
    v_mfma_f32_32x32x16_bf16 v[112:127], v[152:155], v[92:95], v[112:127]
    v_exp_f32 v59, v59
    v_exp_f32 v60, v60
    v_exp_f32 v61, v61
    v_mfma_f32_16x16x32_bf16 v[132:135], v[136:139], v[92:95], v[132:135]
    ds_read_b128 v[152:155], v157 offset:1024
    v_exp_f32 v62, v62
    v_exp_f32 v63, v63
    v_cvt_pk_bf16_f32 v88, v56, v57
    v_cvt_pk_bf16_f32 v89, v58, v59
    v_mfma_f32_32x32x16_bf16 v[72:87], v[188:191], v[212:215], v[72:87]
    v_exp_f32 v64, v64
    v_cvt_pk_bf16_f32 v90, v60, v61
    v_cvt_pk_bf16_f32 v91, v62, v63
    v_exp_f32 v65, v65
    v_exp_f32 v66, v66
    v_mfma_f32_32x32x16_bf16 v[96:111], v[192:195], v[88:91], v[96:111]
    v_exp_f32 v67, v67
    v_exp_f32 v68, v68
    v_exp_f32 v69, v69
    v_mfma_f32_16x16x32_bf16 v[128:131], v[136:139], v[88:91], v[128:131]
    v_exp_f32 v70, v70
    v_exp_f32 v71, v71
    v_cvt_pk_bf16_f32 v92, v64, v65
    v_cvt_pk_bf16_f32 v93, v66, v67
    v_cvt_pk_bf16_f32 v94, v68, v69
    v_cvt_pk_bf16_f32 v95, v70, v71
    s_waitcnt lgkmcnt(0)
    v_mfma_f32_32x32x16_bf16 v[56:71], v[140:143], v[200:203], v[24:39]
    v_exp_f32 v72, v72
    v_exp_f32 v73, v73
    v_exp_f32 v74, v74
    v_mfma_f32_32x32x16_bf16 v[96:111], v[196:199], v[92:95], v[96:111]
    ds_read_b128 v[184:187], v156 offset:512
    v_exp_f32 v75, v75
    v_exp_f32 v76, v76
    v_exp_f32 v77, v77
    v_mfma_f32_16x16x32_bf16 v[128:131], v[136:139], v[92:95], v[128:131]
    v_exp_f32 v78, v78
    v_exp_f32 v79, v79
    v_cvt_pk_bf16_f32 v88, v72, v73
    v_cvt_pk_bf16_f32 v89, v74, v75
    v_mfma_f32_32x32x16_bf16 v[56:71], v[144:147], v[204:207], v[56:71]
    v_exp_f32 v80, v80
    v_cvt_pk_bf16_f32 v90, v76, v77
    v_cvt_pk_bf16_f32 v91, v78, v79
    v_exp_f32 v81, v81
    v_exp_f32 v82, v82
    v_mfma_f32_32x32x16_bf16 v[112:127], v[192:195], v[88:91], v[112:127]
    ds_read_b128 v[188:191], v156 offset:4608
    v_exp_f32 v83, v83
    v_exp_f32 v84, v84
    v_exp_f32 v85, v85
    v_mfma_f32_16x16x32_bf16 v[132:135], v[136:139], v[88:91], v[132:135]
    v_exp_f32 v86, v86
    v_exp_f32 v87, v87
    v_cvt_pk_bf16_f32 v92, v80, v81
    v_cvt_pk_bf16_f32 v93, v82, v83
    v_cvt_pk_bf16_f32 v94, v84, v85
    v_cvt_pk_bf16_f32 v95, v86, v87
    v_mfma_f32_32x32x16_bf16 v[72:87], v[140:143], v[208:211], v[40:55]
    ds_read_b128 v[192:195], v157 offset:2048
    v_exp_f32 v56, v56
    v_exp_f32 v57, v57
    v_exp_f32 v58, v58
    v_mfma_f32_32x32x16_bf16 v[112:127], v[196:199], v[92:95], v[112:127]
    v_exp_f32 v59, v59
    v_exp_f32 v60, v60
    v_exp_f32 v61, v61
    v_mfma_f32_16x16x32_bf16 v[132:135], v[136:139], v[92:95], v[132:135]
    ds_read_b128 v[196:199], v157 offset:3072
    v_exp_f32 v62, v62
    v_exp_f32 v63, v63
    v_cvt_pk_bf16_f32 v88, v56, v57
    v_cvt_pk_bf16_f32 v89, v58, v59
    v_mfma_f32_32x32x16_bf16 v[72:87], v[144:147], v[212:215], v[72:87]
    v_exp_f32 v64, v64
    v_cvt_pk_bf16_f32 v90, v60, v61
    v_cvt_pk_bf16_f32 v91, v62, v63
    v_exp_f32 v65, v65
    v_exp_f32 v66, v66
    v_mfma_f32_32x32x16_bf16 v[96:111], v[148:151], v[88:91], v[96:111]
    v_exp_f32 v67, v67
    v_exp_f32 v68, v68
    v_exp_f32 v69, v69
    v_mfma_f32_16x16x32_bf16 v[128:131], v[136:139], v[88:91], v[128:131]
    v_exp_f32 v70, v70
    v_exp_f32 v71, v71
    v_cvt_pk_bf16_f32 v92, v64, v65
    v_cvt_pk_bf16_f32 v93, v66, v67
    v_cvt_pk_bf16_f32 v94, v68, v69
    v_cvt_pk_bf16_f32 v95, v70, v71
    s_waitcnt lgkmcnt(0)
    v_mfma_f32_32x32x16_bf16 v[56:71], v[184:187], v[200:203], v[24:39]
    v_exp_f32 v72, v72
    v_exp_f32 v73, v73
    v_exp_f32 v74, v74
    v_mfma_f32_32x32x16_bf16 v[96:111], v[152:155], v[92:95], v[96:111]
    ds_read_b128 v[140:143], v156 offset:1024
    v_exp_f32 v75, v75
    v_exp_f32 v76, v76
    v_exp_f32 v77, v77
    v_mfma_f32_16x16x32_bf16 v[128:131], v[136:139], v[92:95], v[128:131]
    v_exp_f32 v78, v78
    v_exp_f32 v79, v79
    v_cvt_pk_bf16_f32 v88, v72, v73
    v_cvt_pk_bf16_f32 v89, v74, v75
    v_mfma_f32_32x32x16_bf16 v[56:71], v[188:191], v[204:207], v[56:71]
    v_exp_f32 v80, v80
    v_cvt_pk_bf16_f32 v90, v76, v77
    v_cvt_pk_bf16_f32 v91, v78, v79
    v_exp_f32 v81, v81
    v_exp_f32 v82, v82
    v_mfma_f32_32x32x16_bf16 v[112:127], v[148:151], v[88:91], v[112:127]
    ds_read_b128 v[144:147], v156 offset:5120
    v_exp_f32 v83, v83
    v_exp_f32 v84, v84
    v_exp_f32 v85, v85
    v_mfma_f32_16x16x32_bf16 v[132:135], v[136:139], v[88:91], v[132:135]
    v_exp_f32 v86, v86
    v_exp_f32 v87, v87
    v_cvt_pk_bf16_f32 v92, v80, v81
    v_cvt_pk_bf16_f32 v93, v82, v83
    v_cvt_pk_bf16_f32 v94, v84, v85
    v_cvt_pk_bf16_f32 v95, v86, v87
    v_mfma_f32_32x32x16_bf16 v[72:87], v[184:187], v[208:211], v[40:55]
    ds_read_b128 v[148:151], v157 offset:4096
    v_exp_f32 v56, v56
    v_exp_f32 v57, v57
    v_exp_f32 v58, v58
    v_mfma_f32_32x32x16_bf16 v[112:127], v[152:155], v[92:95], v[112:127]
    v_exp_f32 v59, v59
    v_exp_f32 v60, v60
    v_exp_f32 v61, v61
    v_mfma_f32_16x16x32_bf16 v[132:135], v[136:139], v[92:95], v[132:135]
    ds_read_b128 v[152:155], v157 offset:5120
    v_exp_f32 v62, v62
    v_exp_f32 v63, v63
    v_cvt_pk_bf16_f32 v88, v56, v57
    v_cvt_pk_bf16_f32 v89, v58, v59
    v_mfma_f32_32x32x16_bf16 v[72:87], v[188:191], v[212:215], v[72:87]
    v_exp_f32 v64, v64
    v_cvt_pk_bf16_f32 v90, v60, v61
    v_cvt_pk_bf16_f32 v91, v62, v63
    v_exp_f32 v65, v65
    v_exp_f32 v66, v66
    v_mfma_f32_32x32x16_bf16 v[96:111], v[192:195], v[88:91], v[96:111]
    v_exp_f32 v67, v67
    v_exp_f32 v68, v68
    v_exp_f32 v69, v69
    v_mfma_f32_16x16x32_bf16 v[128:131], v[136:139], v[88:91], v[128:131]
    v_exp_f32 v70, v70
    v_exp_f32 v71, v71
    v_cvt_pk_bf16_f32 v92, v64, v65
    v_cvt_pk_bf16_f32 v93, v66, v67
    v_cvt_pk_bf16_f32 v94, v68, v69
    v_cvt_pk_bf16_f32 v95, v70, v71
    s_waitcnt lgkmcnt(0)
    v_mfma_f32_32x32x16_bf16 v[56:71], v[140:143], v[200:203], v[24:39]
    v_exp_f32 v72, v72
    v_exp_f32 v73, v73
    v_exp_f32 v74, v74
    v_mfma_f32_32x32x16_bf16 v[96:111], v[196:199], v[92:95], v[96:111]
    ds_read_b128 v[184:187], v156 offset:1536
    v_exp_f32 v75, v75
    v_exp_f32 v76, v76
    v_exp_f32 v77, v77
    v_mfma_f32_16x16x32_bf16 v[128:131], v[136:139], v[92:95], v[128:131]
    v_exp_f32 v78, v78
    v_exp_f32 v79, v79
    v_cvt_pk_bf16_f32 v88, v72, v73
    v_cvt_pk_bf16_f32 v89, v74, v75
    v_mfma_f32_32x32x16_bf16 v[56:71], v[144:147], v[204:207], v[56:71]
    v_exp_f32 v80, v80
    v_cvt_pk_bf16_f32 v90, v76, v77
    v_cvt_pk_bf16_f32 v91, v78, v79
    v_exp_f32 v81, v81
    v_exp_f32 v82, v82
    v_mfma_f32_32x32x16_bf16 v[112:127], v[192:195], v[88:91], v[112:127]
    ds_read_b128 v[188:191], v156 offset:5632
    v_exp_f32 v83, v83
    v_exp_f32 v84, v84
    v_exp_f32 v85, v85
    v_mfma_f32_16x16x32_bf16 v[132:135], v[136:139], v[88:91], v[132:135]
    v_exp_f32 v86, v86
    v_exp_f32 v87, v87
    v_cvt_pk_bf16_f32 v92, v80, v81
    v_cvt_pk_bf16_f32 v93, v82, v83
    v_cvt_pk_bf16_f32 v94, v84, v85
    v_cvt_pk_bf16_f32 v95, v86, v87
    v_mfma_f32_32x32x16_bf16 v[72:87], v[140:143], v[208:211], v[40:55]
    ds_read_b128 v[192:195], v157 offset:6144
    s_add_u32 s60, s60, 32768
    s_cmp_eq_u32 s60, 98304
    s_cselect_b32 s62, -65536, s61
    s_cselect_b32 s60, 0, s60
    v_exp_f32 v56, v56
    v_exp_f32 v57, v57
    v_exp_f32 v58, v58
    v_mfma_f32_32x32x16_bf16 v[112:127], v[196:199], v[92:95], v[112:127]
    v_exp_f32 v59, v59
    v_exp_f32 v60, v60
    v_exp_f32 v61, v61
    v_mfma_f32_16x16x32_bf16 v[132:135], v[136:139], v[92:95], v[132:135]
    ds_read_b128 v[196:199], v157 offset:7168
    v_exp_f32 v62, v62
    v_exp_f32 v63, v63
    v_cvt_pk_bf16_f32 v88, v56, v57
    v_cvt_pk_bf16_f32 v89, v58, v59
    v_mfma_f32_32x32x16_bf16 v[72:87], v[144:147], v[212:215], v[72:87]
    v_exp_f32 v64, v64
    v_cvt_pk_bf16_f32 v90, v60, v61
    v_cvt_pk_bf16_f32 v91, v62, v63
    v_exp_f32 v65, v65
    v_exp_f32 v66, v66
    v_mfma_f32_32x32x16_bf16 v[96:111], v[148:151], v[88:91], v[96:111]
    v_exp_f32 v67, v67
    v_exp_f32 v68, v68
    v_exp_f32 v69, v69
    v_mfma_f32_16x16x32_bf16 v[128:131], v[136:139], v[88:91], v[128:131]
    v_exp_f32 v70, v70
    v_exp_f32 v71, v71
    v_cvt_pk_bf16_f32 v92, v64, v65
    v_cvt_pk_bf16_f32 v93, v66, v67
    v_cvt_pk_bf16_f32 v94, v68, v69
    v_cvt_pk_bf16_f32 v95, v70, v71
    s_waitcnt lgkmcnt(0)
    v_mfma_f32_32x32x16_bf16 v[56:71], v[184:187], v[200:203], v[24:39]
    v_exp_f32 v72, v72
    v_exp_f32 v73, v73
    v_exp_f32 v74, v74
    v_mfma_f32_32x32x16_bf16 v[96:111], v[152:155], v[92:95], v[96:111]
    s_barrier
    v_add_u32 v156, s62, v156
    ds_read_b128 v[140:143], v156 offset:0
    v_exp_f32 v75, v75
    v_exp_f32 v76, v76
    v_exp_f32 v77, v77
    v_mfma_f32_16x16x32_bf16 v[128:131], v[136:139], v[92:95], v[128:131]
    v_exp_f32 v78, v78
    v_exp_f32 v79, v79
    v_cvt_pk_bf16_f32 v88, v72, v73
    v_cvt_pk_bf16_f32 v89, v74, v75
    v_mfma_f32_32x32x16_bf16 v[56:71], v[188:191], v[204:207], v[56:71]
    v_exp_f32 v80, v80
    v_cvt_pk_bf16_f32 v90, v76, v77
    v_cvt_pk_bf16_f32 v91, v78, v79
    v_exp_f32 v81, v81
    v_exp_f32 v82, v82
    v_mfma_f32_32x32x16_bf16 v[112:127], v[148:151], v[88:91], v[112:127]
    ds_read_b128 v[144:147], v156 offset:4096
    v_exp_f32 v83, v83
    v_exp_f32 v84, v84
    v_exp_f32 v85, v85
    v_mfma_f32_16x16x32_bf16 v[132:135], v[136:139], v[88:91], v[132:135]
    v_exp_f32 v86, v86
    v_exp_f32 v87, v87
    v_cvt_pk_bf16_f32 v92, v80, v81
    v_cvt_pk_bf16_f32 v93, v82, v83
    v_cvt_pk_bf16_f32 v94, v84, v85
    v_cvt_pk_bf16_f32 v95, v86, v87
    v_mfma_f32_32x32x16_bf16 v[72:87], v[184:187], v[208:211], v[40:55]
    v_add_u32 v157, s62, v157
    ds_read_b128 v[148:151], v157 offset:0
    v_exp_f32 v56, v56
    v_exp_f32 v57, v57
    v_exp_f32 v58, v58
    v_mfma_f32_32x32x16_bf16 v[112:127], v[152:155], v[92:95], v[112:127]
    v_exp_f32 v59, v59
    v_exp_f32 v60, v60
    v_exp_f32 v61, v61
    v_mfma_f32_16x16x32_bf16 v[132:135], v[136:139], v[92:95], v[132:135]
    ds_read_b128 v[152:155], v157 offset:1024
    v_exp_f32 v62, v62
    v_exp_f32 v63, v63
    v_cvt_pk_bf16_f32 v88, v56, v57
    v_cvt_pk_bf16_f32 v89, v58, v59
    v_mfma_f32_32x32x16_bf16 v[72:87], v[188:191], v[212:215], v[72:87]
    v_exp_f32 v64, v64
    v_cvt_pk_bf16_f32 v90, v60, v61
    v_cvt_pk_bf16_f32 v91, v62, v63
    v_exp_f32 v65, v65
    v_exp_f32 v66, v66
    v_mfma_f32_32x32x16_bf16 v[96:111], v[192:195], v[88:91], v[96:111]
    v_exp_f32 v67, v67
    v_exp_f32 v68, v68
    v_exp_f32 v69, v69
    v_mfma_f32_16x16x32_bf16 v[128:131], v[136:139], v[88:91], v[128:131]
    v_exp_f32 v70, v70
    v_exp_f32 v71, v71
    v_cvt_pk_bf16_f32 v92, v64, v65
    v_cvt_pk_bf16_f32 v93, v66, v67
    v_cvt_pk_bf16_f32 v94, v68, v69
    v_cvt_pk_bf16_f32 v95, v70, v71
    s_waitcnt lgkmcnt(0)
    v_mfma_f32_32x32x16_bf16 v[56:71], v[140:143], v[200:203], v[24:39]
    v_exp_f32 v72, v72
    v_exp_f32 v73, v73
    v_exp_f32 v74, v74
    v_mfma_f32_32x32x16_bf16 v[96:111], v[196:199], v[92:95], v[96:111]
    ds_read_b128 v[184:187], v156 offset:512
    v_exp_f32 v75, v75
    v_exp_f32 v76, v76
    v_exp_f32 v77, v77
    v_mfma_f32_16x16x32_bf16 v[128:131], v[136:139], v[92:95], v[128:131]
    v_exp_f32 v78, v78
    v_exp_f32 v79, v79
    v_cvt_pk_bf16_f32 v88, v72, v73
    v_cvt_pk_bf16_f32 v89, v74, v75
    v_mfma_f32_32x32x16_bf16 v[56:71], v[144:147], v[204:207], v[56:71]
    v_exp_f32 v80, v80
    v_cvt_pk_bf16_f32 v90, v76, v77
    v_cvt_pk_bf16_f32 v91, v78, v79
    v_exp_f32 v81, v81
    v_exp_f32 v82, v82
    v_mfma_f32_32x32x16_bf16 v[112:127], v[192:195], v[88:91], v[112:127]
    ds_read_b128 v[188:191], v156 offset:4608
    v_exp_f32 v83, v83
    v_exp_f32 v84, v84
    v_exp_f32 v85, v85
    v_mfma_f32_16x16x32_bf16 v[132:135], v[136:139], v[88:91], v[132:135]
    v_exp_f32 v86, v86
    v_exp_f32 v87, v87
    v_cvt_pk_bf16_f32 v92, v80, v81
    v_cvt_pk_bf16_f32 v93, v82, v83
    v_cvt_pk_bf16_f32 v94, v84, v85
    v_cvt_pk_bf16_f32 v95, v86, v87
    s_add_u32 s59, s59, 1
    s_cmp_lt_u32 s59, 8
    s_cbranch_scc1 attn_loop
    v_mfma_f32_32x32x16_bf16 v[112:127], v[196:199], v[92:95], v[112:127]
    v_mfma_f32_16x16x32_bf16 v[132:135], v[136:139], v[92:95], v[132:135]
    s_waitcnt lgkmcnt(0)
    v_mov_b32 v162, 0x76800000
    v_mov_b32 v163, 0x7f800000
    v_add_f32 v160, abs(v96), abs(v97)
    v_add_f32 v160, v160, abs(v98)
    v_add_f32 v160, v160, abs(v99)
    v_add_f32 v160, v160, abs(v100)
    v_add_f32 v160, v160, abs(v101)
    v_add_f32 v160, v160, abs(v102)
    v_add_f32 v160, v160, abs(v103)
    v_add_f32 v160, v160, abs(v104)
    v_add_f32 v160, v160, abs(v105)
    v_add_f32 v160, v160, abs(v106)
    v_add_f32 v160, v160, abs(v107)
    v_add_f32 v160, v160, abs(v108)
    v_add_f32 v160, v160, abs(v109)
    v_add_f32 v160, v160, abs(v110)
    v_add_f32 v160, v160, abs(v111)
    v_cmp_nlt_f32 vcc, v128, v162
    v_cmp_nlt_f32 s[46:47], v160, v163
    s_nop 0
    s_or_b64 vcc, vcc, s[46:47]
    s_cbranch_vccnz attn_slow0
attn_fin0:
    v_rcp_f32 v160, v128
    s_nop 0
    v_mul_f32 v96, v96, v160
    v_mul_f32 v97, v97, v160
    v_mul_f32 v98, v98, v160
    v_mul_f32 v99, v99, v160
    v_mul_f32 v100, v100, v160
    v_mul_f32 v101, v101, v160
    v_mul_f32 v102, v102, v160
    v_mul_f32 v103, v103, v160
    v_mul_f32 v104, v104, v160
    v_mul_f32 v105, v105, v160
    v_mul_f32 v106, v106, v160
    v_mul_f32 v107, v107, v160
    v_mul_f32 v108, v108, v160
    v_mul_f32 v109, v109, v160
    v_mul_f32 v110, v110, v160
    v_mul_f32 v111, v111, v160
    v_cvt_pk_bf16_f32 v164, v96, v97
    v_cvt_pk_bf16_f32 v165, v98, v99
    v_cvt_pk_bf16_f32 v166, v100, v101
    v_cvt_pk_bf16_f32 v167, v102, v103
    v_cvt_pk_bf16_f32 v168, v104, v105
    v_cvt_pk_bf16_f32 v169, v106, v107
    v_cvt_pk_bf16_f32 v170, v108, v109
    v_cvt_pk_bf16_f32 v171, v110, v111
    v_permlane32_swap_b32 v164, v166
    v_permlane32_swap_b32 v165, v167
    v_permlane32_swap_b32 v168, v170
    v_permlane32_swap_b32 v169, v171
    s_add_u32 s46, s51, 66048
    buffer_store_dwordx4 v[164:167], v6, s[32:35], s51 offen offset:0 sc1
    buffer_store_dwordx4 v[168:171], v6, s[32:35], s46 offen offset:0 sc1
    v_add_f32 v160, abs(v112), abs(v113)
    v_add_f32 v160, v160, abs(v114)
    v_add_f32 v160, v160, abs(v115)
    v_add_f32 v160, v160, abs(v116)
    v_add_f32 v160, v160, abs(v117)
    v_add_f32 v160, v160, abs(v118)
    v_add_f32 v160, v160, abs(v119)
    v_add_f32 v160, v160, abs(v120)
    v_add_f32 v160, v160, abs(v121)
    v_add_f32 v160, v160, abs(v122)
    v_add_f32 v160, v160, abs(v123)
    v_add_f32 v160, v160, abs(v124)
    v_add_f32 v160, v160, abs(v125)
    v_add_f32 v160, v160, abs(v126)
    v_add_f32 v160, v160, abs(v127)
    v_cmp_nlt_f32 vcc, v132, v162
    v_cmp_nlt_f32 s[46:47], v160, v163
    s_nop 0
    s_or_b64 vcc, vcc, s[46:47]
    s_cbranch_vccnz attn_slow1
attn_fin1:
    v_rcp_f32 v160, v132
    s_nop 0
    v_mul_f32 v112, v112, v160
    v_mul_f32 v113, v113, v160
    v_mul_f32 v114, v114, v160
    v_mul_f32 v115, v115, v160
    v_mul_f32 v116, v116, v160
    v_mul_f32 v117, v117, v160
    v_mul_f32 v118, v118, v160
    v_mul_f32 v119, v119, v160
    v_mul_f32 v120, v120, v160
    v_mul_f32 v121, v121, v160
    v_mul_f32 v122, v122, v160
    v_mul_f32 v123, v123, v160
    v_mul_f32 v124, v124, v160
    v_mul_f32 v125, v125, v160
    v_mul_f32 v126, v126, v160
    v_mul_f32 v127, v127, v160
    v_cvt_pk_bf16_f32 v172, v112, v113
    v_cvt_pk_bf16_f32 v173, v114, v115
    v_cvt_pk_bf16_f32 v174, v116, v117
    v_cvt_pk_bf16_f32 v175, v118, v119
    v_cvt_pk_bf16_f32 v176, v120, v121
    v_cvt_pk_bf16_f32 v177, v122, v123
    v_cvt_pk_bf16_f32 v178, v124, v125
    v_cvt_pk_bf16_f32 v179, v126, v127
    v_permlane32_swap_b32 v172, v174
    v_permlane32_swap_b32 v173, v175
    v_permlane32_swap_b32 v176, v178
    v_permlane32_swap_b32 v177, v179
    s_add_u32 s46, s51, 66048
    buffer_store_dwordx4 v[172:175], v6, s[32:35], s51 offen offset:512 sc1
    buffer_store_dwordx4 v[176:179], v6, s[32:35], s46 offen offset:512 sc1
    s_waitcnt vmcnt(0)
    s_barrier
    s_lshr_b32 s40, s43, 1
    s_and_b32 s41, s43, 1
    s_lshl_b32 s40, s40, 3
    s_lshl_b32 s41, s41, 2
    s_lshr_b32 s46, s44, 2
    s_and_b32 s47, s44, 3
    s_add_u32 s40, s40, s46
    s_add_u32 s41, s41, s47
    s_and_b32 s54, s42, 1
    s_lshr_b32 s53, s42, 1
    s_lshl_b32 s53, s53, 5
    s_mov_b32 s28, s4
    s_mov_b32 s29, s5
    s_mov_b32 s30, 65536
    s_mov_b32 s31, 0x20000
    s_add_u32 s32, s4, 29360128
    s_addc_u32 s33, s5, 0
    s_mov_b32 s34, 4227072
    s_mov_b32 s35, 0x20000
    s_add_u32 s36, s4, 131072
    s_addc_u32 s37, s5, 0
    s_mov_b32 s38, 262144
    s_mov_b32 s39, 0x20000
    s_lshl_b32 s56, s40, 6
    s_add_u32 s56, s56, s53
    v_and_b32 v3, 31, v1
    v_lshrrev_b32 v4, 5, v1
    v_add_u32 v5, s53, v3
    v_lshlrev_b32 v5, 8, v5
    v_lshl_add_u32 v5, v4, 3, v5
    v_add_u32 v5, 0, v5
    v_and_b32 v6, 15, v1
    s_lshl_b32 s58, s54, 3
    v_xor_b32 v6, s58, v6
    v_xor_b32 v7, 0, v6
    v_lshl_add_u32 v7, v7, 4, v5
    ds_read_b64 v[200:201], v7
    v_xor_b32 v7, 1, v6
    v_lshl_add_u32 v7, v7, 4, v5
    ds_read_b64 v[202:203], v7
    v_xor_b32 v7, 2, v6
    v_lshl_add_u32 v7, v7, 4, v5
    ds_read_b64 v[204:205], v7
    v_xor_b32 v7, 3, v6
    v_lshl_add_u32 v7, v7, 4, v5
    ds_read_b64 v[206:207], v7
    v_xor_b32 v7, 4, v6
    v_lshl_add_u32 v7, v7, 4, v5
    ds_read_b64 v[208:209], v7
    v_xor_b32 v7, 5, v6
    v_lshl_add_u32 v7, v7, 4, v5
    ds_read_b64 v[210:211], v7
    v_xor_b32 v7, 6, v6
    v_lshl_add_u32 v7, v7, 4, v5
    ds_read_b64 v[212:213], v7
    v_xor_b32 v7, 7, v6
    v_lshl_add_u32 v7, v7, 4, v5
    ds_read_b64 v[214:215], v7
    s_waitcnt lgkmcnt(0)
    v_lshlrev_b32 v164, 16, v200
    v_and_b32 v165, 0xffff0000, v200
    v_lshlrev_b32 v166, 16, v201
    v_and_b32 v167, 0xffff0000, v201
    v_lshlrev_b32 v168, 16, v202
    v_and_b32 v169, 0xffff0000, v202
    v_lshlrev_b32 v170, 16, v203
    v_and_b32 v171, 0xffff0000, v203
    v_lshlrev_b32 v172, 16, v204
    v_and_b32 v173, 0xffff0000, v204
    v_lshlrev_b32 v174, 16, v205
    v_and_b32 v175, 0xffff0000, v205
    v_lshlrev_b32 v176, 16, v206
    v_and_b32 v177, 0xffff0000, v206
    v_lshlrev_b32 v178, 16, v207
    v_and_b32 v179, 0xffff0000, v207
    v_lshlrev_b32 v180, 16, v208
    v_and_b32 v181, 0xffff0000, v208
    v_lshlrev_b32 v182, 16, v209
    v_and_b32 v183, 0xffff0000, v209
    v_lshlrev_b32 v184, 16, v210
    v_and_b32 v185, 0xffff0000, v210
    v_lshlrev_b32 v186, 16, v211
    v_and_b32 v187, 0xffff0000, v211
    v_lshlrev_b32 v188, 16, v212
    v_and_b32 v189, 0xffff0000, v212
    v_lshlrev_b32 v190, 16, v213
    v_and_b32 v191, 0xffff0000, v213
    v_lshlrev_b32 v192, 16, v214
    v_and_b32 v193, 0xffff0000, v214
    v_lshlrev_b32 v194, 16, v215
    v_and_b32 v195, 0xffff0000, v215
    v_and_b32 v3, 31, v1
    v_lshrrev_b32 v4, 5, v1
    v_add_u32 v5, s53, v3
    v_mul_u32_u24 v6, 1024, v4
    v_lshl_add_u32 v160, v5, 4, v6
    v_lshrrev_b32 v4, 4, v1
    v_bfe_u32 v6, v1, 2, 2
    v_and_b32 v7, 3, v1
    v_lshrrev_b32 v8, 1, v4
    v_lshl_add_u32 v8, v8, 3, v6
    v_lshlrev_b32 v8, 7, v8
    v_and_b32 v9, 1, v4
    v_lshl_add_u32 v8, v9, 5, v8
    v_lshl_add_u32 v8, v7, 3, v8
    v_lshrrev_b32 v9, 1, v6
    s_mul_i32 s48, s54, 8192
    s_add_u32 s48, s48, 8192
    v_xor_b32 v10, 0, v9
    v_lshl_add_u32 v161, v10, 6, v8
    v_add_u32 v161, s48, v161
    v_xor_b32 v10, 1, v9
    v_lshl_add_u32 v162, v10, 6, v8
    v_add_u32 v162, s48, v162
    v_add_u32 v160, 24576, v160
    v_add_u32 v161, 24576, v161
    v_add_u32 v162, 24576, v162
    v_mov_b32 v16, 0
    v_mov_b32 v17, 0
    v_mov_b32 v18, 0
    v_mov_b32 v19, 0
    v_mov_b32 v20, 0
    v_mov_b32 v21, 0
    v_mov_b32 v22, 0
    v_mov_b32 v23, 0
    v_mov_b32 v24, 0
    v_mov_b32 v25, 0
    v_mov_b32 v26, 0
    v_mov_b32 v27, 0
    v_mov_b32 v28, 0
    v_mov_b32 v29, 0
    v_mov_b32 v30, 0
    v_mov_b32 v31, 0
    v_mov_b32 v32, 0
    v_mov_b32 v33, 0
    v_mov_b32 v34, 0
    v_mov_b32 v35, 0
    v_mov_b32 v36, 0
    v_mov_b32 v37, 0
    v_mov_b32 v38, 0
    v_mov_b32 v39, 0
    v_mov_b32 v40, 0
    v_mov_b32 v41, 0
    v_mov_b32 v42, 0
    v_mov_b32 v43, 0
    v_mov_b32 v44, 0
    v_mov_b32 v45, 0
    v_mov_b32 v46, 0
    v_mov_b32 v47, 0
    s_mov_b32 s46, 24576
    s_mov_b32 s47, 15
    s_mov_b32 s49, 24576
    s_barrier
    v_cmp_gt_u32 vcc, 96, v0
    s_nop 0
    s_and_saveexec_b64 s[62:63], vcc
    s_cbranch_execz wo_nostage1
    v_lshrrev_b32 v6, 5, v0
    v_and_b32 v7, 31, v0
    v_mov_b32 v8, 0
    v_mov_b32 v232, 0
    v_mov_b32 v9, 8192
    v_cmp_le_u32 vcc, 1, v6
    s_nop 1
    v_cndmask_b32 v8, v8, v9, vcc
    v_mov_b32 v9, 4096
    v_cmp_le_u32 vcc, 2, v6
    s_nop 1
    v_cndmask_b32 v8, v8, v9, vcc
    v_cmp_eq_u32 vcc, 1, v6
    s_nop 1
    v_cndmask_b32 v232, 0, 1.0, vcc
    v_lshl_add_u32 v8, v7, 4, v8
    s_lshl_b32 s61, s41, 9
    buffer_load_dwordx4 v[216:219], v8, s[28:31], s61 offen sc1
    s_add_u32 s61, s61, 16384
    buffer_load_dwordx4 v[220:223], v8, s[28:31], s61 offen sc1
    s_add_u32 s61, s61, 16384
    buffer_load_dwordx4 v[224:227], v8, s[28:31], s61 offen sc1
    s_add_u32 s61, s61, 16384
    buffer_load_dwordx4 v[228:231], v8, s[28:31], s61 offen sc1
    s_add_u32 s61, s61, 16384
wo_nostage1:
    s_mov_b64 exec, s[62:63]
    s_barrier
    ds_read_b128 v[48:51], v160 offset:0
    ds_read_b64_tr_b16 v[52:53], v161 offset:0
    ds_read_b64_tr_b16 v[54:55], v161 offset:512
    ds_read_b64_tr_b16 v[56:57], v162 offset:0
    ds_read_b64_tr_b16 v[58:59], v162 offset:512
    ds_read_b128 v[60:63], v160 offset:2048
    ds_read_b64_tr_b16 v[64:65], v161 offset:2048
    ds_read_b64_tr_b16 v[66:67], v161 offset:2560
    ds_read_b64_tr_b16 v[68:69], v162 offset:2048
    ds_read_b64_tr_b16 v[70:71], v162 offset:2560
    ds_read_b128 v[72:75], v160 offset:4096
    ds_read_b64_tr_b16 v[76:77], v161 offset:4096
    ds_read_b64_tr_b16 v[78:79], v161 offset:4608
    ds_read_b64_tr_b16 v[80:81], v162 offset:4096
    ds_read_b64_tr_b16 v[82:83], v162 offset:4608
    ds_read_b128 v[84:87], v160 offset:6144
    ds_read_b64_tr_b16 v[88:89], v161 offset:6144
    ds_read_b64_tr_b16 v[90:91], v161 offset:6656
    ds_read_b64_tr_b16 v[92:93], v162 offset:6144
    ds_read_b64_tr_b16 v[94:95], v162 offset:6656
    v_cmp_gt_u32 vcc, 96, v0
    s_nop 0
    s_and_saveexec_b64 s[62:63], vcc
    s_cbranch_execz wo_nostage2
    v_lshlrev_b32 v9, 4, v0
    v_add_u32 v9, 159744, v9
    s_waitcnt vmcnt(0)
    v_add_f32 v216, v216, v220
    v_add_f32 v224, v224, v228
    v_add_f32 v217, v217, v221
    v_add_f32 v225, v225, v229
    v_add_f32 v218, v218, v222
    v_add_f32 v226, v226, v230
    v_add_f32 v219, v219, v223
    v_add_f32 v227, v227, v231
    v_add_f32 v216, v216, v232
    v_add_f32 v217, v217, v232
    v_add_f32 v218, v218, v232
    v_add_f32 v219, v219, v232
    v_add_f32 v216, v216, v224
    v_add_f32 v217, v217, v225
    v_add_f32 v218, v218, v226
    v_add_f32 v219, v219, v227
    ds_write_b128 v9, v[216:219]
    s_waitcnt lgkmcnt(0)
wo_nostage2:
    s_mov_b64 exec, s[62:63]
    s_add_u32 s46, s46, 24576
    s_cmp_eq_u32 s46, 147456
    s_cselect_b32 s48, 4294844416, s49
    s_cselect_b32 s46, 0, s46
    s_mov_b32 s47, 7
wo_loop:
    s_barrier
    s_waitcnt lgkmcnt(15)
    v_mfma_f32_32x32x16_bf16 v[16:31], v[52:55], v[48:51], v[16:31]
    v_add_u32 v160, s48, v160
    v_add_u32 v161, s48, v161
    v_add_u32 v162, s48, v162
    s_waitcnt lgkmcnt(15)
    v_mfma_f32_32x32x16_bf16 v[32:47], v[56:59], v[48:51], v[32:47]
    ds_read_b128 v[96:99], v160 offset:0
    ds_read_b64_tr_b16 v[100:101], v161 offset:0
    ds_read_b64_tr_b16 v[102:103], v161 offset:512
    s_waitcnt lgkmcnt(15)
    v_mfma_f32_32x32x16_bf16 v[16:31], v[64:67], v[60:63], v[16:31]
    ds_read_b64_tr_b16 v[104:105], v162 offset:0
    ds_read_b64_tr_b16 v[106:107], v162 offset:512
    ds_read_b128 v[108:111], v160 offset:2048
    s_waitcnt lgkmcnt(15)
    v_mfma_f32_32x32x16_bf16 v[32:47], v[68:71], v[60:63], v[32:47]
    ds_read_b64_tr_b16 v[112:113], v161 offset:2048
    ds_read_b64_tr_b16 v[114:115], v161 offset:2560
    ds_read_b64_tr_b16 v[116:117], v162 offset:2048
    s_waitcnt lgkmcnt(15)
    v_mfma_f32_32x32x16_bf16 v[16:31], v[76:79], v[72:75], v[16:31]
    ds_read_b64_tr_b16 v[118:119], v162 offset:2560
    ds_read_b128 v[120:123], v160 offset:4096
    ds_read_b64_tr_b16 v[124:125], v161 offset:4096
    s_waitcnt lgkmcnt(15)
    v_mfma_f32_32x32x16_bf16 v[32:47], v[80:83], v[72:75], v[32:47]
    ds_read_b64_tr_b16 v[126:127], v161 offset:4608
    ds_read_b64_tr_b16 v[128:129], v162 offset:4096
    ds_read_b64_tr_b16 v[130:131], v162 offset:4608
    s_waitcnt lgkmcnt(15)
    v_mfma_f32_32x32x16_bf16 v[16:31], v[88:91], v[84:87], v[16:31]
    ds_read_b128 v[132:135], v160 offset:6144
    ds_read_b64_tr_b16 v[136:137], v161 offset:6144
    ds_read_b64_tr_b16 v[138:139], v161 offset:6656
    s_waitcnt lgkmcnt(15)
    v_mfma_f32_32x32x16_bf16 v[32:47], v[92:95], v[84:87], v[32:47]
    ds_read_b64_tr_b16 v[140:141], v162 offset:6144
    ds_read_b64_tr_b16 v[142:143], v162 offset:6656
    s_add_u32 s46, s46, 24576
    s_cmp_eq_u32 s46, 147456
    s_cselect_b32 s48, 4294844416, s49
    s_cselect_b32 s46, 0, s46
    s_barrier
    s_waitcnt lgkmcnt(15)
    v_mfma_f32_32x32x16_bf16 v[16:31], v[100:103], v[96:99], v[16:31]
    v_add_u32 v160, s48, v160
    v_add_u32 v161, s48, v161
    v_add_u32 v162, s48, v162
    s_waitcnt lgkmcnt(15)
    v_mfma_f32_32x32x16_bf16 v[32:47], v[104:107], v[96:99], v[32:47]
    ds_read_b128 v[48:51], v160 offset:0
    ds_read_b64_tr_b16 v[52:53], v161 offset:0
    ds_read_b64_tr_b16 v[54:55], v161 offset:512
    s_waitcnt lgkmcnt(15)
    v_mfma_f32_32x32x16_bf16 v[16:31], v[112:115], v[108:111], v[16:31]
    ds_read_b64_tr_b16 v[56:57], v162 offset:0
    ds_read_b64_tr_b16 v[58:59], v162 offset:512
    ds_read_b128 v[60:63], v160 offset:2048
    s_waitcnt lgkmcnt(15)
    v_mfma_f32_32x32x16_bf16 v[32:47], v[116:119], v[108:111], v[32:47]
    ds_read_b64_tr_b16 v[64:65], v161 offset:2048
    ds_read_b64_tr_b16 v[66:67], v161 offset:2560
    ds_read_b64_tr_b16 v[68:69], v162 offset:2048
    s_waitcnt lgkmcnt(15)
    v_mfma_f32_32x32x16_bf16 v[16:31], v[124:127], v[120:123], v[16:31]
    ds_read_b64_tr_b16 v[70:71], v162 offset:2560
    ds_read_b128 v[72:75], v160 offset:4096
    ds_read_b64_tr_b16 v[76:77], v161 offset:4096
    s_waitcnt lgkmcnt(15)
    v_mfma_f32_32x32x16_bf16 v[32:47], v[128:131], v[120:123], v[32:47]
    ds_read_b64_tr_b16 v[78:79], v161 offset:4608
    ds_read_b64_tr_b16 v[80:81], v162 offset:4096
    ds_read_b64_tr_b16 v[82:83], v162 offset:4608
    s_waitcnt lgkmcnt(15)
    v_mfma_f32_32x32x16_bf16 v[16:31], v[136:139], v[132:135], v[16:31]
    ds_read_b128 v[84:87], v160 offset:6144
    ds_read_b64_tr_b16 v[88:89], v161 offset:6144
    ds_read_b64_tr_b16 v[90:91], v161 offset:6656
    s_waitcnt lgkmcnt(15)
    v_mfma_f32_32x32x16_bf16 v[32:47], v[140:143], v[132:135], v[32:47]
    ds_read_b64_tr_b16 v[92:93], v162 offset:6144
    ds_read_b64_tr_b16 v[94:95], v162 offset:6656
    s_add_u32 s46, s46, 24576
    s_cmp_eq_u32 s46, 147456
    s_cselect_b32 s48, 4294844416, s49
    s_cselect_b32 s46, 0, s46
    s_sub_u32 s47, s47, 1
    s_cmp_lg_u32 s47, 0
    s_cbranch_scc1 wo_loop
    s_barrier
    s_waitcnt lgkmcnt(15)
    v_mfma_f32_32x32x16_bf16 v[16:31], v[52:55], v[48:51], v[16:31]
    v_add_u32 v160, s48, v160
    v_add_u32 v161, s48, v161
    v_add_u32 v162, s48, v162
    s_waitcnt lgkmcnt(15)
    v_mfma_f32_32x32x16_bf16 v[32:47], v[56:59], v[48:51], v[32:47]
    ds_read_b128 v[96:99], v160 offset:0
    ds_read_b64_tr_b16 v[100:101], v161 offset:0
    ds_read_b64_tr_b16 v[102:103], v161 offset:512
    s_waitcnt lgkmcnt(15)
    v_mfma_f32_32x32x16_bf16 v[16:31], v[64:67], v[60:63], v[16:31]
    ds_read_b64_tr_b16 v[104:105], v162 offset:0
    ds_read_b64_tr_b16 v[106:107], v162 offset:512
    ds_read_b128 v[108:111], v160 offset:2048
    s_waitcnt lgkmcnt(15)
    v_mfma_f32_32x32x16_bf16 v[32:47], v[68:71], v[60:63], v[32:47]
    ds_read_b64_tr_b16 v[112:113], v161 offset:2048
    ds_read_b64_tr_b16 v[114:115], v161 offset:2560
    ds_read_b64_tr_b16 v[116:117], v162 offset:2048
    s_waitcnt lgkmcnt(15)
    v_mfma_f32_32x32x16_bf16 v[16:31], v[76:79], v[72:75], v[16:31]
    ds_read_b64_tr_b16 v[118:119], v162 offset:2560
    ds_read_b128 v[120:123], v160 offset:4096
    ds_read_b64_tr_b16 v[124:125], v161 offset:4096
    s_waitcnt lgkmcnt(15)
    v_mfma_f32_32x32x16_bf16 v[32:47], v[80:83], v[72:75], v[32:47]
    ds_read_b64_tr_b16 v[126:127], v161 offset:4608
    ds_read_b64_tr_b16 v[128:129], v162 offset:4096
    ds_read_b64_tr_b16 v[130:131], v162 offset:4608
    s_waitcnt lgkmcnt(15)
    v_mfma_f32_32x32x16_bf16 v[16:31], v[88:91], v[84:87], v[16:31]
    ds_read_b128 v[132:135], v160 offset:6144
    ds_read_b64_tr_b16 v[136:137], v161 offset:6144
    ds_read_b64_tr_b16 v[138:139], v161 offset:6656
    s_waitcnt lgkmcnt(15)
    v_mfma_f32_32x32x16_bf16 v[32:47], v[92:95], v[84:87], v[32:47]
    ds_read_b64_tr_b16 v[140:141], v162 offset:6144
    ds_read_b64_tr_b16 v[142:143], v162 offset:6656
    s_add_u32 s46, s46, 24576
    s_cmp_eq_u32 s46, 147456
    s_cselect_b32 s48, 4294844416, s49
    s_cselect_b32 s46, 0, s46
    s_waitcnt lgkmcnt(15)
    v_mfma_f32_32x32x16_bf16 v[16:31], v[100:103], v[96:99], v[16:31]
    v_lshrrev_b32 v4, 5, v1
    s_lshl_b32 s58, s54, 8
    s_add_u32 s58, s58, 159744
    s_waitcnt lgkmcnt(15)
    v_mfma_f32_32x32x16_bf16 v[32:47], v[104:107], v[96:99], v[32:47]
    v_lshl_add_u32 v6, v4, 4, s58
    ds_read_b128 v[48:51], v6 offset:0
    ds_read_b128 v[52:55], v6 offset:32
    s_waitcnt lgkmcnt(14)
    v_mfma_f32_32x32x16_bf16 v[16:31], v[112:115], v[108:111], v[16:31]
    ds_read_b128 v[56:59], v6 offset:64
    ds_read_b128 v[60:63], v6 offset:96
    ds_read_b128 v[64:67], v6 offset:128
    s_waitcnt lgkmcnt(15)
    v_mfma_f32_32x32x16_bf16 v[32:47], v[116:119], v[108:111], v[32:47]
    ds_read_b128 v[68:71], v6 offset:160
    ds_read_b128 v[72:75], v6 offset:192
    ds_read_b128 v[76:79], v6 offset:224
    s_waitcnt lgkmcnt(15)
    v_mfma_f32_32x32x16_bf16 v[16:31], v[124:127], v[120:123], v[16:31]
    s_waitcnt lgkmcnt(13)
    v_mfma_f32_32x32x16_bf16 v[32:47], v[128:131], v[120:123], v[32:47]
    s_waitcnt lgkmcnt(10)
    v_mfma_f32_32x32x16_bf16 v[16:31], v[136:139], v[132:135], v[16:31]
    s_waitcnt lgkmcnt(8)
    v_mfma_f32_32x32x16_bf16 v[32:47], v[140:143], v[132:135], v[32:47]
    v_and_b32 v3, 31, v1
    s_waitcnt lgkmcnt(0)
    s_nop 7
    v_pk_fma_f32 v[16:17], v[16:17], v[48:49], v[164:165]
    v_pk_fma_f32 v[18:19], v[18:19], v[50:51], v[166:167]
    v_pk_fma_f32 v[20:21], v[20:21], v[52:53], v[168:169]
    v_pk_fma_f32 v[22:23], v[22:23], v[54:55], v[170:171]
    v_pk_fma_f32 v[24:25], v[24:25], v[56:57], v[172:173]
    v_pk_fma_f32 v[26:27], v[26:27], v[58:59], v[174:175]
    v_pk_fma_f32 v[28:29], v[28:29], v[60:61], v[176:177]
    v_pk_fma_f32 v[30:31], v[30:31], v[62:63], v[178:179]
    v_pk_fma_f32 v[32:33], v[32:33], v[64:65], v[180:181]
    v_pk_fma_f32 v[34:35], v[34:35], v[66:67], v[182:183]
    v_pk_fma_f32 v[36:37], v[36:37], v[68:69], v[184:185]
    v_pk_fma_f32 v[38:39], v[38:39], v[70:71], v[186:187]
    v_pk_fma_f32 v[40:41], v[40:41], v[72:73], v[188:189]
    v_pk_fma_f32 v[42:43], v[42:43], v[74:75], v[190:191]
    v_pk_fma_f32 v[44:45], v[44:45], v[76:77], v[192:193]
    v_pk_fma_f32 v[46:47], v[46:47], v[78:79], v[194:195]
    v_pk_add_f32 v[8:9], v[16:17], v[18:19]
    v_pk_mul_f32 v[10:11], v[16:17], v[16:17]
    v_pk_fma_f32 v[10:11], v[18:19], v[18:19], v[10:11]
    v_pk_add_f32 v[8:9], v[8:9], v[20:21]
    v_pk_fma_f32 v[10:11], v[20:21], v[20:21], v[10:11]
    v_pk_add_f32 v[8:9], v[8:9], v[22:23]
    v_pk_fma_f32 v[10:11], v[22:23], v[22:23], v[10:11]
    v_pk_add_f32 v[8:9], v[8:9], v[24:25]
    v_pk_fma_f32 v[10:11], v[24:25], v[24:25], v[10:11]
    v_pk_add_f32 v[8:9], v[8:9], v[26:27]
    v_pk_fma_f32 v[10:11], v[26:27], v[26:27], v[10:11]
    v_pk_add_f32 v[8:9], v[8:9], v[28:29]
    v_pk_fma_f32 v[10:11], v[28:29], v[28:29], v[10:11]
    v_pk_add_f32 v[8:9], v[8:9], v[30:31]
    v_pk_fma_f32 v[10:11], v[30:31], v[30:31], v[10:11]
    v_pk_add_f32 v[8:9], v[8:9], v[32:33]
    v_pk_fma_f32 v[10:11], v[32:33], v[32:33], v[10:11]
    v_pk_add_f32 v[8:9], v[8:9], v[34:35]
    v_pk_fma_f32 v[10:11], v[34:35], v[34:35], v[10:11]
    v_pk_add_f32 v[8:9], v[8:9], v[36:37]
    v_pk_fma_f32 v[10:11], v[36:37], v[36:37], v[10:11]
    v_pk_add_f32 v[8:9], v[8:9], v[38:39]
    v_pk_fma_f32 v[10:11], v[38:39], v[38:39], v[10:11]
    v_pk_add_f32 v[8:9], v[8:9], v[40:41]
    v_pk_fma_f32 v[10:11], v[40:41], v[40:41], v[10:11]
    v_pk_add_f32 v[8:9], v[8:9], v[42:43]
    v_pk_fma_f32 v[10:11], v[42:43], v[42:43], v[10:11]
    v_pk_add_f32 v[8:9], v[8:9], v[44:45]
    v_pk_fma_f32 v[10:11], v[44:45], v[44:45], v[10:11]
    v_pk_add_f32 v[8:9], v[8:9], v[46:47]
    v_pk_fma_f32 v[10:11], v[46:47], v[46:47], v[10:11]
    v_add_f32 v8, v8, v9
    v_add_f32 v9, v10, v11
    v_mov_b32 v10, v8
    v_mov_b32 v11, v9
    s_nop 0
    v_permlane32_swap_b32 v8, v10
    v_permlane32_swap_b32 v9, v11
    v_add_f32 v8, v8, v10
    v_add_f32 v9, v9, v11
    s_lshl_b32 s58, s40, 13
    s_lshl_b32 s59, s53, 3
    s_add_u32 s58, s58, s59
    s_lshl_b32 s59, s41, 1
    s_add_u32 s59, s59, s54
    s_lshl_b32 s59, s59, 9
    s_add_u32 s59, s59, s58
    v_lshlrev_b32 v7, 3, v3
    s_mov_b64 exec, 0xffffffff
    buffer_store_dwordx2 v[8:9], v7, s[36:39], s59 offen sc0 sc1
    s_mov_b64 exec, -1
    ds_read_b128 v[48:51], v6 offset:512
    ds_read_b128 v[52:55], v6 offset:544
    ds_read_b128 v[56:59], v6 offset:576
    ds_read_b128 v[60:63], v6 offset:608
    ds_read_b128 v[64:67], v6 offset:640
    ds_read_b128 v[68:71], v6 offset:672
    ds_read_b128 v[72:75], v6 offset:704
    ds_read_b128 v[76:79], v6 offset:736
    ds_read_b128 v[128:131], v6 offset:1024
    ds_read_b128 v[132:135], v6 offset:1056
    ds_read_b128 v[136:139], v6 offset:1088
    ds_read_b128 v[140:143], v6 offset:1120
    ds_read_b128 v[144:147], v6 offset:1152
    ds_read_b128 v[148:151], v6 offset:1184
    ds_read_b128 v[152:155], v6 offset:1216
    ds_read_b128 v[156:159], v6 offset:1248
    v_cvt_pk_bf16_f32 v240, v16, v17
    v_cvt_pk_bf16_f32 v241, v18, v19
    v_cvt_pk_bf16_f32 v242, v20, v21
    v_cvt_pk_bf16_f32 v243, v22, v23
    v_cvt_pk_bf16_f32 v244, v24, v25
    v_cvt_pk_bf16_f32 v245, v26, v27
    v_cvt_pk_bf16_f32 v246, v28, v29
    v_cvt_pk_bf16_f32 v247, v30, v31
    v_cvt_pk_bf16_f32 v248, v32, v33
    v_cvt_pk_bf16_f32 v249, v34, v35
    v_cvt_pk_bf16_f32 v250, v36, v37
    v_cvt_pk_bf16_f32 v251, v38, v39
    v_cvt_pk_bf16_f32 v252, v40, v41
    v_cvt_pk_bf16_f32 v253, v42, v43
    v_cvt_pk_bf16_f32 v254, v44, v45
    v_cvt_pk_bf16_f32 v255, v46, v47
    v_lshl_add_u32 v7, v4, 12, v7
    s_lshl_b32 s60, s41, 1
    s_add_u32 s60, s60, s54
    s_mul_i32 s60, s60, 264192
    s_lshl_b32 s59, s56, 4
    s_add_u32 s60, s60, s59
    v_mul_u32_u24 v5, 33024, v4
    v_lshl_add_u32 v5, v3, 4, v5
    s_mov_b32 s61, 524288
wo_poll:
    buffer_load_dwordx2 v[80:81], v7, s[36:39], s58 offen offset:0 sc0 sc1
    buffer_load_dwordx2 v[82:83], v7, s[36:39], s58 offen offset:512 sc0 sc1
    buffer_load_dwordx2 v[84:85], v7, s[36:39], s58 offen offset:1024 sc0 sc1
    buffer_load_dwordx2 v[86:87], v7, s[36:39], s58 offen offset:1536 sc0 sc1
    buffer_load_dwordx2 v[88:89], v7, s[36:39], s58 offen offset:2048 sc0 sc1
    buffer_load_dwordx2 v[90:91], v7, s[36:39], s58 offen offset:2560 sc0 sc1
    buffer_load_dwordx2 v[92:93], v7, s[36:39], s58 offen offset:3072 sc0 sc1
    buffer_load_dwordx2 v[94:95], v7, s[36:39], s58 offen offset:3584 sc0 sc1
    s_waitcnt vmcnt(0)
    v_max3_u32 v8, v81, v83, v85
    v_max3_u32 v9, v87, v89, v91
    v_max3_u32 v8, v8, v93, v95
    v_max_u32 v8, v8, v9
    v_cmp_eq_u32 vcc, -1, v8
    s_sub_u32 s61, s61, 1
    s_cmp_eq_u32 s61, 0
    s_cbranch_scc1 wo_polled
    s_cbranch_vccnz wo_poll
wo_polled:
    v_pk_add_f32 v[80:81], v[80:81], v[88:89]
    v_pk_add_f32 v[82:83], v[82:83], v[90:91]
    v_pk_add_f32 v[84:85], v[84:85], v[92:93]
    v_pk_add_f32 v[86:87], v[86:87], v[94:95]
    v_pk_add_f32 v[80:81], v[80:81], v[84:85]
    v_pk_add_f32 v[82:83], v[82:83], v[86:87]
    v_pk_add_f32 v[80:81], v[80:81], v[82:83]
    v_mov_b32 v10, v80
    v_mov_b32 v11, v81
    s_nop 0
    v_permlane32_swap_b32 v80, v10
    v_permlane32_swap_b32 v81, v11
    v_add_f32 v8, v80, v10
    v_add_f32 v9, v81, v11
    v_mul_f32 v8, 0x3a800000, v8
    v_mul_f32 v9, 0x3a800000, v9
    v_fma_f32 v9, -v8, v8, v9
    v_max_f32 v9, 0, v9
    v_add_f32 v9, 0x3727c5ac, v9
    v_rsq_f32 v9, v9
    s_nop 0
    v_mul_f32 v8, v8, v9
    v_sub_f32 v8, 0, v8
    v_mov_b32 v10, v9
    v_mov_b32 v11, v9
    v_mov_b32 v9, v8
    s_waitcnt lgkmcnt(0)
    v_pk_fma_f32 v[16:17], v[16:17], v[10:11], v[8:9]
    v_pk_fma_f32 v[18:19], v[18:19], v[10:11], v[8:9]
    v_pk_fma_f32 v[20:21], v[20:21], v[10:11], v[8:9]
    v_pk_fma_f32 v[22:23], v[22:23], v[10:11], v[8:9]
    v_pk_fma_f32 v[24:25], v[24:25], v[10:11], v[8:9]
    v_pk_fma_f32 v[26:27], v[26:27], v[10:11], v[8:9]
    v_pk_fma_f32 v[28:29], v[28:29], v[10:11], v[8:9]
    v_pk_fma_f32 v[30:31], v[30:31], v[10:11], v[8:9]
    v_pk_fma_f32 v[16:17], v[16:17], v[48:49], v[128:129]
    v_pk_fma_f32 v[18:19], v[18:19], v[50:51], v[130:131]
    v_pk_fma_f32 v[20:21], v[20:21], v[52:53], v[132:133]
    v_pk_fma_f32 v[22:23], v[22:23], v[54:55], v[134:135]
    v_pk_fma_f32 v[24:25], v[24:25], v[56:57], v[136:137]
    v_pk_fma_f32 v[26:27], v[26:27], v[58:59], v[138:139]
    v_pk_fma_f32 v[28:29], v[28:29], v[60:61], v[140:141]
    v_pk_fma_f32 v[30:31], v[30:31], v[62:63], v[142:143]
    v_cvt_pk_bf16_f32 v80, v16, v17
    v_cvt_pk_bf16_f32 v81, v18, v19
    v_cvt_pk_bf16_f32 v82, v20, v21
    v_cvt_pk_bf16_f32 v83, v22, v23
    v_cvt_pk_bf16_f32 v84, v24, v25
    v_cvt_pk_bf16_f32 v85, v26, v27
    v_cvt_pk_bf16_f32 v86, v28, v29
    v_cvt_pk_bf16_f32 v87, v30, v31
    v_permlane32_swap_b32 v80, v82
    v_permlane32_swap_b32 v81, v83
    v_permlane32_swap_b32 v84, v86
    v_permlane32_swap_b32 v85, v87
    buffer_store_dwordx4 v[80:83], v5, s[32:35], s60 offen sc1
    s_add_u32 s60, s60, 66048
    buffer_store_dwordx4 v[84:87], v5, s[32:35], s60 offen sc1
    s_add_u32 s60, s60, 66048
    v_pk_fma_f32 v[32:33], v[32:33], v[10:11], v[8:9]
    v_pk_fma_f32 v[34:35], v[34:35], v[10:11], v[8:9]
    v_pk_fma_f32 v[36:37], v[36:37], v[10:11], v[8:9]
    v_pk_fma_f32 v[38:39], v[38:39], v[10:11], v[8:9]
    v_pk_fma_f32 v[40:41], v[40:41], v[10:11], v[8:9]
    v_pk_fma_f32 v[42:43], v[42:43], v[10:11], v[8:9]
    v_pk_fma_f32 v[44:45], v[44:45], v[10:11], v[8:9]
    v_pk_fma_f32 v[46:47], v[46:47], v[10:11], v[8:9]
    v_pk_fma_f32 v[32:33], v[32:33], v[64:65], v[144:145]
    v_pk_fma_f32 v[34:35], v[34:35], v[66:67], v[146:147]
    v_pk_fma_f32 v[36:37], v[36:37], v[68:69], v[148:149]
    v_pk_fma_f32 v[38:39], v[38:39], v[70:71], v[150:151]
    v_pk_fma_f32 v[40:41], v[40:41], v[72:73], v[152:153]
    v_pk_fma_f32 v[42:43], v[42:43], v[74:75], v[154:155]
    v_pk_fma_f32 v[44:45], v[44:45], v[76:77], v[156:157]
    v_pk_fma_f32 v[46:47], v[46:47], v[78:79], v[158:159]
    v_cvt_pk_bf16_f32 v88, v32, v33
    v_cvt_pk_bf16_f32 v89, v34, v35
    v_cvt_pk_bf16_f32 v90, v36, v37
    v_cvt_pk_bf16_f32 v91, v38, v39
    v_cvt_pk_bf16_f32 v92, v40, v41
    v_cvt_pk_bf16_f32 v93, v42, v43
    v_cvt_pk_bf16_f32 v94, v44, v45
    v_cvt_pk_bf16_f32 v95, v46, v47
    v_permlane32_swap_b32 v88, v90
    v_permlane32_swap_b32 v89, v91
    v_permlane32_swap_b32 v92, v94
    v_permlane32_swap_b32 v93, v95
    buffer_store_dwordx4 v[88:91], v5, s[32:35], s60 offen sc1
    s_add_u32 s60, s60, 66048
    buffer_store_dwordx4 v[92:95], v5, s[32:35], s60 offen sc1
    s_add_u32 s60, s60, 66048
    s_waitcnt vmcnt(0)
    s_barrier
    s_lshr_b32 s40, s43, 2
    s_and_b32 s41, s43, 3
    s_lshl_b32 s40, s40, 3
    s_lshl_b32 s41, s41, 2
    s_lshr_b32 s46, s44, 2
    s_and_b32 s47, s44, 3
    s_add_u32 s40, s40, s46
    s_add_u32 s41, s41, s47
    s_and_b32 s54, s42, 1
    s_lshr_b32 s53, s42, 1
    s_lshl_b32 s53, s53, 6
    v_and_b32 v3, 15, v1
    v_lshrrev_b32 v4, 4, v1
    v_add_u32 v5, s53, v3
    v_mul_u32_u24 v6, 2048, v4
    v_lshl_add_u32 v216, v5, 4, v6
    v_lshrrev_b32 v4, 4, v1
    v_bfe_u32 v6, v1, 2, 2
    v_and_b32 v7, 3, v1
    v_lshl_add_u32 v8, v4, 3, v6
    v_and_b32 v9, 1, v4
    v_lshrrev_b32 v10, 1, v6
    v_lshl_add_u32 v10, v9, 1, v10
    v_lshlrev_b32 v11, 7, v8
    v_lshl_add_u32 v11, v7, 3, v11
    s_lshl_b32 s48, s54, 1
    s_add_u32 s48, s48, 0
    v_xor_b32 v12, s48, v10
    v_lshl_add_u32 v12, v12, 5, v11
    v_add_u32 v217, 16384, v12
    s_lshl_b32 s48, s54, 1
    s_add_u32 s48, s48, 1
    v_xor_b32 v12, s48, v10
    v_lshl_add_u32 v12, v12, 5, v11
    v_add_u32 v218, 16384, v12
    v_lshlrev_b32 v11, 6, v8
    v_lshl_add_u32 v11, v7, 3, v11
    v_xor_b32 v12, s54, v9
    v_lshl_add_u32 v12, v12, 5, v11
    v_add_u32 v219, 40960, v12
    v_add_u32 v216, 114688, v216
    v_add_u32 v217, 114688, v217
    v_add_u32 v218, 114688, v218
    v_add_u32 v219, 114688, v219
    v_mov_b32 v16, 0
    v_mov_b32 v17, 0
    v_mov_b32 v18, 0
    v_mov_b32 v19, 0
    v_mov_b32 v20, 0
    v_mov_b32 v21, 0
    v_mov_b32 v22, 0
    v_mov_b32 v23, 0
    v_mov_b32 v24, 0
    v_mov_b32 v25, 0
    v_mov_b32 v26, 0
    v_mov_b32 v27, 0
    v_mov_b32 v28, 0
    v_mov_b32 v29, 0
    v_mov_b32 v30, 0
    v_mov_b32 v31, 0
    v_mov_b32 v32, 0
    v_mov_b32 v33, 0
    v_mov_b32 v34, 0
    v_mov_b32 v35, 0
    v_mov_b32 v36, 0
    v_mov_b32 v37, 0
    v_mov_b32 v38, 0
    v_mov_b32 v39, 0
    v_mov_b32 v40, 0
    v_mov_b32 v41, 0
    v_mov_b32 v42, 0
    v_mov_b32 v43, 0
    v_mov_b32 v44, 0
    v_mov_b32 v45, 0
    v_mov_b32 v46, 0
    v_mov_b32 v47, 0
    v_mov_b32 v48, 0
    v_mov_b32 v49, 0
    v_mov_b32 v50, 0
    v_mov_b32 v51, 0
    v_mov_b32 v52, 0
    v_mov_b32 v53, 0
    v_mov_b32 v54, 0
    v_mov_b32 v55, 0
    v_mov_b32 v56, 0
    v_mov_b32 v57, 0
    v_mov_b32 v58, 0
    v_mov_b32 v59, 0
    v_mov_b32 v60, 0
    v_mov_b32 v61, 0
    v_mov_b32 v62, 0
    v_mov_b32 v63, 0
    v_mov_b32 v64, 0
    v_mov_b32 v65, 0
    v_mov_b32 v66, 0
    v_mov_b32 v67, 0
    v_mov_b32 v68, 0
    v_mov_b32 v69, 0
    v_mov_b32 v70, 0
    v_mov_b32 v71, 0
    v_mov_b32 v72, 0
    v_mov_b32 v73, 0
    v_mov_b32 v74, 0
    v_mov_b32 v75, 0
    v_mov_b32 v76, 0
    v_mov_b32 v77, 0
    v_mov_b32 v78, 0
    v_mov_b32 v79, 0
    v_mov_b32 v80, 0
    v_mov_b32 v81, 0
    v_mov_b32 v82, 0
    v_mov_b32 v83, 0
    v_mov_b32 v84, 0
    v_mov_b32 v85, 0
    v_mov_b32 v86, 0
    v_mov_b32 v87, 0
    v_mov_b32 v88, 0
    v_mov_b32 v89, 0
    v_mov_b32 v90, 0
    v_mov_b32 v91, 0
    v_mov_b32 v92, 0
    v_mov_b32 v93, 0
    v_mov_b32 v94, 0
    v_mov_b32 v95, 0
    v_mov_b32 v96, 0
    v_mov_b32 v97, 0
    v_mov_b32 v98, 0
    v_mov_b32 v99, 0
    v_mov_b32 v100, 0
    v_mov_b32 v101, 0
    v_mov_b32 v102, 0
    v_mov_b32 v103, 0
    v_mov_b32 v104, 0
    v_mov_b32 v105, 0
    v_mov_b32 v106, 0
    v_mov_b32 v107, 0
    v_mov_b32 v108, 0
    v_mov_b32 v109, 0
    v_mov_b32 v110, 0
    v_mov_b32 v111, 0
    v_mov_b32 v112, 0
    v_mov_b32 v113, 0
    v_mov_b32 v114, 0
    v_mov_b32 v115, 0
    v_mov_b32 v116, 0
    v_mov_b32 v117, 0
    v_mov_b32 v118, 0
    v_mov_b32 v119, 0
    v_mov_b32 v120, 0
    v_mov_b32 v121, 0
    v_mov_b32 v122, 0
    v_mov_b32 v123, 0
    v_mov_b32 v124, 0
    v_mov_b32 v125, 0
    v_mov_b32 v126, 0
    v_mov_b32 v127, 0
    s_mov_b32 s46, 90112
    s_mov_b32 s47, 15
    s_mov_b32 s49, 45056
    s_barrier
    s_add_u32 s46, s46, 45056
    s_cmp_eq_u32 s46, 135168
    s_cselect_b32 s48, 4294877184, s49
    s_cselect_b32 s46, 0, s46
    s_barrier
    ds_read_b128 v[128:131], v216 offset:0
    ds_read_b64_tr_b16 v[144:145], v217 offset:0
    ds_read_b64_tr_b16 v[146:147], v217 offset:512
    ds_read_b128 v[132:135], v216 offset:256
    ds_read_b128 v[136:139], v216 offset:512
    ds_read_b128 v[140:143], v216 offset:768
    ds_read_b64_tr_b16 v[148:149], v218 offset:0
    ds_read_b64_tr_b16 v[150:151], v218 offset:512
    ds_read_b64_tr_b16 v[152:153], v217 offset:8192
    ds_read_b64_tr_b16 v[154:155], v217 offset:8704
    ds_read_b64_tr_b16 v[156:157], v218 offset:8192
    ds_read_b64_tr_b16 v[158:159], v218 offset:8704
    ds_read_b64_tr_b16 v[160:161], v217 offset:16384
    ds_read_b64_tr_b16 v[162:163], v217 offset:16896
    ds_read_b64_tr_b16 v[164:165], v218 offset:16384
    ds_read_b64_tr_b16 v[166:167], v218 offset:16896
    ds_read_b64_tr_b16 v[168:169], v219 offset:0
    ds_read_b64_tr_b16 v[170:171], v219 offset:256
    s_mov_b32 s47, 7
win_loop:
    s_waitcnt lgkmcnt(0)
    v_mfma_f32_16x16x32_bf16 v[16:19], v[144:147], v[128:131], v[16:19]
    ds_read_b128 v[172:175], v216 offset:8192
    v_mfma_f32_16x16x32_bf16 v[44:47], v[144:147], v[132:135], v[44:47]
    ds_read_b64_tr_b16 v[188:189], v217 offset:4096
    v_mfma_f32_16x16x32_bf16 v[72:75], v[144:147], v[136:139], v[72:75]
    ds_read_b64_tr_b16 v[190:191], v217 offset:4608
    v_mfma_f32_16x16x32_bf16 v[100:103], v[144:147], v[140:143], v[100:103]
    ds_read_b128 v[176:179], v216 offset:8448
    v_mfma_f32_16x16x32_bf16 v[104:107], v[148:151], v[140:143], v[104:107]
    ds_read_b128 v[180:183], v216 offset:8704
    v_mfma_f32_16x16x32_bf16 v[76:79], v[148:151], v[136:139], v[76:79]
    ds_read_b128 v[184:187], v216 offset:8960
    v_mfma_f32_16x16x32_bf16 v[48:51], v[148:151], v[132:135], v[48:51]
    ds_read_b64_tr_b16 v[192:193], v218 offset:4096
    v_mfma_f32_16x16x32_bf16 v[20:23], v[148:151], v[128:131], v[20:23]
    ds_read_b64_tr_b16 v[194:195], v218 offset:4608
    v_mfma_f32_16x16x32_bf16 v[24:27], v[152:155], v[128:131], v[24:27]
    ds_read_b64_tr_b16 v[196:197], v217 offset:12288
    v_mfma_f32_16x16x32_bf16 v[52:55], v[152:155], v[132:135], v[52:55]
    ds_read_b64_tr_b16 v[198:199], v217 offset:12800
    v_mfma_f32_16x16x32_bf16 v[80:83], v[152:155], v[136:139], v[80:83]
    ds_read_b64_tr_b16 v[200:201], v218 offset:12288
    v_mfma_f32_16x16x32_bf16 v[108:111], v[152:155], v[140:143], v[108:111]
    ds_read_b64_tr_b16 v[202:203], v218 offset:12800
    v_mfma_f32_16x16x32_bf16 v[112:115], v[156:159], v[140:143], v[112:115]
    ds_read_b64_tr_b16 v[204:205], v217 offset:20480
    v_mfma_f32_16x16x32_bf16 v[84:87], v[156:159], v[136:139], v[84:87]
    ds_read_b64_tr_b16 v[206:207], v217 offset:20992
    v_mfma_f32_16x16x32_bf16 v[56:59], v[156:159], v[132:135], v[56:59]
    ds_read_b64_tr_b16 v[208:209], v218 offset:20480
    v_mfma_f32_16x16x32_bf16 v[28:31], v[156:159], v[128:131], v[28:31]
    ds_read_b64_tr_b16 v[210:211], v218 offset:20992
    v_mfma_f32_16x16x32_bf16 v[32:35], v[160:163], v[128:131], v[32:35]
    ds_read_b64_tr_b16 v[212:213], v219 offset:2048
    v_mfma_f32_16x16x32_bf16 v[60:63], v[160:163], v[132:135], v[60:63]
    ds_read_b64_tr_b16 v[214:215], v219 offset:2304
    v_mfma_f32_16x16x32_bf16 v[88:91], v[160:163], v[136:139], v[88:91]
    v_add_u32 v220, s48, v216
    v_mfma_f32_16x16x32_bf16 v[116:119], v[160:163], v[140:143], v[116:119]
    v_add_u32 v221, s48, v217
    v_mfma_f32_16x16x32_bf16 v[120:123], v[164:167], v[140:143], v[120:123]
    v_add_u32 v222, s48, v218
    v_mfma_f32_16x16x32_bf16 v[92:95], v[164:167], v[136:139], v[92:95]
    v_add_u32 v223, s48, v219
    v_mfma_f32_16x16x32_bf16 v[64:67], v[164:167], v[132:135], v[64:67]
    v_mfma_f32_16x16x32_bf16 v[36:39], v[164:167], v[128:131], v[36:39]
    v_mfma_f32_16x16x32_bf16 v[40:43], v[168:171], v[128:131], v[40:43]
    v_mfma_f32_16x16x32_bf16 v[68:71], v[168:171], v[132:135], v[68:71]
    v_mfma_f32_16x16x32_bf16 v[96:99], v[168:171], v[136:139], v[96:99]
    v_mfma_f32_16x16x32_bf16 v[124:127], v[168:171], v[140:143], v[124:127]
    s_waitcnt lgkmcnt(0)
    s_barrier
    v_mfma_f32_16x16x32_bf16 v[16:19], v[188:191], v[172:175], v[16:19]
    ds_read_b128 v[128:131], v220 offset:0
    v_mfma_f32_16x16x32_bf16 v[44:47], v[188:191], v[176:179], v[44:47]
    ds_read_b64_tr_b16 v[144:145], v221 offset:0
    v_mfma_f32_16x16x32_bf16 v[72:75], v[188:191], v[180:183], v[72:75]
    ds_read_b64_tr_b16 v[146:147], v221 offset:512
    v_mfma_f32_16x16x32_bf16 v[100:103], v[188:191], v[184:187], v[100:103]
    ds_read_b128 v[132:135], v220 offset:256
    v_mfma_f32_16x16x32_bf16 v[104:107], v[192:195], v[184:187], v[104:107]
    ds_read_b128 v[136:139], v220 offset:512
    v_mfma_f32_16x16x32_bf16 v[76:79], v[192:195], v[180:183], v[76:79]
    ds_read_b128 v[140:143], v220 offset:768
    v_mfma_f32_16x16x32_bf16 v[48:51], v[192:195], v[176:179], v[48:51]
    ds_read_b64_tr_b16 v[148:149], v222 offset:0
    v_mfma_f32_16x16x32_bf16 v[20:23], v[192:195], v[172:175], v[20:23]
    ds_read_b64_tr_b16 v[150:151], v222 offset:512
    v_mfma_f32_16x16x32_bf16 v[24:27], v[196:199], v[172:175], v[24:27]
    ds_read_b64_tr_b16 v[152:153], v221 offset:8192
    v_mfma_f32_16x16x32_bf16 v[52:55], v[196:199], v[176:179], v[52:55]
    ds_read_b64_tr_b16 v[154:155], v221 offset:8704
    v_mfma_f32_16x16x32_bf16 v[80:83], v[196:199], v[180:183], v[80:83]
    ds_read_b64_tr_b16 v[156:157], v222 offset:8192
    v_mfma_f32_16x16x32_bf16 v[108:111], v[196:199], v[184:187], v[108:111]
    ds_read_b64_tr_b16 v[158:159], v222 offset:8704
    v_mfma_f32_16x16x32_bf16 v[112:115], v[200:203], v[184:187], v[112:115]
    ds_read_b64_tr_b16 v[160:161], v221 offset:16384
    v_mfma_f32_16x16x32_bf16 v[84:87], v[200:203], v[180:183], v[84:87]
    ds_read_b64_tr_b16 v[162:163], v221 offset:16896
    v_mfma_f32_16x16x32_bf16 v[56:59], v[200:203], v[176:179], v[56:59]
    ds_read_b64_tr_b16 v[164:165], v222 offset:16384
    v_mfma_f32_16x16x32_bf16 v[28:31], v[200:203], v[172:175], v[28:31]
    ds_read_b64_tr_b16 v[166:167], v222 offset:16896
    v_mfma_f32_16x16x32_bf16 v[32:35], v[204:207], v[172:175], v[32:35]
    ds_read_b64_tr_b16 v[168:169], v223 offset:0
    v_mfma_f32_16x16x32_bf16 v[60:63], v[204:207], v[176:179], v[60:63]
    ds_read_b64_tr_b16 v[170:171], v223 offset:256
    v_mfma_f32_16x16x32_bf16 v[88:91], v[204:207], v[180:183], v[88:91]
    s_add_u32 s46, s46, 45056
    v_mfma_f32_16x16x32_bf16 v[116:119], v[204:207], v[184:187], v[116:119]
    s_cmp_eq_u32 s46, 135168
    v_mfma_f32_16x16x32_bf16 v[120:123], v[208:211], v[184:187], v[120:123]
    s_cselect_b32 s48, 4294877184, s49
    v_mfma_f32_16x16x32_bf16 v[92:95], v[208:211], v[180:183], v[92:95]
    s_cselect_b32 s46, 0, s46
    v_mfma_f32_16x16x32_bf16 v[64:67], v[208:211], v[176:179], v[64:67]
    v_mfma_f32_16x16x32_bf16 v[36:39], v[208:211], v[172:175], v[36:39]
    v_mfma_f32_16x16x32_bf16 v[40:43], v[212:215], v[172:175], v[40:43]
    v_mfma_f32_16x16x32_bf16 v[68:71], v[212:215], v[176:179], v[68:71]
    v_mfma_f32_16x16x32_bf16 v[96:99], v[212:215], v[180:183], v[96:99]
    v_mfma_f32_16x16x32_bf16 v[124:127], v[212:215], v[184:187], v[124:127]
    s_waitcnt lgkmcnt(0)
    v_mfma_f32_16x16x32_bf16 v[16:19], v[144:147], v[128:131], v[16:19]
    ds_read_b128 v[172:175], v220 offset:8192
    v_mfma_f32_16x16x32_bf16 v[44:47], v[144:147], v[132:135], v[44:47]
    ds_read_b64_tr_b16 v[188:189], v221 offset:4096
    v_mfma_f32_16x16x32_bf16 v[72:75], v[144:147], v[136:139], v[72:75]
    ds_read_b64_tr_b16 v[190:191], v221 offset:4608
    v_mfma_f32_16x16x32_bf16 v[100:103], v[144:147], v[140:143], v[100:103]
    ds_read_b128 v[176:179], v220 offset:8448
    v_mfma_f32_16x16x32_bf16 v[104:107], v[148:151], v[140:143], v[104:107]
    ds_read_b128 v[180:183], v220 offset:8704
    v_mfma_f32_16x16x32_bf16 v[76:79], v[148:151], v[136:139], v[76:79]
    ds_read_b128 v[184:187], v220 offset:8960
    v_mfma_f32_16x16x32_bf16 v[48:51], v[148:151], v[132:135], v[48:51]
    ds_read_b64_tr_b16 v[192:193], v222 offset:4096
    v_mfma_f32_16x16x32_bf16 v[20:23], v[148:151], v[128:131], v[20:23]
    ds_read_b64_tr_b16 v[194:195], v222 offset:4608
    v_mfma_f32_16x16x32_bf16 v[24:27], v[152:155], v[128:131], v[24:27]
    ds_read_b64_tr_b16 v[196:197], v221 offset:12288
    v_mfma_f32_16x16x32_bf16 v[52:55], v[152:155], v[132:135], v[52:55]
    ds_read_b64_tr_b16 v[198:199], v221 offset:12800
    v_mfma_f32_16x16x32_bf16 v[80:83], v[152:155], v[136:139], v[80:83]
    ds_read_b64_tr_b16 v[200:201], v222 offset:12288
    v_mfma_f32_16x16x32_bf16 v[108:111], v[152:155], v[140:143], v[108:111]
    ds_read_b64_tr_b16 v[202:203], v222 offset:12800
    v_mfma_f32_16x16x32_bf16 v[112:115], v[156:159], v[140:143], v[112:115]
    ds_read_b64_tr_b16 v[204:205], v221 offset:20480
    v_mfma_f32_16x16x32_bf16 v[84:87], v[156:159], v[136:139], v[84:87]
    ds_read_b64_tr_b16 v[206:207], v221 offset:20992
    v_mfma_f32_16x16x32_bf16 v[56:59], v[156:159], v[132:135], v[56:59]
    ds_read_b64_tr_b16 v[208:209], v222 offset:20480
    v_mfma_f32_16x16x32_bf16 v[28:31], v[156:159], v[128:131], v[28:31]
    ds_read_b64_tr_b16 v[210:211], v222 offset:20992
    v_mfma_f32_16x16x32_bf16 v[32:35], v[160:163], v[128:131], v[32:35]
    ds_read_b64_tr_b16 v[212:213], v223 offset:2048
    v_mfma_f32_16x16x32_bf16 v[60:63], v[160:163], v[132:135], v[60:63]
    ds_read_b64_tr_b16 v[214:215], v223 offset:2304
    v_mfma_f32_16x16x32_bf16 v[88:91], v[160:163], v[136:139], v[88:91]
    v_add_u32 v216, s48, v220
    v_mfma_f32_16x16x32_bf16 v[116:119], v[160:163], v[140:143], v[116:119]
    v_add_u32 v217, s48, v221
    v_mfma_f32_16x16x32_bf16 v[120:123], v[164:167], v[140:143], v[120:123]
    v_add_u32 v218, s48, v222
    v_mfma_f32_16x16x32_bf16 v[92:95], v[164:167], v[136:139], v[92:95]
    v_add_u32 v219, s48, v223
    v_mfma_f32_16x16x32_bf16 v[64:67], v[164:167], v[132:135], v[64:67]
    v_mfma_f32_16x16x32_bf16 v[36:39], v[164:167], v[128:131], v[36:39]
    v_mfma_f32_16x16x32_bf16 v[40:43], v[168:171], v[128:131], v[40:43]
    v_mfma_f32_16x16x32_bf16 v[68:71], v[168:171], v[132:135], v[68:71]
    v_mfma_f32_16x16x32_bf16 v[96:99], v[168:171], v[136:139], v[96:99]
    v_mfma_f32_16x16x32_bf16 v[124:127], v[168:171], v[140:143], v[124:127]
    s_waitcnt lgkmcnt(0)
    s_barrier
    v_mfma_f32_16x16x32_bf16 v[16:19], v[188:191], v[172:175], v[16:19]
    ds_read_b128 v[128:131], v216 offset:0
    v_mfma_f32_16x16x32_bf16 v[44:47], v[188:191], v[176:179], v[44:47]
    ds_read_b64_tr_b16 v[144:145], v217 offset:0
    v_mfma_f32_16x16x32_bf16 v[72:75], v[188:191], v[180:183], v[72:75]
    ds_read_b64_tr_b16 v[146:147], v217 offset:512
    v_mfma_f32_16x16x32_bf16 v[100:103], v[188:191], v[184:187], v[100:103]
    ds_read_b128 v[132:135], v216 offset:256
    v_mfma_f32_16x16x32_bf16 v[104:107], v[192:195], v[184:187], v[104:107]
    ds_read_b128 v[136:139], v216 offset:512
    v_mfma_f32_16x16x32_bf16 v[76:79], v[192:195], v[180:183], v[76:79]
    ds_read_b128 v[140:143], v216 offset:768
    v_mfma_f32_16x16x32_bf16 v[48:51], v[192:195], v[176:179], v[48:51]
    ds_read_b64_tr_b16 v[148:149], v218 offset:0
    v_mfma_f32_16x16x32_bf16 v[20:23], v[192:195], v[172:175], v[20:23]
    ds_read_b64_tr_b16 v[150:151], v218 offset:512
    v_mfma_f32_16x16x32_bf16 v[24:27], v[196:199], v[172:175], v[24:27]
    ds_read_b64_tr_b16 v[152:153], v217 offset:8192
    v_mfma_f32_16x16x32_bf16 v[52:55], v[196:199], v[176:179], v[52:55]
    ds_read_b64_tr_b16 v[154:155], v217 offset:8704
    v_mfma_f32_16x16x32_bf16 v[80:83], v[196:199], v[180:183], v[80:83]
    ds_read_b64_tr_b16 v[156:157], v218 offset:8192
    v_mfma_f32_16x16x32_bf16 v[108:111], v[196:199], v[184:187], v[108:111]
    ds_read_b64_tr_b16 v[158:159], v218 offset:8704
    v_mfma_f32_16x16x32_bf16 v[112:115], v[200:203], v[184:187], v[112:115]
    ds_read_b64_tr_b16 v[160:161], v217 offset:16384
    v_mfma_f32_16x16x32_bf16 v[84:87], v[200:203], v[180:183], v[84:87]
    ds_read_b64_tr_b16 v[162:163], v217 offset:16896
    v_mfma_f32_16x16x32_bf16 v[56:59], v[200:203], v[176:179], v[56:59]
    ds_read_b64_tr_b16 v[164:165], v218 offset:16384
    v_mfma_f32_16x16x32_bf16 v[28:31], v[200:203], v[172:175], v[28:31]
    ds_read_b64_tr_b16 v[166:167], v218 offset:16896
    v_mfma_f32_16x16x32_bf16 v[32:35], v[204:207], v[172:175], v[32:35]
    ds_read_b64_tr_b16 v[168:169], v219 offset:0
    v_mfma_f32_16x16x32_bf16 v[60:63], v[204:207], v[176:179], v[60:63]
    ds_read_b64_tr_b16 v[170:171], v219 offset:256
    v_mfma_f32_16x16x32_bf16 v[88:91], v[204:207], v[180:183], v[88:91]
    s_add_u32 s46, s46, 45056
    v_mfma_f32_16x16x32_bf16 v[116:119], v[204:207], v[184:187], v[116:119]
    s_cmp_eq_u32 s46, 135168
    v_mfma_f32_16x16x32_bf16 v[120:123], v[208:211], v[184:187], v[120:123]
    s_cselect_b32 s48, 4294877184, s49
    v_mfma_f32_16x16x32_bf16 v[92:95], v[208:211], v[180:183], v[92:95]
    s_cselect_b32 s46, 0, s46
    v_mfma_f32_16x16x32_bf16 v[64:67], v[208:211], v[176:179], v[64:67]
    s_sub_u32 s47, s47, 1
    v_mfma_f32_16x16x32_bf16 v[36:39], v[208:211], v[172:175], v[36:39]
    s_cmp_lg_u32 s47, 0
    v_mfma_f32_16x16x32_bf16 v[40:43], v[212:215], v[172:175], v[40:43]
    v_mfma_f32_16x16x32_bf16 v[68:71], v[212:215], v[176:179], v[68:71]
    v_mfma_f32_16x16x32_bf16 v[96:99], v[212:215], v[180:183], v[96:99]
    v_mfma_f32_16x16x32_bf16 v[124:127], v[212:215], v[184:187], v[124:127]
    s_cbranch_scc1 win_loop
    s_waitcnt lgkmcnt(0)
    v_mfma_f32_16x16x32_bf16 v[16:19], v[144:147], v[128:131], v[16:19]
    ds_read_b128 v[172:175], v216 offset:8192
    v_mfma_f32_16x16x32_bf16 v[44:47], v[144:147], v[132:135], v[44:47]
    ds_read_b64_tr_b16 v[188:189], v217 offset:4096
    v_mfma_f32_16x16x32_bf16 v[72:75], v[144:147], v[136:139], v[72:75]
    ds_read_b64_tr_b16 v[190:191], v217 offset:4608
    v_mfma_f32_16x16x32_bf16 v[100:103], v[144:147], v[140:143], v[100:103]
    ds_read_b128 v[176:179], v216 offset:8448
    v_mfma_f32_16x16x32_bf16 v[104:107], v[148:151], v[140:143], v[104:107]
    ds_read_b128 v[180:183], v216 offset:8704
    v_mfma_f32_16x16x32_bf16 v[76:79], v[148:151], v[136:139], v[76:79]
    ds_read_b128 v[184:187], v216 offset:8960
    v_mfma_f32_16x16x32_bf16 v[48:51], v[148:151], v[132:135], v[48:51]
    ds_read_b64_tr_b16 v[192:193], v218 offset:4096
    v_mfma_f32_16x16x32_bf16 v[20:23], v[148:151], v[128:131], v[20:23]
    ds_read_b64_tr_b16 v[194:195], v218 offset:4608
    v_mfma_f32_16x16x32_bf16 v[24:27], v[152:155], v[128:131], v[24:27]
    ds_read_b64_tr_b16 v[196:197], v217 offset:12288
    v_mfma_f32_16x16x32_bf16 v[52:55], v[152:155], v[132:135], v[52:55]
    ds_read_b64_tr_b16 v[198:199], v217 offset:12800
    v_mfma_f32_16x16x32_bf16 v[80:83], v[152:155], v[136:139], v[80:83]
    ds_read_b64_tr_b16 v[200:201], v218 offset:12288
    v_mfma_f32_16x16x32_bf16 v[108:111], v[152:155], v[140:143], v[108:111]
    ds_read_b64_tr_b16 v[202:203], v218 offset:12800
    v_mfma_f32_16x16x32_bf16 v[112:115], v[156:159], v[140:143], v[112:115]
    ds_read_b64_tr_b16 v[204:205], v217 offset:20480
    v_mfma_f32_16x16x32_bf16 v[84:87], v[156:159], v[136:139], v[84:87]
    ds_read_b64_tr_b16 v[206:207], v217 offset:20992
    v_mfma_f32_16x16x32_bf16 v[56:59], v[156:159], v[132:135], v[56:59]
    ds_read_b64_tr_b16 v[208:209], v218 offset:20480
    v_mfma_f32_16x16x32_bf16 v[28:31], v[156:159], v[128:131], v[28:31]
    ds_read_b64_tr_b16 v[210:211], v218 offset:20992
    v_mfma_f32_16x16x32_bf16 v[32:35], v[160:163], v[128:131], v[32:35]
    ds_read_b64_tr_b16 v[212:213], v219 offset:2048
    v_mfma_f32_16x16x32_bf16 v[60:63], v[160:163], v[132:135], v[60:63]
    ds_read_b64_tr_b16 v[214:215], v219 offset:2304
    v_mfma_f32_16x16x32_bf16 v[88:91], v[160:163], v[136:139], v[88:91]
    v_add_u32 v220, s48, v216
    v_mfma_f32_16x16x32_bf16 v[116:119], v[160:163], v[140:143], v[116:119]
    v_add_u32 v221, s48, v217
    v_mfma_f32_16x16x32_bf16 v[120:123], v[164:167], v[140:143], v[120:123]
    v_add_u32 v222, s48, v218
    v_mfma_f32_16x16x32_bf16 v[92:95], v[164:167], v[136:139], v[92:95]
    v_add_u32 v223, s48, v219
    v_mfma_f32_16x16x32_bf16 v[64:67], v[164:167], v[132:135], v[64:67]
    v_mfma_f32_16x16x32_bf16 v[36:39], v[164:167], v[128:131], v[36:39]
    v_mfma_f32_16x16x32_bf16 v[40:43], v[168:171], v[128:131], v[40:43]
    v_mfma_f32_16x16x32_bf16 v[68:71], v[168:171], v[132:135], v[68:71]
    v_mfma_f32_16x16x32_bf16 v[96:99], v[168:171], v[136:139], v[96:99]
    v_mfma_f32_16x16x32_bf16 v[124:127], v[168:171], v[140:143], v[124:127]
    s_waitcnt lgkmcnt(0)
    s_barrier
    v_mfma_f32_16x16x32_bf16 v[16:19], v[188:191], v[172:175], v[16:19]
    ds_read_b128 v[128:131], v220 offset:0
    v_mfma_f32_16x16x32_bf16 v[44:47], v[188:191], v[176:179], v[44:47]
    ds_read_b64_tr_b16 v[144:145], v221 offset:0
    v_mfma_f32_16x16x32_bf16 v[72:75], v[188:191], v[180:183], v[72:75]
    ds_read_b64_tr_b16 v[146:147], v221 offset:512
    v_mfma_f32_16x16x32_bf16 v[100:103], v[188:191], v[184:187], v[100:103]
    ds_read_b128 v[132:135], v220 offset:256
    v_mfma_f32_16x16x32_bf16 v[104:107], v[192:195], v[184:187], v[104:107]
    ds_read_b128 v[136:139], v220 offset:512
    v_mfma_f32_16x16x32_bf16 v[76:79], v[192:195], v[180:183], v[76:79]
    ds_read_b128 v[140:143], v220 offset:768
    v_mfma_f32_16x16x32_bf16 v[48:51], v[192:195], v[176:179], v[48:51]
    ds_read_b64_tr_b16 v[148:149], v222 offset:0
    v_mfma_f32_16x16x32_bf16 v[20:23], v[192:195], v[172:175], v[20:23]
    ds_read_b64_tr_b16 v[150:151], v222 offset:512
    v_mfma_f32_16x16x32_bf16 v[24:27], v[196:199], v[172:175], v[24:27]
    ds_read_b64_tr_b16 v[152:153], v221 offset:8192
    v_mfma_f32_16x16x32_bf16 v[52:55], v[196:199], v[176:179], v[52:55]
    ds_read_b64_tr_b16 v[154:155], v221 offset:8704
    v_mfma_f32_16x16x32_bf16 v[80:83], v[196:199], v[180:183], v[80:83]
    ds_read_b64_tr_b16 v[156:157], v222 offset:8192
    v_mfma_f32_16x16x32_bf16 v[108:111], v[196:199], v[184:187], v[108:111]
    ds_read_b64_tr_b16 v[158:159], v222 offset:8704
    v_mfma_f32_16x16x32_bf16 v[112:115], v[200:203], v[184:187], v[112:115]
    ds_read_b64_tr_b16 v[160:161], v221 offset:16384
    v_mfma_f32_16x16x32_bf16 v[84:87], v[200:203], v[180:183], v[84:87]
    ds_read_b64_tr_b16 v[162:163], v221 offset:16896
    v_mfma_f32_16x16x32_bf16 v[56:59], v[200:203], v[176:179], v[56:59]
    ds_read_b64_tr_b16 v[164:165], v222 offset:16384
    v_mfma_f32_16x16x32_bf16 v[28:31], v[200:203], v[172:175], v[28:31]
    ds_read_b64_tr_b16 v[166:167], v222 offset:16896
    v_mfma_f32_16x16x32_bf16 v[32:35], v[204:207], v[172:175], v[32:35]
    ds_read_b64_tr_b16 v[168:169], v223 offset:0
    v_mfma_f32_16x16x32_bf16 v[60:63], v[204:207], v[176:179], v[60:63]
    ds_read_b64_tr_b16 v[170:171], v223 offset:256
    v_mfma_f32_16x16x32_bf16 v[88:91], v[204:207], v[180:183], v[88:91]
    s_add_u32 s46, s46, 45056
    v_mfma_f32_16x16x32_bf16 v[116:119], v[204:207], v[184:187], v[116:119]
    s_cmp_eq_u32 s46, 135168
    v_mfma_f32_16x16x32_bf16 v[120:123], v[208:211], v[184:187], v[120:123]
    s_cselect_b32 s48, 4294877184, s49
    v_mfma_f32_16x16x32_bf16 v[92:95], v[208:211], v[180:183], v[92:95]
    s_cselect_b32 s46, 0, s46
    v_mfma_f32_16x16x32_bf16 v[64:67], v[208:211], v[176:179], v[64:67]
    v_mfma_f32_16x16x32_bf16 v[36:39], v[208:211], v[172:175], v[36:39]
    v_mfma_f32_16x16x32_bf16 v[40:43], v[212:215], v[172:175], v[40:43]
    v_mfma_f32_16x16x32_bf16 v[68:71], v[212:215], v[176:179], v[68:71]
    v_mfma_f32_16x16x32_bf16 v[96:99], v[212:215], v[180:183], v[96:99]
    v_mfma_f32_16x16x32_bf16 v[124:127], v[212:215], v[184:187], v[124:127]
    s_waitcnt lgkmcnt(0)
    v_mfma_f32_16x16x32_bf16 v[16:19], v[144:147], v[128:131], v[16:19]
    ds_read_b128 v[172:175], v220 offset:8192
    v_mfma_f32_16x16x32_bf16 v[44:47], v[144:147], v[132:135], v[44:47]
    ds_read_b64_tr_b16 v[188:189], v221 offset:4096
    v_mfma_f32_16x16x32_bf16 v[72:75], v[144:147], v[136:139], v[72:75]
    ds_read_b64_tr_b16 v[190:191], v221 offset:4608
    v_mfma_f32_16x16x32_bf16 v[100:103], v[144:147], v[140:143], v[100:103]
    ds_read_b128 v[176:179], v220 offset:8448
    v_mfma_f32_16x16x32_bf16 v[104:107], v[148:151], v[140:143], v[104:107]
    ds_read_b128 v[180:183], v220 offset:8704
    v_mfma_f32_16x16x32_bf16 v[76:79], v[148:151], v[136:139], v[76:79]
    ds_read_b128 v[184:187], v220 offset:8960
    v_mfma_f32_16x16x32_bf16 v[48:51], v[148:151], v[132:135], v[48:51]
    ds_read_b64_tr_b16 v[192:193], v222 offset:4096
    v_mfma_f32_16x16x32_bf16 v[20:23], v[148:151], v[128:131], v[20:23]
    ds_read_b64_tr_b16 v[194:195], v222 offset:4608
    v_mfma_f32_16x16x32_bf16 v[24:27], v[152:155], v[128:131], v[24:27]
    ds_read_b64_tr_b16 v[196:197], v221 offset:12288
    v_mfma_f32_16x16x32_bf16 v[52:55], v[152:155], v[132:135], v[52:55]
    ds_read_b64_tr_b16 v[198:199], v221 offset:12800
    v_mfma_f32_16x16x32_bf16 v[80:83], v[152:155], v[136:139], v[80:83]
    ds_read_b64_tr_b16 v[200:201], v222 offset:12288
    v_mfma_f32_16x16x32_bf16 v[108:111], v[152:155], v[140:143], v[108:111]
    ds_read_b64_tr_b16 v[202:203], v222 offset:12800
    v_mfma_f32_16x16x32_bf16 v[112:115], v[156:159], v[140:143], v[112:115]
    ds_read_b64_tr_b16 v[204:205], v221 offset:20480
    v_mfma_f32_16x16x32_bf16 v[84:87], v[156:159], v[136:139], v[84:87]
    ds_read_b64_tr_b16 v[206:207], v221 offset:20992
    v_mfma_f32_16x16x32_bf16 v[56:59], v[156:159], v[132:135], v[56:59]
    ds_read_b64_tr_b16 v[208:209], v222 offset:20480
    v_mfma_f32_16x16x32_bf16 v[28:31], v[156:159], v[128:131], v[28:31]
    ds_read_b64_tr_b16 v[210:211], v222 offset:20992
    v_mfma_f32_16x16x32_bf16 v[32:35], v[160:163], v[128:131], v[32:35]
    ds_read_b64_tr_b16 v[212:213], v223 offset:2048
    v_mfma_f32_16x16x32_bf16 v[60:63], v[160:163], v[132:135], v[60:63]
    ds_read_b64_tr_b16 v[214:215], v223 offset:2304
    v_mfma_f32_16x16x32_bf16 v[88:91], v[160:163], v[136:139], v[88:91]
    v_mfma_f32_16x16x32_bf16 v[116:119], v[160:163], v[140:143], v[116:119]
    v_mfma_f32_16x16x32_bf16 v[120:123], v[164:167], v[140:143], v[120:123]
    v_mfma_f32_16x16x32_bf16 v[92:95], v[164:167], v[136:139], v[92:95]
    v_mfma_f32_16x16x32_bf16 v[64:67], v[164:167], v[132:135], v[64:67]
    v_mfma_f32_16x16x32_bf16 v[36:39], v[164:167], v[128:131], v[36:39]
    v_mfma_f32_16x16x32_bf16 v[40:43], v[168:171], v[128:131], v[40:43]
    v_mfma_f32_16x16x32_bf16 v[68:71], v[168:171], v[132:135], v[68:71]
    v_mfma_f32_16x16x32_bf16 v[96:99], v[168:171], v[136:139], v[96:99]
    v_mfma_f32_16x16x32_bf16 v[124:127], v[168:171], v[140:143], v[124:127]
    s_waitcnt lgkmcnt(0)
    v_mfma_f32_16x16x32_bf16 v[16:19], v[188:191], v[172:175], v[16:19]
    v_mfma_f32_16x16x32_bf16 v[44:47], v[188:191], v[176:179], v[44:47]
    v_mfma_f32_16x16x32_bf16 v[72:75], v[188:191], v[180:183], v[72:75]
    v_mfma_f32_16x16x32_bf16 v[100:103], v[188:191], v[184:187], v[100:103]
    v_mfma_f32_16x16x32_bf16 v[104:107], v[192:195], v[184:187], v[104:107]
    v_mfma_f32_16x16x32_bf16 v[76:79], v[192:195], v[180:183], v[76:79]
    v_mfma_f32_16x16x32_bf16 v[48:51], v[192:195], v[176:179], v[48:51]
    v_mfma_f32_16x16x32_bf16 v[20:23], v[192:195], v[172:175], v[20:23]
    v_mfma_f32_16x16x32_bf16 v[24:27], v[196:199], v[172:175], v[24:27]
    v_mfma_f32_16x16x32_bf16 v[52:55], v[196:199], v[176:179], v[52:55]
    v_mfma_f32_16x16x32_bf16 v[80:83], v[196:199], v[180:183], v[80:83]
    v_mfma_f32_16x16x32_bf16 v[108:111], v[196:199], v[184:187], v[108:111]
    v_mfma_f32_16x16x32_bf16 v[112:115], v[200:203], v[184:187], v[112:115]
    v_mfma_f32_16x16x32_bf16 v[84:87], v[200:203], v[180:183], v[84:87]
    v_mfma_f32_16x16x32_bf16 v[56:59], v[200:203], v[176:179], v[56:59]
    v_mfma_f32_16x16x32_bf16 v[28:31], v[200:203], v[172:175], v[28:31]
    v_mfma_f32_16x16x32_bf16 v[32:35], v[204:207], v[172:175], v[32:35]
    v_mfma_f32_16x16x32_bf16 v[60:63], v[204:207], v[176:179], v[60:63]
    v_mfma_f32_16x16x32_bf16 v[88:91], v[204:207], v[180:183], v[88:91]
    v_mfma_f32_16x16x32_bf16 v[116:119], v[204:207], v[184:187], v[116:119]
    v_mfma_f32_16x16x32_bf16 v[120:123], v[208:211], v[184:187], v[120:123]
    v_mfma_f32_16x16x32_bf16 v[92:95], v[208:211], v[180:183], v[92:95]
    v_mfma_f32_16x16x32_bf16 v[64:67], v[208:211], v[176:179], v[64:67]
    v_mfma_f32_16x16x32_bf16 v[36:39], v[208:211], v[172:175], v[36:39]
    v_mfma_f32_16x16x32_bf16 v[40:43], v[212:215], v[172:175], v[40:43]
    v_mfma_f32_16x16x32_bf16 v[68:71], v[212:215], v[176:179], v[68:71]
    v_mfma_f32_16x16x32_bf16 v[96:99], v[212:215], v[180:183], v[96:99]
    v_mfma_f32_16x16x32_bf16 v[124:127], v[212:215], v[184:187], v[124:127]
    s_add_u32 s24, s4, 34603008
    s_addc_u32 s25, s5, 0
    s_mov_b32 s26, 7340032
    s_mov_b32 s27, 0x20000
    s_add_u32 s28, s4, 41943040
    s_addc_u32 s29, s5, 0
    s_mov_b32 s30, 7340032
    s_mov_b32 s31, 0x20000
    s_lshr_b32 s55, s41, 1
    s_and_b32 s56, s55, 1
    s_lshl_b32 s57, s56, 1
    s_lshl_b32 s58, s54, 1
    s_add_u32 s57, s57, s58
    s_add_u32 s64, s57, 0
    s_add_u32 s65, s57, 1
    s_add_u32 s66, s57, 4
    s_add_u32 s67, s57, 5
    s_add_u32 s68, s57, 8
    s_add_u32 s69, s57, 9
    s_cmp_eq_u32 s56, 1
    s_cselect_b32 s57, 0, 12
    s_add_u32 s70, s54, s57
    s_lshl_b32 s57, s40, 2
    s_lshr_b32 s58, s53, 5
    s_add_u32 s57, s57, s58
    s_mul_i32 s57, s57, 112
    s_mul_i32 s58, s55, 14
    s_add_u32 s57, s57, s58
    s_lshl_b32 s58, s55, 6
    s_lshl_b32 s59, s40, 1
    s_add_u32 s58, s58, s59
    s_lshr_b32 s59, s53, 6
    s_add_u32 s58, s58, s59
    s_mul_i32 s58, s58, 56
    v_mov_b32 v12, 0xc0135761
    v_mov_b32 v13, 0xc0135761
    s_mov_b32 s72, 0xbdd2d3e8
    s_mov_b32 s73, 0xbdd2d3e8
    v_lshlrev_b32 v5, 4, v1
    v_and_b32 v3, 15, v1
    v_lshrrev_b32 v6, 5, v1
    v_bfe_u32 v7, v1, 4, 1
    v_lshl_add_u32 v6, v7, 1, v6
    v_lshl_add_u32 v6, v6, 4, v3
    s_lshl_b32 s59, s54, 7
    s_add_u32 s59, s59, s53
    s_lshl_b32 s59, s59, 3
    s_add_u32 s59, s59, 159744
    v_lshl_add_u32 v6, v6, 3, s59
    s_lshl_b32 s59, s53, 3
    s_add_u32 s59, s59, 161792
    v_lshl_add_u32 v9, v3, 3, s59
    v_lshrrev_b32 v8, 4, v1
    v_mul_u32_u24 v7, 1792, v8
    v_lshl_add_u32 v7, v3, 4, v7
    s_mul_i32 s59, s54, 5120
    s_mul_i32 s60, s53, 480
    s_add_u32 s59, s59, s60
    s_add_u32 s59, s59, 16384
    v_mul_u32_u24 v10, 40, v3
    v_lshl_add_u32 v10, v8, 3, v10
    v_add_u32 v10, s59, v10
    v_bfe_u32 v11, v1, 2, 2
    v_lshl_add_u32 v11, v8, 3, v11
    v_mul_u32_u24 v11, 40, v11
    v_and_b32 v8, 3, v1
    v_lshl_add_u32 v11, v8, 3, v11
    v_add_u32 v11, s59, v11
    s_and_b32 s59, s41, 1
    s_cmp_eq_u32 s59, 1
    s_cbranch_scc1 win_epiB
    s_add_u32 s64, s64, s57
    s_lshl_b32 s64, s64, 10
    s_add_u32 s65, s65, s57
    s_lshl_b32 s65, s65, 10
    s_add_u32 s66, s66, s57
    s_lshl_b32 s66, s66, 10
    s_add_u32 s67, s67, s57
    s_lshl_b32 s67, s67, 10
    s_cmp_ge_u32 s68, 7
    s_cselect_b32 s59, 1785, 0
    s_add_u32 s68, s68, s59
    s_add_u32 s68, s68, s58
    s_lshl_b32 s68, s68, 8
    s_cmp_ge_u32 s69, 7
    s_cselect_b32 s59, 1785, 0
    s_add_u32 s69, s69, s59
    s_add_u32 s69, s69, s58
    s_lshl_b32 s69, s69, 8
    s_cmp_ge_u32 s70, 7
    s_cselect_b32 s59, 1785, 0
    s_add_u32 s70, s70, s59
    s_add_u32 s70, s70, s58
    s_lshl_b32 s70, s70, 8
    v_pk_mul_f32 v[128:129], v[32:33], v[32:33]
    v_pk_mul_f32 v[130:131], v[34:35], v[34:35]
    v_pk_mul_f32 v[132:133], v[36:37], v[36:37]
    v_pk_mul_f32 v[134:135], v[38:39], v[38:39]
    v_pk_mul_f32 v[136:137], v[40:41], v[40:41]
    v_pk_mul_f32 v[138:139], v[42:43], v[42:43]
    v_pk_fma_f32 v[128:129], v[128:129], s[72:73], v[12:13]
    v_pk_fma_f32 v[130:131], v[130:131], s[72:73], v[12:13]
    v_pk_fma_f32 v[132:133], v[132:133], s[72:73], v[12:13]
    v_pk_fma_f32 v[134:135], v[134:135], s[72:73], v[12:13]
    v_pk_fma_f32 v[136:137], v[136:137], s[72:73], v[12:13]
    v_pk_fma_f32 v[138:139], v[138:139], s[72:73], v[12:13]
    v_pk_mul_f32 v[128:129], v[128:129], v[32:33]
    v_pk_mul_f32 v[130:131], v[130:131], v[34:35]
    v_pk_mul_f32 v[132:133], v[132:133], v[36:37]
    v_pk_mul_f32 v[134:135], v[134:135], v[38:39]
    v_pk_mul_f32 v[136:137], v[136:137], v[40:41]
    v_pk_mul_f32 v[138:139], v[138:139], v[42:43]
    v_exp_f32 v128, v128
    v_exp_f32 v129, v129
    v_exp_f32 v130, v130
    v_exp_f32 v131, v131
    v_exp_f32 v132, v132
    v_exp_f32 v133, v133
    v_exp_f32 v134, v134
    v_exp_f32 v135, v135
    v_exp_f32 v136, v136
    v_exp_f32 v137, v137
    v_exp_f32 v138, v138
    v_exp_f32 v139, v139
    v_pk_add_f32 v[128:129], v[128:129], 1.0 op_sel_hi:[1,0]
    v_pk_add_f32 v[130:131], v[130:131], 1.0 op_sel_hi:[1,0]
    v_pk_add_f32 v[132:133], v[132:133], 1.0 op_sel_hi:[1,0]
    v_pk_add_f32 v[134:135], v[134:135], 1.0 op_sel_hi:[1,0]
    v_pk_add_f32 v[136:137], v[136:137], 1.0 op_sel_hi:[1,0]
    v_pk_add_f32 v[138:139], v[138:139], 1.0 op_sel_hi:[1,0]
    v_rcp_f32 v128, v128
    v_rcp_f32 v129, v129
    v_rcp_f32 v130, v130
    v_rcp_f32 v131, v131
    v_rcp_f32 v132, v132
    v_rcp_f32 v133, v133
    v_rcp_f32 v134, v134
    v_rcp_f32 v135, v135
    v_rcp_f32 v136, v136
    v_rcp_f32 v137, v137
    v_rcp_f32 v138, v138
    v_rcp_f32 v139, v139
    v_pk_mul_f32 v[32:33], v[128:129], v[32:33]
    v_pk_mul_f32 v[34:35], v[130:131], v[34:35]
    v_pk_mul_f32 v[36:37], v[132:133], v[36:37]
    v_pk_mul_f32 v[38:39], v[134:135], v[38:39]
    v_pk_mul_f32 v[40:41], v[136:137], v[40:41]
    v_pk_mul_f32 v[42:43], v[138:139], v[42:43]
    v_pk_add_f32 v[168:169], v[32:33], v[34:35]
    v_pk_mul_f32 v[170:171], v[32:33], v[32:33]
    v_pk_fma_f32 v[170:171], v[34:35], v[34:35], v[170:171]
    v_pk_add_f32 v[168:169], v[168:169], v[36:37]
    v_pk_fma_f32 v[170:171], v[36:37], v[36:37], v[170:171]
    v_pk_add_f32 v[168:169], v[168:169], v[38:39]
    v_pk_fma_f32 v[170:171], v[38:39], v[38:39], v[170:171]
    v_pk_add_f32 v[168:169], v[168:169], v[40:41]
    v_pk_fma_f32 v[170:171], v[40:41], v[40:41], v[170:171]
    v_pk_add_f32 v[168:169], v[168:169], v[42:43]
    v_pk_fma_f32 v[170:171], v[42:43], v[42:43], v[170:171]
    v_add_f32 v160, v168, v169
    v_add_f32 v161, v170, v171
    v_pk_mul_f32 v[144:145], v[60:61], v[60:61]
    v_pk_mul_f32 v[146:147], v[62:63], v[62:63]
    v_pk_mul_f32 v[148:149], v[64:65], v[64:65]
    v_pk_mul_f32 v[150:151], v[66:67], v[66:67]
    v_pk_mul_f32 v[152:153], v[68:69], v[68:69]
    v_pk_mul_f32 v[154:155], v[70:71], v[70:71]
    v_pk_fma_f32 v[144:145], v[144:145], s[72:73], v[12:13]
    v_pk_fma_f32 v[146:147], v[146:147], s[72:73], v[12:13]
    v_pk_fma_f32 v[148:149], v[148:149], s[72:73], v[12:13]
    v_pk_fma_f32 v[150:151], v[150:151], s[72:73], v[12:13]
    v_pk_fma_f32 v[152:153], v[152:153], s[72:73], v[12:13]
    v_pk_fma_f32 v[154:155], v[154:155], s[72:73], v[12:13]
    v_pk_mul_f32 v[144:145], v[144:145], v[60:61]
    v_pk_mul_f32 v[146:147], v[146:147], v[62:63]
    v_pk_mul_f32 v[148:149], v[148:149], v[64:65]
    v_pk_mul_f32 v[150:151], v[150:151], v[66:67]
    v_pk_mul_f32 v[152:153], v[152:153], v[68:69]
    v_pk_mul_f32 v[154:155], v[154:155], v[70:71]
    v_exp_f32 v144, v144
    v_exp_f32 v145, v145
    v_exp_f32 v146, v146
    v_exp_f32 v147, v147
    v_exp_f32 v148, v148
    v_exp_f32 v149, v149
    v_exp_f32 v150, v150
    v_exp_f32 v151, v151
    v_exp_f32 v152, v152
    v_exp_f32 v153, v153
    v_exp_f32 v154, v154
    v_exp_f32 v155, v155
    v_pk_add_f32 v[144:145], v[144:145], 1.0 op_sel_hi:[1,0]
    v_pk_add_f32 v[146:147], v[146:147], 1.0 op_sel_hi:[1,0]
    v_pk_add_f32 v[148:149], v[148:149], 1.0 op_sel_hi:[1,0]
    v_pk_add_f32 v[150:151], v[150:151], 1.0 op_sel_hi:[1,0]
    v_pk_add_f32 v[152:153], v[152:153], 1.0 op_sel_hi:[1,0]
    v_pk_add_f32 v[154:155], v[154:155], 1.0 op_sel_hi:[1,0]
    v_rcp_f32 v144, v144
    v_rcp_f32 v145, v145
    v_rcp_f32 v146, v146
    v_rcp_f32 v147, v147
    v_rcp_f32 v148, v148
    v_rcp_f32 v149, v149
    v_rcp_f32 v150, v150
    v_rcp_f32 v151, v151
    v_rcp_f32 v152, v152
    v_rcp_f32 v153, v153
    v_rcp_f32 v154, v154
    v_rcp_f32 v155, v155
    v_pk_mul_f32 v[60:61], v[144:145], v[60:61]
    v_pk_mul_f32 v[62:63], v[146:147], v[62:63]
    v_pk_mul_f32 v[64:65], v[148:149], v[64:65]
    v_pk_mul_f32 v[66:67], v[150:151], v[66:67]
    v_pk_mul_f32 v[68:69], v[152:153], v[68:69]
    v_pk_mul_f32 v[70:71], v[154:155], v[70:71]
    v_pk_add_f32 v[168:169], v[60:61], v[62:63]
    v_pk_mul_f32 v[170:171], v[60:61], v[60:61]
    v_pk_fma_f32 v[170:171], v[62:63], v[62:63], v[170:171]
    v_pk_add_f32 v[168:169], v[168:169], v[64:65]
    v_pk_fma_f32 v[170:171], v[64:65], v[64:65], v[170:171]
    v_pk_add_f32 v[168:169], v[168:169], v[66:67]
    v_pk_fma_f32 v[170:171], v[66:67], v[66:67], v[170:171]
    v_pk_add_f32 v[168:169], v[168:169], v[68:69]
    v_pk_fma_f32 v[170:171], v[68:69], v[68:69], v[170:171]
    v_pk_add_f32 v[168:169], v[168:169], v[70:71]
    v_pk_fma_f32 v[170:171], v[70:71], v[70:71], v[170:171]
    v_add_f32 v162, v168, v169
    v_add_f32 v163, v170, v171
    v_pk_mul_f32 v[128:129], v[88:89], v[88:89]
    v_pk_mul_f32 v[130:131], v[90:91], v[90:91]
    v_pk_mul_f32 v[132:133], v[92:93], v[92:93]
    v_pk_mul_f32 v[134:135], v[94:95], v[94:95]
    v_pk_mul_f32 v[136:137], v[96:97], v[96:97]
    v_pk_mul_f32 v[138:139], v[98:99], v[98:99]
    v_pk_fma_f32 v[128:129], v[128:129], s[72:73], v[12:13]
    v_pk_fma_f32 v[130:131], v[130:131], s[72:73], v[12:13]
    v_pk_fma_f32 v[132:133], v[132:133], s[72:73], v[12:13]
    v_pk_fma_f32 v[134:135], v[134:135], s[72:73], v[12:13]
    v_pk_fma_f32 v[136:137], v[136:137], s[72:73], v[12:13]
    v_pk_fma_f32 v[138:139], v[138:139], s[72:73], v[12:13]
    v_pk_mul_f32 v[128:129], v[128:129], v[88:89]
    v_pk_mul_f32 v[130:131], v[130:131], v[90:91]
    v_pk_mul_f32 v[132:133], v[132:133], v[92:93]
    v_pk_mul_f32 v[134:135], v[134:135], v[94:95]
    v_pk_mul_f32 v[136:137], v[136:137], v[96:97]
    v_pk_mul_f32 v[138:139], v[138:139], v[98:99]
    v_exp_f32 v128, v128
    v_exp_f32 v129, v129
    v_exp_f32 v130, v130
    v_exp_f32 v131, v131
    v_exp_f32 v132, v132
    v_exp_f32 v133, v133
    v_exp_f32 v134, v134
    v_exp_f32 v135, v135
    v_exp_f32 v136, v136
    v_exp_f32 v137, v137
    v_exp_f32 v138, v138
    v_exp_f32 v139, v139
    v_pk_add_f32 v[128:129], v[128:129], 1.0 op_sel_hi:[1,0]
    v_pk_add_f32 v[130:131], v[130:131], 1.0 op_sel_hi:[1,0]
    v_pk_add_f32 v[132:133], v[132:133], 1.0 op_sel_hi:[1,0]
    v_pk_add_f32 v[134:135], v[134:135], 1.0 op_sel_hi:[1,0]
    v_pk_add_f32 v[136:137], v[136:137], 1.0 op_sel_hi:[1,0]
    v_pk_add_f32 v[138:139], v[138:139], 1.0 op_sel_hi:[1,0]
    v_rcp_f32 v128, v128
    v_rcp_f32 v129, v129
    v_rcp_f32 v130, v130
    v_rcp_f32 v131, v131
    v_rcp_f32 v132, v132
    v_rcp_f32 v133, v133
    v_rcp_f32 v134, v134
    v_rcp_f32 v135, v135
    v_rcp_f32 v136, v136
    v_rcp_f32 v137, v137
    v_rcp_f32 v138, v138
    v_rcp_f32 v139, v139
    v_pk_mul_f32 v[88:89], v[128:129], v[88:89]
    v_pk_mul_f32 v[90:91], v[130:131], v[90:91]
    v_pk_mul_f32 v[92:93], v[132:133], v[92:93]
    v_pk_mul_f32 v[94:95], v[134:135], v[94:95]
    v_pk_mul_f32 v[96:97], v[136:137], v[96:97]
    v_pk_mul_f32 v[98:99], v[138:139], v[98:99]
    v_pk_add_f32 v[168:169], v[88:89], v[90:91]
    v_pk_mul_f32 v[170:171], v[88:89], v[88:89]
    v_pk_fma_f32 v[170:171], v[90:91], v[90:91], v[170:171]
    v_pk_add_f32 v[168:169], v[168:169], v[92:93]
    v_pk_fma_f32 v[170:171], v[92:93], v[92:93], v[170:171]
    v_pk_add_f32 v[168:169], v[168:169], v[94:95]
    v_pk_fma_f32 v[170:171], v[94:95], v[94:95], v[170:171]
    v_pk_add_f32 v[168:169], v[168:169], v[96:97]
    v_pk_fma_f32 v[170:171], v[96:97], v[96:97], v[170:171]
    v_pk_add_f32 v[168:169], v[168:169], v[98:99]
    v_pk_fma_f32 v[170:171], v[98:99], v[98:99], v[170:171]
    v_add_f32 v164, v168, v169
    v_add_f32 v165, v170, v171
    v_pk_mul_f32 v[144:145], v[116:117], v[116:117]
    v_pk_mul_f32 v[146:147], v[118:119], v[118:119]
    v_pk_mul_f32 v[148:149], v[120:121], v[120:121]
    v_pk_mul_f32 v[150:151], v[122:123], v[122:123]
    v_pk_mul_f32 v[152:153], v[124:125], v[124:125]
    v_pk_mul_f32 v[154:155], v[126:127], v[126:127]
    v_pk_fma_f32 v[144:145], v[144:145], s[72:73], v[12:13]
    v_pk_fma_f32 v[146:147], v[146:147], s[72:73], v[12:13]
    v_pk_fma_f32 v[148:149], v[148:149], s[72:73], v[12:13]
    v_pk_fma_f32 v[150:151], v[150:151], s[72:73], v[12:13]
    v_pk_fma_f32 v[152:153], v[152:153], s[72:73], v[12:13]
    v_pk_fma_f32 v[154:155], v[154:155], s[72:73], v[12:13]
    v_pk_mul_f32 v[144:145], v[144:145], v[116:117]
    v_pk_mul_f32 v[146:147], v[146:147], v[118:119]
    v_pk_mul_f32 v[148:149], v[148:149], v[120:121]
    v_pk_mul_f32 v[150:151], v[150:151], v[122:123]
    v_pk_mul_f32 v[152:153], v[152:153], v[124:125]
    v_pk_mul_f32 v[154:155], v[154:155], v[126:127]
    v_exp_f32 v144, v144
    v_exp_f32 v145, v145
    v_exp_f32 v146, v146
    v_exp_f32 v147, v147
    v_exp_f32 v148, v148
    v_exp_f32 v149, v149
    v_exp_f32 v150, v150
    v_exp_f32 v151, v151
    v_exp_f32 v152, v152
    v_exp_f32 v153, v153
    v_exp_f32 v154, v154
    v_exp_f32 v155, v155
    v_pk_add_f32 v[144:145], v[144:145], 1.0 op_sel_hi:[1,0]
    v_pk_add_f32 v[146:147], v[146:147], 1.0 op_sel_hi:[1,0]
    v_pk_add_f32 v[148:149], v[148:149], 1.0 op_sel_hi:[1,0]
    v_pk_add_f32 v[150:151], v[150:151], 1.0 op_sel_hi:[1,0]
    v_pk_add_f32 v[152:153], v[152:153], 1.0 op_sel_hi:[1,0]
    v_pk_add_f32 v[154:155], v[154:155], 1.0 op_sel_hi:[1,0]
    v_rcp_f32 v144, v144
    v_rcp_f32 v145, v145
    v_rcp_f32 v146, v146
    v_rcp_f32 v147, v147
    v_rcp_f32 v148, v148
    v_rcp_f32 v149, v149
    v_rcp_f32 v150, v150
    v_rcp_f32 v151, v151
    v_rcp_f32 v152, v152
    v_rcp_f32 v153, v153
    v_rcp_f32 v154, v154
    v_rcp_f32 v155, v155
    v_pk_mul_f32 v[116:117], v[144:145], v[116:117]
    v_pk_mul_f32 v[118:119], v[146:147], v[118:119]
    v_pk_mul_f32 v[120:121], v[148:149], v[120:121]
    v_pk_mul_f32 v[122:123], v[150:151], v[122:123]
    v_pk_mul_f32 v[124:125], v[152:153], v[124:125]
    v_pk_mul_f32 v[126:127], v[154:155], v[126:127]
    v_pk_add_f32 v[168:169], v[116:117], v[118:119]
    v_pk_mul_f32 v[170:171], v[116:117], v[116:117]
    v_pk_fma_f32 v[170:171], v[118:119], v[118:119], v[170:171]
    v_pk_add_f32 v[168:169], v[168:169], v[120:121]
    v_pk_fma_f32 v[170:171], v[120:121], v[120:121], v[170:171]
    v_pk_add_f32 v[168:169], v[168:169], v[122:123]
    v_pk_fma_f32 v[170:171], v[122:123], v[122:123], v[170:171]
    v_pk_add_f32 v[168:169], v[168:169], v[124:125]
    v_pk_fma_f32 v[170:171], v[124:125], v[124:125], v[170:171]
    v_pk_add_f32 v[168:169], v[168:169], v[126:127]
    v_pk_fma_f32 v[170:171], v[126:127], v[126:127], v[170:171]
    v_add_f32 v166, v168, v169
    v_add_f32 v167, v170, v171
    v_permlane16_swap_b32 v160, v161
    v_permlane16_swap_b32 v162, v163
    v_permlane16_swap_b32 v164, v165
    v_permlane16_swap_b32 v166, v167
    v_add_f32 v160, v160, v161
    v_add_f32 v162, v162, v163
    v_add_f32 v164, v164, v165
    v_add_f32 v166, v166, v167
    v_permlane32_swap_b32 v160, v162
    s_nop 0
    v_permlane32_swap_b32 v164, v166
    v_add_f32 v160, v160, v162
    v_add_f32 v161, v164, v166
    s_nop 1
    v_permlane16_swap_b32 v160, v161
    ds_write_b64 v6, v[160:161]
    s_waitcnt lgkmcnt(0)
    s_barrier
    v_pk_mul_f32 v[128:129], v[16:17], v[16:17]
    v_pk_mul_f32 v[130:131], v[18:19], v[18:19]
    v_pk_mul_f32 v[132:133], v[44:45], v[44:45]
    v_pk_mul_f32 v[134:135], v[46:47], v[46:47]
    v_pk_fma_f32 v[128:129], v[128:129], s[72:73], v[12:13]
    v_pk_fma_f32 v[130:131], v[130:131], s[72:73], v[12:13]
    v_pk_fma_f32 v[132:133], v[132:133], s[72:73], v[12:13]
    v_pk_fma_f32 v[134:135], v[134:135], s[72:73], v[12:13]
    v_pk_mul_f32 v[128:129], v[128:129], v[16:17]
    v_pk_mul_f32 v[130:131], v[130:131], v[18:19]
    v_pk_mul_f32 v[132:133], v[132:133], v[44:45]
    v_pk_mul_f32 v[134:135], v[134:135], v[46:47]
    v_exp_f32 v128, v128
    v_exp_f32 v129, v129
    v_exp_f32 v130, v130
    v_exp_f32 v131, v131
    v_exp_f32 v132, v132
    v_exp_f32 v133, v133
    v_exp_f32 v134, v134
    v_exp_f32 v135, v135
    v_pk_add_f32 v[128:129], v[128:129], 1.0 op_sel_hi:[1,0]
    v_pk_add_f32 v[130:131], v[130:131], 1.0 op_sel_hi:[1,0]
    v_pk_add_f32 v[132:133], v[132:133], 1.0 op_sel_hi:[1,0]
    v_pk_add_f32 v[134:135], v[134:135], 1.0 op_sel_hi:[1,0]
    v_rcp_f32 v128, v128
    v_rcp_f32 v129, v129
    v_rcp_f32 v130, v130
    v_rcp_f32 v131, v131
    v_rcp_f32 v132, v132
    v_rcp_f32 v133, v133
    v_rcp_f32 v134, v134
    v_rcp_f32 v135, v135
    v_pk_mul_f32 v[16:17], v[128:129], v[16:17]
    v_pk_mul_f32 v[18:19], v[130:131], v[18:19]
    v_pk_mul_f32 v[44:45], v[132:133], v[44:45]
    v_pk_mul_f32 v[46:47], v[134:135], v[46:47]
    v_cvt_pk_bf16_f32 v176, v16, v17
    v_cvt_pk_bf16_f32 v177, v18, v19
    v_cvt_pk_bf16_f32 v178, v44, v45
    v_cvt_pk_bf16_f32 v179, v46, v47
    buffer_store_dwordx4 v[176:179], v5, s[24:27], s64 offen sc1
    v_pk_mul_f32 v[136:137], v[20:21], v[20:21]
    v_pk_mul_f32 v[138:139], v[22:23], v[22:23]
    v_pk_mul_f32 v[140:141], v[48:49], v[48:49]
    v_pk_mul_f32 v[142:143], v[50:51], v[50:51]
    v_pk_fma_f32 v[136:137], v[136:137], s[72:73], v[12:13]
    v_pk_fma_f32 v[138:139], v[138:139], s[72:73], v[12:13]
    v_pk_fma_f32 v[140:141], v[140:141], s[72:73], v[12:13]
    v_pk_fma_f32 v[142:143], v[142:143], s[72:73], v[12:13]
    v_pk_mul_f32 v[136:137], v[136:137], v[20:21]
    v_pk_mul_f32 v[138:139], v[138:139], v[22:23]
    v_pk_mul_f32 v[140:141], v[140:141], v[48:49]
    v_pk_mul_f32 v[142:143], v[142:143], v[50:51]
    v_exp_f32 v136, v136
    v_exp_f32 v137, v137
    v_exp_f32 v138, v138
    v_exp_f32 v139, v139
    v_exp_f32 v140, v140
    v_exp_f32 v141, v141
    v_exp_f32 v142, v142
    v_exp_f32 v143, v143
    v_pk_add_f32 v[136:137], v[136:137], 1.0 op_sel_hi:[1,0]
    v_pk_add_f32 v[138:139], v[138:139], 1.0 op_sel_hi:[1,0]
    v_pk_add_f32 v[140:141], v[140:141], 1.0 op_sel_hi:[1,0]
    v_pk_add_f32 v[142:143], v[142:143], 1.0 op_sel_hi:[1,0]
    v_rcp_f32 v136, v136
    v_rcp_f32 v137, v137
    v_rcp_f32 v138, v138
    v_rcp_f32 v139, v139
    v_rcp_f32 v140, v140
    v_rcp_f32 v141, v141
    v_rcp_f32 v142, v142
    v_rcp_f32 v143, v143
    v_pk_mul_f32 v[20:21], v[136:137], v[20:21]
    v_pk_mul_f32 v[22:23], v[138:139], v[22:23]
    v_pk_mul_f32 v[48:49], v[140:141], v[48:49]
    v_pk_mul_f32 v[50:51], v[142:143], v[50:51]
    v_cvt_pk_bf16_f32 v180, v20, v21
    v_cvt_pk_bf16_f32 v181, v22, v23
    v_cvt_pk_bf16_f32 v182, v48, v49
    v_cvt_pk_bf16_f32 v183, v50, v51
    buffer_store_dwordx4 v[180:183], v5, s[24:27], s65 offen sc1
    v_pk_mul_f32 v[144:145], v[24:25], v[24:25]
    v_pk_mul_f32 v[146:147], v[26:27], v[26:27]
    v_pk_mul_f32 v[148:149], v[52:53], v[52:53]
    v_pk_mul_f32 v[150:151], v[54:55], v[54:55]
    v_pk_fma_f32 v[144:145], v[144:145], s[72:73], v[12:13]
    v_pk_fma_f32 v[146:147], v[146:147], s[72:73], v[12:13]
    v_pk_fma_f32 v[148:149], v[148:149], s[72:73], v[12:13]
    v_pk_fma_f32 v[150:151], v[150:151], s[72:73], v[12:13]
    v_pk_mul_f32 v[144:145], v[144:145], v[24:25]
    v_pk_mul_f32 v[146:147], v[146:147], v[26:27]
    v_pk_mul_f32 v[148:149], v[148:149], v[52:53]
    v_pk_mul_f32 v[150:151], v[150:151], v[54:55]
    v_exp_f32 v144, v144
    v_exp_f32 v145, v145
    v_exp_f32 v146, v146
    v_exp_f32 v147, v147
    v_exp_f32 v148, v148
    v_exp_f32 v149, v149
    v_exp_f32 v150, v150
    v_exp_f32 v151, v151
    v_pk_add_f32 v[144:145], v[144:145], 1.0 op_sel_hi:[1,0]
    v_pk_add_f32 v[146:147], v[146:147], 1.0 op_sel_hi:[1,0]
    v_pk_add_f32 v[148:149], v[148:149], 1.0 op_sel_hi:[1,0]
    v_pk_add_f32 v[150:151], v[150:151], 1.0 op_sel_hi:[1,0]
    v_rcp_f32 v144, v144
    v_rcp_f32 v145, v145
    v_rcp_f32 v146, v146
    v_rcp_f32 v147, v147
    v_rcp_f32 v148, v148
    v_rcp_f32 v149, v149
    v_rcp_f32 v150, v150
    v_rcp_f32 v151, v151
    v_pk_mul_f32 v[24:25], v[144:145], v[24:25]
    v_pk_mul_f32 v[26:27], v[146:147], v[26:27]
    v_pk_mul_f32 v[52:53], v[148:149], v[52:53]
    v_pk_mul_f32 v[54:55], v[150:151], v[54:55]
    v_cvt_pk_bf16_f32 v184, v24, v25
    v_cvt_pk_bf16_f32 v185, v26, v27
    v_cvt_pk_bf16_f32 v186, v52, v53
    v_cvt_pk_bf16_f32 v187, v54, v55
    buffer_store_dwordx4 v[184:187], v5, s[24:27], s66 offen sc1
    v_pk_mul_f32 v[152:153], v[28:29], v[28:29]
    v_pk_mul_f32 v[154:155], v[30:31], v[30:31]
    v_pk_mul_f32 v[156:157], v[56:57], v[56:57]
    v_pk_mul_f32 v[158:159], v[58:59], v[58:59]
    v_pk_fma_f32 v[152:153], v[152:153], s[72:73], v[12:13]
    v_pk_fma_f32 v[154:155], v[154:155], s[72:73], v[12:13]
    v_pk_fma_f32 v[156:157], v[156:157], s[72:73], v[12:13]
    v_pk_fma_f32 v[158:159], v[158:159], s[72:73], v[12:13]
    v_pk_mul_f32 v[152:153], v[152:153], v[28:29]
    v_pk_mul_f32 v[154:155], v[154:155], v[30:31]
    v_pk_mul_f32 v[156:157], v[156:157], v[56:57]
    v_pk_mul_f32 v[158:159], v[158:159], v[58:59]
    v_exp_f32 v152, v152
    v_exp_f32 v153, v153
    v_exp_f32 v154, v154
    v_exp_f32 v155, v155
    v_exp_f32 v156, v156
    v_exp_f32 v157, v157
    v_exp_f32 v158, v158
    v_exp_f32 v159, v159
    v_pk_add_f32 v[152:153], v[152:153], 1.0 op_sel_hi:[1,0]
    v_pk_add_f32 v[154:155], v[154:155], 1.0 op_sel_hi:[1,0]
    v_pk_add_f32 v[156:157], v[156:157], 1.0 op_sel_hi:[1,0]
    v_pk_add_f32 v[158:159], v[158:159], 1.0 op_sel_hi:[1,0]
    v_rcp_f32 v152, v152
    v_rcp_f32 v153, v153
    v_rcp_f32 v154, v154
    v_rcp_f32 v155, v155
    v_rcp_f32 v156, v156
    v_rcp_f32 v157, v157
    v_rcp_f32 v158, v158
    v_rcp_f32 v159, v159
    v_pk_mul_f32 v[28:29], v[152:153], v[28:29]
    v_pk_mul_f32 v[30:31], v[154:155], v[30:31]
    v_pk_mul_f32 v[56:57], v[156:157], v[56:57]
    v_pk_mul_f32 v[58:59], v[158:159], v[58:59]
    v_cvt_pk_bf16_f32 v188, v28, v29
    v_cvt_pk_bf16_f32 v189, v30, v31
    v_cvt_pk_bf16_f32 v190, v56, v57
    v_cvt_pk_bf16_f32 v191, v58, v59
    buffer_store_dwordx4 v[188:191], v5, s[24:27], s67 offen sc1
    v_pk_mul_f32 v[128:129], v[72:73], v[72:73]
    v_pk_mul_f32 v[130:131], v[74:75], v[74:75]
    v_pk_mul_f32 v[132:133], v[100:101], v[100:101]
    v_pk_mul_f32 v[134:135], v[102:103], v[102:103]
    v_pk_fma_f32 v[128:129], v[128:129], s[72:73], v[12:13]
    v_pk_fma_f32 v[130:131], v[130:131], s[72:73], v[12:13]
    v_pk_fma_f32 v[132:133], v[132:133], s[72:73], v[12:13]
    v_pk_fma_f32 v[134:135], v[134:135], s[72:73], v[12:13]
    v_pk_mul_f32 v[128:129], v[128:129], v[72:73]
    v_pk_mul_f32 v[130:131], v[130:131], v[74:75]
    v_pk_mul_f32 v[132:133], v[132:133], v[100:101]
    v_pk_mul_f32 v[134:135], v[134:135], v[102:103]
    v_exp_f32 v128, v128
    v_exp_f32 v129, v129
    v_exp_f32 v130, v130
    v_exp_f32 v131, v131
    v_exp_f32 v132, v132
    v_exp_f32 v133, v133
    v_exp_f32 v134, v134
    v_exp_f32 v135, v135
    v_pk_add_f32 v[128:129], v[128:129], 1.0 op_sel_hi:[1,0]
    v_pk_add_f32 v[130:131], v[130:131], 1.0 op_sel_hi:[1,0]
    v_pk_add_f32 v[132:133], v[132:133], 1.0 op_sel_hi:[1,0]
    v_pk_add_f32 v[134:135], v[134:135], 1.0 op_sel_hi:[1,0]
    v_rcp_f32 v128, v128
    v_rcp_f32 v129, v129
    v_rcp_f32 v130, v130
    v_rcp_f32 v131, v131
    v_rcp_f32 v132, v132
    v_rcp_f32 v133, v133
    v_rcp_f32 v134, v134
    v_rcp_f32 v135, v135
    v_pk_mul_f32 v[72:73], v[128:129], v[72:73]
    v_pk_mul_f32 v[74:75], v[130:131], v[74:75]
    v_pk_mul_f32 v[100:101], v[132:133], v[100:101]
    v_pk_mul_f32 v[102:103], v[134:135], v[102:103]
    v_cvt_pk_bf16_f32 v192, v72, v73
    v_cvt_pk_bf16_f32 v193, v74, v75
    v_cvt_pk_bf16_f32 v194, v100, v101
    v_cvt_pk_bf16_f32 v195, v102, v103
    s_add_u32 s64, s64, 114688
    buffer_store_dwordx4 v[192:195], v5, s[24:27], s64 offen sc1
    v_pk_mul_f32 v[136:137], v[76:77], v[76:77]
    v_pk_mul_f32 v[138:139], v[78:79], v[78:79]
    v_pk_mul_f32 v[140:141], v[104:105], v[104:105]
    v_pk_mul_f32 v[142:143], v[106:107], v[106:107]
    v_pk_fma_f32 v[136:137], v[136:137], s[72:73], v[12:13]
    v_pk_fma_f32 v[138:139], v[138:139], s[72:73], v[12:13]
    v_pk_fma_f32 v[140:141], v[140:141], s[72:73], v[12:13]
    v_pk_fma_f32 v[142:143], v[142:143], s[72:73], v[12:13]
    v_pk_mul_f32 v[136:137], v[136:137], v[76:77]
    v_pk_mul_f32 v[138:139], v[138:139], v[78:79]
    v_pk_mul_f32 v[140:141], v[140:141], v[104:105]
    v_pk_mul_f32 v[142:143], v[142:143], v[106:107]
    v_exp_f32 v136, v136
    v_exp_f32 v137, v137
    v_exp_f32 v138, v138
    v_exp_f32 v139, v139
    v_exp_f32 v140, v140
    v_exp_f32 v141, v141
    v_exp_f32 v142, v142
    v_exp_f32 v143, v143
    v_pk_add_f32 v[136:137], v[136:137], 1.0 op_sel_hi:[1,0]
    v_pk_add_f32 v[138:139], v[138:139], 1.0 op_sel_hi:[1,0]
    v_pk_add_f32 v[140:141], v[140:141], 1.0 op_sel_hi:[1,0]
    v_pk_add_f32 v[142:143], v[142:143], 1.0 op_sel_hi:[1,0]
    v_rcp_f32 v136, v136
    v_rcp_f32 v137, v137
    v_rcp_f32 v138, v138
    v_rcp_f32 v139, v139
    v_rcp_f32 v140, v140
    v_rcp_f32 v141, v141
    v_rcp_f32 v142, v142
    v_rcp_f32 v143, v143
    v_pk_mul_f32 v[76:77], v[136:137], v[76:77]
    v_pk_mul_f32 v[78:79], v[138:139], v[78:79]
    v_pk_mul_f32 v[104:105], v[140:141], v[104:105]
    v_pk_mul_f32 v[106:107], v[142:143], v[106:107]
    v_cvt_pk_bf16_f32 v196, v76, v77
    v_cvt_pk_bf16_f32 v197, v78, v79
    v_cvt_pk_bf16_f32 v198, v104, v105
    v_cvt_pk_bf16_f32 v199, v106, v107
    s_add_u32 s65, s65, 114688
    buffer_store_dwordx4 v[196:199], v5, s[24:27], s65 offen sc1
    v_pk_mul_f32 v[144:145], v[80:81], v[80:81]
    v_pk_mul_f32 v[146:147], v[82:83], v[82:83]
    v_pk_mul_f32 v[148:149], v[108:109], v[108:109]
    v_pk_mul_f32 v[150:151], v[110:111], v[110:111]
    v_pk_fma_f32 v[144:145], v[144:145], s[72:73], v[12:13]
    v_pk_fma_f32 v[146:147], v[146:147], s[72:73], v[12:13]
    v_pk_fma_f32 v[148:149], v[148:149], s[72:73], v[12:13]
    v_pk_fma_f32 v[150:151], v[150:151], s[72:73], v[12:13]
    v_pk_mul_f32 v[144:145], v[144:145], v[80:81]
    v_pk_mul_f32 v[146:147], v[146:147], v[82:83]
    v_pk_mul_f32 v[148:149], v[148:149], v[108:109]
    v_pk_mul_f32 v[150:151], v[150:151], v[110:111]
    v_exp_f32 v144, v144
    v_exp_f32 v145, v145
    v_exp_f32 v146, v146
    v_exp_f32 v147, v147
    v_exp_f32 v148, v148
    v_exp_f32 v149, v149
    v_exp_f32 v150, v150
    v_exp_f32 v151, v151
    v_pk_add_f32 v[144:145], v[144:145], 1.0 op_sel_hi:[1,0]
    v_pk_add_f32 v[146:147], v[146:147], 1.0 op_sel_hi:[1,0]
    v_pk_add_f32 v[148:149], v[148:149], 1.0 op_sel_hi:[1,0]
    v_pk_add_f32 v[150:151], v[150:151], 1.0 op_sel_hi:[1,0]
    v_rcp_f32 v144, v144
    v_rcp_f32 v145, v145
    v_rcp_f32 v146, v146
    v_rcp_f32 v147, v147
    v_rcp_f32 v148, v148
    v_rcp_f32 v149, v149
    v_rcp_f32 v150, v150
    v_rcp_f32 v151, v151
    v_pk_mul_f32 v[80:81], v[144:145], v[80:81]
    v_pk_mul_f32 v[82:83], v[146:147], v[82:83]
    v_pk_mul_f32 v[108:109], v[148:149], v[108:109]
    v_pk_mul_f32 v[110:111], v[150:151], v[110:111]
    v_cvt_pk_bf16_f32 v200, v80, v81
    v_cvt_pk_bf16_f32 v201, v82, v83
    v_cvt_pk_bf16_f32 v202, v108, v109
    v_cvt_pk_bf16_f32 v203, v110, v111
    s_add_u32 s66, s66, 114688
    buffer_store_dwordx4 v[200:203], v5, s[24:27], s66 offen sc1
    v_pk_mul_f32 v[152:153], v[84:85], v[84:85]
    v_pk_mul_f32 v[154:155], v[86:87], v[86:87]
    v_pk_mul_f32 v[156:157], v[112:113], v[112:113]
    v_pk_mul_f32 v[158:159], v[114:115], v[114:115]
    v_pk_fma_f32 v[152:153], v[152:153], s[72:73], v[12:13]
    v_pk_fma_f32 v[154:155], v[154:155], s[72:73], v[12:13]
    v_pk_fma_f32 v[156:157], v[156:157], s[72:73], v[12:13]
    v_pk_fma_f32 v[158:159], v[158:159], s[72:73], v[12:13]
    v_pk_mul_f32 v[152:153], v[152:153], v[84:85]
    v_pk_mul_f32 v[154:155], v[154:155], v[86:87]
    v_pk_mul_f32 v[156:157], v[156:157], v[112:113]
    v_pk_mul_f32 v[158:159], v[158:159], v[114:115]
    v_exp_f32 v152, v152
    v_exp_f32 v153, v153
    v_exp_f32 v154, v154
    v_exp_f32 v155, v155
    v_exp_f32 v156, v156
    v_exp_f32 v157, v157
    v_exp_f32 v158, v158
    v_exp_f32 v159, v159
    v_pk_add_f32 v[152:153], v[152:153], 1.0 op_sel_hi:[1,0]
    v_pk_add_f32 v[154:155], v[154:155], 1.0 op_sel_hi:[1,0]
    v_pk_add_f32 v[156:157], v[156:157], 1.0 op_sel_hi:[1,0]
    v_pk_add_f32 v[158:159], v[158:159], 1.0 op_sel_hi:[1,0]
    v_rcp_f32 v152, v152
    v_rcp_f32 v153, v153
    v_rcp_f32 v154, v154
    v_rcp_f32 v155, v155
    v_rcp_f32 v156, v156
    v_rcp_f32 v157, v157
    v_rcp_f32 v158, v158
    v_rcp_f32 v159, v159
    v_pk_mul_f32 v[84:85], v[152:153], v[84:85]
    v_pk_mul_f32 v[86:87], v[154:155], v[86:87]
    v_pk_mul_f32 v[112:113], v[156:157], v[112:113]
    v_pk_mul_f32 v[114:115], v[158:159], v[114:115]
    v_cvt_pk_bf16_f32 v204, v84, v85
    v_cvt_pk_bf16_f32 v205, v86, v87
    v_cvt_pk_bf16_f32 v206, v112, v113
    v_cvt_pk_bf16_f32 v207, v114, v115
    s_add_u32 s67, s67, 114688
    buffer_store_dwordx4 v[204:207], v5, s[24:27], s67 offen sc1
    s_barrier
    ds_read_b64 v[160:161], v9 offset:0
    ds_read_b64 v[164:165], v9 offset:128
    ds_read_b64 v[168:169], v9 offset:256
    ds_read_b64 v[172:173], v9 offset:384
    s_waitcnt lgkmcnt(0)
    v_mov_b32 v162, v161
    v_mov_b32 v163, v161
    v_mov_b32 v161, v160
    v_mov_b32 v166, v165
    v_mov_b32 v167, v165
    v_mov_b32 v165, v164
    v_mov_b32 v170, v169
    v_mov_b32 v171, v169
    v_mov_b32 v169, v168
    v_mov_b32 v174, v173
    v_mov_b32 v175, v173
    v_mov_b32 v173, v172
    v_pk_fma_f32 v[32:33], v[32:33], v[162:163], v[160:161]
    v_pk_fma_f32 v[34:35], v[34:35], v[162:163], v[160:161]
    v_pk_fma_f32 v[60:61], v[60:61], v[166:167], v[164:165]
    v_pk_fma_f32 v[62:63], v[62:63], v[166:167], v[164:165]
    v_cvt_pk_bf16_f32 v208, v32, v33
    v_cvt_pk_bf16_f32 v209, v34, v35
    v_cvt_pk_bf16_f32 v210, v60, v61
    v_cvt_pk_bf16_f32 v211, v62, v63
    ds_write_b64 v10, v[208:209] offset:0
    ds_write_b64 v10, v[210:211] offset:640
    ds_read_b64_tr_b16 v[128:129], v11 offset:0
    ds_read_b64_tr_b16 v[130:131], v11 offset:160
    v_pk_fma_f32 v[36:37], v[36:37], v[162:163], v[160:161]
    v_pk_fma_f32 v[38:39], v[38:39], v[162:163], v[160:161]
    v_pk_fma_f32 v[64:65], v[64:65], v[166:167], v[164:165]
    v_pk_fma_f32 v[66:67], v[66:67], v[166:167], v[164:165]
    v_cvt_pk_bf16_f32 v212, v36, v37
    v_cvt_pk_bf16_f32 v213, v38, v39
    v_cvt_pk_bf16_f32 v214, v64, v65
    v_cvt_pk_bf16_f32 v215, v66, v67
    ds_write_b64 v10, v[212:213] offset:1280
    ds_write_b64 v10, v[214:215] offset:1920
    ds_read_b64_tr_b16 v[132:133], v11 offset:1280
    ds_read_b64_tr_b16 v[134:135], v11 offset:1440
    s_waitcnt lgkmcnt(4)
    buffer_store_dwordx4 v[128:131], v7, s[28:31], s68 offen sc1
    v_pk_fma_f32 v[40:41], v[40:41], v[162:163], v[160:161]
    v_pk_fma_f32 v[42:43], v[42:43], v[162:163], v[160:161]
    v_pk_fma_f32 v[68:69], v[68:69], v[166:167], v[164:165]
    v_pk_fma_f32 v[70:71], v[70:71], v[166:167], v[164:165]
    v_cvt_pk_bf16_f32 v208, v40, v41
    v_cvt_pk_bf16_f32 v209, v42, v43
    v_cvt_pk_bf16_f32 v210, v68, v69
    v_cvt_pk_bf16_f32 v211, v70, v71
    ds_write_b64 v10, v[208:209] offset:2560
    ds_write_b64 v10, v[210:211] offset:3200
    ds_read_b64_tr_b16 v[136:137], v11 offset:2560
    ds_read_b64_tr_b16 v[138:139], v11 offset:2720
    s_waitcnt lgkmcnt(4)
    buffer_store_dwordx4 v[132:135], v7, s[28:31], s69 offen sc1
    v_pk_fma_f32 v[88:89], v[88:89], v[170:171], v[168:169]
    v_pk_fma_f32 v[90:91], v[90:91], v[170:171], v[168:169]
    v_pk_fma_f32 v[116:117], v[116:117], v[174:175], v[172:173]
    v_pk_fma_f32 v[118:119], v[118:119], v[174:175], v[172:173]
    v_cvt_pk_bf16_f32 v212, v88, v89
    v_cvt_pk_bf16_f32 v213, v90, v91
    v_cvt_pk_bf16_f32 v214, v116, v117
    v_cvt_pk_bf16_f32 v215, v118, v119
    ds_write_b64 v10, v[212:213] offset:3840
    ds_write_b64 v10, v[214:215] offset:4480
    ds_read_b64_tr_b16 v[140:141], v11 offset:3840
    ds_read_b64_tr_b16 v[142:143], v11 offset:4000
    s_waitcnt lgkmcnt(4)
    buffer_store_dwordx4 v[136:139], v7, s[28:31], s70 offen sc1
    v_pk_fma_f32 v[92:93], v[92:93], v[170:171], v[168:169]
    v_pk_fma_f32 v[94:95], v[94:95], v[170:171], v[168:169]
    v_pk_fma_f32 v[120:121], v[120:121], v[174:175], v[172:173]
    v_pk_fma_f32 v[122:123], v[122:123], v[174:175], v[172:173]
    v_cvt_pk_bf16_f32 v208, v92, v93
    v_cvt_pk_bf16_f32 v209, v94, v95
    v_cvt_pk_bf16_f32 v210, v120, v121
    v_cvt_pk_bf16_f32 v211, v122, v123
    ds_write_b64 v10, v[208:209] offset:0
    ds_write_b64 v10, v[210:211] offset:640
    ds_read_b64_tr_b16 v[144:145], v11 offset:0
    ds_read_b64_tr_b16 v[146:147], v11 offset:160
    s_waitcnt lgkmcnt(4)
    s_add_u32 s68, s68, 7168
    buffer_store_dwordx4 v[140:143], v7, s[28:31], s68 offen sc1
    v_pk_fma_f32 v[96:97], v[96:97], v[170:171], v[168:169]
    v_pk_fma_f32 v[98:99], v[98:99], v[170:171], v[168:169]
    v_pk_fma_f32 v[124:125], v[124:125], v[174:175], v[172:173]
    v_pk_fma_f32 v[126:127], v[126:127], v[174:175], v[172:173]
    v_cvt_pk_bf16_f32 v212, v96, v97
    v_cvt_pk_bf16_f32 v213, v98, v99
    v_cvt_pk_bf16_f32 v214, v124, v125
    v_cvt_pk_bf16_f32 v215, v126, v127
    ds_write_b64 v10, v[212:213] offset:1280
    ds_write_b64 v10, v[214:215] offset:1920
    ds_read_b64_tr_b16 v[148:149], v11 offset:1280
    ds_read_b64_tr_b16 v[150:151], v11 offset:1440
    s_waitcnt lgkmcnt(4)
    s_add_u32 s69, s69, 7168
    buffer_store_dwordx4 v[144:147], v7, s[28:31], s69 offen sc1
    s_waitcnt lgkmcnt(0)
    s_add_u32 s70, s70, 7168
    buffer_store_dwordx4 v[148:151], v7, s[28:31], s70 offen sc1
    s_branch win_epi_done
win_epiB:
    s_add_u32 s68, s68, s57
    s_lshl_b32 s68, s68, 10
    s_add_u32 s69, s69, s57
    s_lshl_b32 s69, s69, 10
    s_add_u32 s70, s70, s57
    s_lshl_b32 s70, s70, 10
    s_cmp_ge_u32 s64, 7
    s_cselect_b32 s59, 1785, 0
    s_add_u32 s64, s64, s59
    s_add_u32 s64, s64, s58
    s_lshl_b32 s64, s64, 8
    s_cmp_ge_u32 s65, 7
    s_cselect_b32 s59, 1785, 0
    s_add_u32 s65, s65, s59
    s_add_u32 s65, s65, s58
    s_lshl_b32 s65, s65, 8
    s_cmp_ge_u32 s66, 7
    s_cselect_b32 s59, 1785, 0
    s_add_u32 s66, s66, s59
    s_add_u32 s66, s66, s58
    s_lshl_b32 s66, s66, 8
    s_cmp_ge_u32 s67, 7
    s_cselect_b32 s59, 1785, 0
    s_add_u32 s67, s67, s59
    s_add_u32 s67, s67, s58
    s_lshl_b32 s67, s67, 8
    v_pk_mul_f32 v[128:129], v[16:17], v[16:17]
    v_pk_mul_f32 v[130:131], v[18:19], v[18:19]
    v_pk_mul_f32 v[132:133], v[20:21], v[20:21]
    v_pk_mul_f32 v[134:135], v[22:23], v[22:23]
    v_pk_mul_f32 v[136:137], v[24:25], v[24:25]
    v_pk_mul_f32 v[138:139], v[26:27], v[26:27]
    v_pk_mul_f32 v[140:141], v[28:29], v[28:29]
    v_pk_mul_f32 v[142:143], v[30:31], v[30:31]
    v_pk_fma_f32 v[128:129], v[128:129], s[72:73], v[12:13]
    v_pk_fma_f32 v[130:131], v[130:131], s[72:73], v[12:13]
    v_pk_fma_f32 v[132:133], v[132:133], s[72:73], v[12:13]
    v_pk_fma_f32 v[134:135], v[134:135], s[72:73], v[12:13]
    v_pk_fma_f32 v[136:137], v[136:137], s[72:73], v[12:13]
    v_pk_fma_f32 v[138:139], v[138:139], s[72:73], v[12:13]
    v_pk_fma_f32 v[140:141], v[140:141], s[72:73], v[12:13]
    v_pk_fma_f32 v[142:143], v[142:143], s[72:73], v[12:13]
    v_pk_mul_f32 v[128:129], v[128:129], v[16:17]
    v_pk_mul_f32 v[130:131], v[130:131], v[18:19]
    v_pk_mul_f32 v[132:133], v[132:133], v[20:21]
    v_pk_mul_f32 v[134:135], v[134:135], v[22:23]
    v_pk_mul_f32 v[136:137], v[136:137], v[24:25]
    v_pk_mul_f32 v[138:139], v[138:139], v[26:27]
    v_pk_mul_f32 v[140:141], v[140:141], v[28:29]
    v_pk_mul_f32 v[142:143], v[142:143], v[30:31]
    v_exp_f32 v128, v128
    v_exp_f32 v129, v129
    v_exp_f32 v130, v130
    v_exp_f32 v131, v131
    v_exp_f32 v132, v132
    v_exp_f32 v133, v133
    v_exp_f32 v134, v134
    v_exp_f32 v135, v135
    v_exp_f32 v136, v136
    v_exp_f32 v137, v137
    v_exp_f32 v138, v138
    v_exp_f32 v139, v139
    v_exp_f32 v140, v140
    v_exp_f32 v141, v141
    v_exp_f32 v142, v142
    v_exp_f32 v143, v143
    v_pk_add_f32 v[128:129], v[128:129], 1.0 op_sel_hi:[1,0]
    v_pk_add_f32 v[130:131], v[130:131], 1.0 op_sel_hi:[1,0]
    v_pk_add_f32 v[132:133], v[132:133], 1.0 op_sel_hi:[1,0]
    v_pk_add_f32 v[134:135], v[134:135], 1.0 op_sel_hi:[1,0]
    v_pk_add_f32 v[136:137], v[136:137], 1.0 op_sel_hi:[1,0]
    v_pk_add_f32 v[138:139], v[138:139], 1.0 op_sel_hi:[1,0]
    v_pk_add_f32 v[140:141], v[140:141], 1.0 op_sel_hi:[1,0]
    v_pk_add_f32 v[142:143], v[142:143], 1.0 op_sel_hi:[1,0]
    v_rcp_f32 v128, v128
    v_rcp_f32 v129, v129
    v_rcp_f32 v130, v130
    v_rcp_f32 v131, v131
    v_rcp_f32 v132, v132
    v_rcp_f32 v133, v133
    v_rcp_f32 v134, v134
    v_rcp_f32 v135, v135
    v_rcp_f32 v136, v136
    v_rcp_f32 v137, v137
    v_rcp_f32 v138, v138
    v_rcp_f32 v139, v139
    v_rcp_f32 v140, v140
    v_rcp_f32 v141, v141
    v_rcp_f32 v142, v142
    v_rcp_f32 v143, v143
    v_pk_mul_f32 v[16:17], v[128:129], v[16:17]
    v_pk_mul_f32 v[18:19], v[130:131], v[18:19]
    v_pk_mul_f32 v[20:21], v[132:133], v[20:21]
    v_pk_mul_f32 v[22:23], v[134:135], v[22:23]
    v_pk_mul_f32 v[24:25], v[136:137], v[24:25]
    v_pk_mul_f32 v[26:27], v[138:139], v[26:27]
    v_pk_mul_f32 v[28:29], v[140:141], v[28:29]
    v_pk_mul_f32 v[30:31], v[142:143], v[30:31]
    v_pk_add_f32 v[168:169], v[16:17], v[18:19]
    v_pk_mul_f32 v[170:171], v[16:17], v[16:17]
    v_pk_fma_f32 v[170:171], v[18:19], v[18:19], v[170:171]
    v_pk_add_f32 v[168:169], v[168:169], v[20:21]
    v_pk_fma_f32 v[170:171], v[20:21], v[20:21], v[170:171]
    v_pk_add_f32 v[168:169], v[168:169], v[22:23]
    v_pk_fma_f32 v[170:171], v[22:23], v[22:23], v[170:171]
    v_pk_add_f32 v[168:169], v[168:169], v[24:25]
    v_pk_fma_f32 v[170:171], v[24:25], v[24:25], v[170:171]
    v_pk_add_f32 v[168:169], v[168:169], v[26:27]
    v_pk_fma_f32 v[170:171], v[26:27], v[26:27], v[170:171]
    v_pk_add_f32 v[168:169], v[168:169], v[28:29]
    v_pk_fma_f32 v[170:171], v[28:29], v[28:29], v[170:171]
    v_pk_add_f32 v[168:169], v[168:169], v[30:31]
    v_pk_fma_f32 v[170:171], v[30:31], v[30:31], v[170:171]
    v_add_f32 v160, v168, v169
    v_add_f32 v161, v170, v171
    v_pk_mul_f32 v[144:145], v[44:45], v[44:45]
    v_pk_mul_f32 v[146:147], v[46:47], v[46:47]
    v_pk_mul_f32 v[148:149], v[48:49], v[48:49]
    v_pk_mul_f32 v[150:151], v[50:51], v[50:51]
    v_pk_mul_f32 v[152:153], v[52:53], v[52:53]
    v_pk_mul_f32 v[154:155], v[54:55], v[54:55]
    v_pk_mul_f32 v[156:157], v[56:57], v[56:57]
    v_pk_mul_f32 v[158:159], v[58:59], v[58:59]
    v_pk_fma_f32 v[144:145], v[144:145], s[72:73], v[12:13]
    v_pk_fma_f32 v[146:147], v[146:147], s[72:73], v[12:13]
    v_pk_fma_f32 v[148:149], v[148:149], s[72:73], v[12:13]
    v_pk_fma_f32 v[150:151], v[150:151], s[72:73], v[12:13]
    v_pk_fma_f32 v[152:153], v[152:153], s[72:73], v[12:13]
    v_pk_fma_f32 v[154:155], v[154:155], s[72:73], v[12:13]
    v_pk_fma_f32 v[156:157], v[156:157], s[72:73], v[12:13]
    v_pk_fma_f32 v[158:159], v[158:159], s[72:73], v[12:13]
    v_pk_mul_f32 v[144:145], v[144:145], v[44:45]
    v_pk_mul_f32 v[146:147], v[146:147], v[46:47]
    v_pk_mul_f32 v[148:149], v[148:149], v[48:49]
    v_pk_mul_f32 v[150:151], v[150:151], v[50:51]
    v_pk_mul_f32 v[152:153], v[152:153], v[52:53]
    v_pk_mul_f32 v[154:155], v[154:155], v[54:55]
    v_pk_mul_f32 v[156:157], v[156:157], v[56:57]
    v_pk_mul_f32 v[158:159], v[158:159], v[58:59]
    v_exp_f32 v144, v144
    v_exp_f32 v145, v145
    v_exp_f32 v146, v146
    v_exp_f32 v147, v147
    v_exp_f32 v148, v148
    v_exp_f32 v149, v149
    v_exp_f32 v150, v150
    v_exp_f32 v151, v151
    v_exp_f32 v152, v152
    v_exp_f32 v153, v153
    v_exp_f32 v154, v154
    v_exp_f32 v155, v155
    v_exp_f32 v156, v156
    v_exp_f32 v157, v157
    v_exp_f32 v158, v158
    v_exp_f32 v159, v159
    v_pk_add_f32 v[144:145], v[144:145], 1.0 op_sel_hi:[1,0]
    v_pk_add_f32 v[146:147], v[146:147], 1.0 op_sel_hi:[1,0]
    v_pk_add_f32 v[148:149], v[148:149], 1.0 op_sel_hi:[1,0]
    v_pk_add_f32 v[150:151], v[150:151], 1.0 op_sel_hi:[1,0]
    v_pk_add_f32 v[152:153], v[152:153], 1.0 op_sel_hi:[1,0]
    v_pk_add_f32 v[154:155], v[154:155], 1.0 op_sel_hi:[1,0]
    v_pk_add_f32 v[156:157], v[156:157], 1.0 op_sel_hi:[1,0]
    v_pk_add_f32 v[158:159], v[158:159], 1.0 op_sel_hi:[1,0]
    v_rcp_f32 v144, v144
    v_rcp_f32 v145, v145
    v_rcp_f32 v146, v146
    v_rcp_f32 v147, v147
    v_rcp_f32 v148, v148
    v_rcp_f32 v149, v149
    v_rcp_f32 v150, v150
    v_rcp_f32 v151, v151
    v_rcp_f32 v152, v152
    v_rcp_f32 v153, v153
    v_rcp_f32 v154, v154
    v_rcp_f32 v155, v155
    v_rcp_f32 v156, v156
    v_rcp_f32 v157, v157
    v_rcp_f32 v158, v158
    v_rcp_f32 v159, v159
    v_pk_mul_f32 v[44:45], v[144:145], v[44:45]
    v_pk_mul_f32 v[46:47], v[146:147], v[46:47]
    v_pk_mul_f32 v[48:49], v[148:149], v[48:49]
    v_pk_mul_f32 v[50:51], v[150:151], v[50:51]
    v_pk_mul_f32 v[52:53], v[152:153], v[52:53]
    v_pk_mul_f32 v[54:55], v[154:155], v[54:55]
    v_pk_mul_f32 v[56:57], v[156:157], v[56:57]
    v_pk_mul_f32 v[58:59], v[158:159], v[58:59]
    v_pk_add_f32 v[168:169], v[44:45], v[46:47]
    v_pk_mul_f32 v[170:171], v[44:45], v[44:45]
    v_pk_fma_f32 v[170:171], v[46:47], v[46:47], v[170:171]
    v_pk_add_f32 v[168:169], v[168:169], v[48:49]
    v_pk_fma_f32 v[170:171], v[48:49], v[48:49], v[170:171]
    v_pk_add_f32 v[168:169], v[168:169], v[50:51]
    v_pk_fma_f32 v[170:171], v[50:51], v[50:51], v[170:171]
    v_pk_add_f32 v[168:169], v[168:169], v[52:53]
    v_pk_fma_f32 v[170:171], v[52:53], v[52:53], v[170:171]
    v_pk_add_f32 v[168:169], v[168:169], v[54:55]
    v_pk_fma_f32 v[170:171], v[54:55], v[54:55], v[170:171]
    v_pk_add_f32 v[168:169], v[168:169], v[56:57]
    v_pk_fma_f32 v[170:171], v[56:57], v[56:57], v[170:171]
    v_pk_add_f32 v[168:169], v[168:169], v[58:59]
    v_pk_fma_f32 v[170:171], v[58:59], v[58:59], v[170:171]
    v_add_f32 v162, v168, v169
    v_add_f32 v163, v170, v171
    v_pk_mul_f32 v[128:129], v[72:73], v[72:73]
    v_pk_mul_f32 v[130:131], v[74:75], v[74:75]
    v_pk_mul_f32 v[132:133], v[76:77], v[76:77]
    v_pk_mul_f32 v[134:135], v[78:79], v[78:79]
    v_pk_mul_f32 v[136:137], v[80:81], v[80:81]
    v_pk_mul_f32 v[138:139], v[82:83], v[82:83]
    v_pk_mul_f32 v[140:141], v[84:85], v[84:85]
    v_pk_mul_f32 v[142:143], v[86:87], v[86:87]
    v_pk_fma_f32 v[128:129], v[128:129], s[72:73], v[12:13]
    v_pk_fma_f32 v[130:131], v[130:131], s[72:73], v[12:13]
    v_pk_fma_f32 v[132:133], v[132:133], s[72:73], v[12:13]
    v_pk_fma_f32 v[134:135], v[134:135], s[72:73], v[12:13]
    v_pk_fma_f32 v[136:137], v[136:137], s[72:73], v[12:13]
    v_pk_fma_f32 v[138:139], v[138:139], s[72:73], v[12:13]
    v_pk_fma_f32 v[140:141], v[140:141], s[72:73], v[12:13]
    v_pk_fma_f32 v[142:143], v[142:143], s[72:73], v[12:13]
    v_pk_mul_f32 v[128:129], v[128:129], v[72:73]
    v_pk_mul_f32 v[130:131], v[130:131], v[74:75]
    v_pk_mul_f32 v[132:133], v[132:133], v[76:77]
    v_pk_mul_f32 v[134:135], v[134:135], v[78:79]
    v_pk_mul_f32 v[136:137], v[136:137], v[80:81]
    v_pk_mul_f32 v[138:139], v[138:139], v[82:83]
    v_pk_mul_f32 v[140:141], v[140:141], v[84:85]
    v_pk_mul_f32 v[142:143], v[142:143], v[86:87]
    v_exp_f32 v128, v128
    v_exp_f32 v129, v129
    v_exp_f32 v130, v130
    v_exp_f32 v131, v131
    v_exp_f32 v132, v132
    v_exp_f32 v133, v133
    v_exp_f32 v134, v134
    v_exp_f32 v135, v135
    v_exp_f32 v136, v136
    v_exp_f32 v137, v137
    v_exp_f32 v138, v138
    v_exp_f32 v139, v139
    v_exp_f32 v140, v140
    v_exp_f32 v141, v141
    v_exp_f32 v142, v142
    v_exp_f32 v143, v143
    v_pk_add_f32 v[128:129], v[128:129], 1.0 op_sel_hi:[1,0]
    v_pk_add_f32 v[130:131], v[130:131], 1.0 op_sel_hi:[1,0]
    v_pk_add_f32 v[132:133], v[132:133], 1.0 op_sel_hi:[1,0]
    v_pk_add_f32 v[134:135], v[134:135], 1.0 op_sel_hi:[1,0]
    v_pk_add_f32 v[136:137], v[136:137], 1.0 op_sel_hi:[1,0]
    v_pk_add_f32 v[138:139], v[138:139], 1.0 op_sel_hi:[1,0]
    v_pk_add_f32 v[140:141], v[140:141], 1.0 op_sel_hi:[1,0]
    v_pk_add_f32 v[142:143], v[142:143], 1.0 op_sel_hi:[1,0]
    v_rcp_f32 v128, v128
    v_rcp_f32 v129, v129
    v_rcp_f32 v130, v130
    v_rcp_f32 v131, v131
    v_rcp_f32 v132, v132
    v_rcp_f32 v133, v133
    v_rcp_f32 v134, v134
    v_rcp_f32 v135, v135
    v_rcp_f32 v136, v136
    v_rcp_f32 v137, v137
    v_rcp_f32 v138, v138
    v_rcp_f32 v139, v139
    v_rcp_f32 v140, v140
    v_rcp_f32 v141, v141
    v_rcp_f32 v142, v142
    v_rcp_f32 v143, v143
    v_pk_mul_f32 v[72:73], v[128:129], v[72:73]
    v_pk_mul_f32 v[74:75], v[130:131], v[74:75]
    v_pk_mul_f32 v[76:77], v[132:133], v[76:77]
    v_pk_mul_f32 v[78:79], v[134:135], v[78:79]
    v_pk_mul_f32 v[80:81], v[136:137], v[80:81]
    v_pk_mul_f32 v[82:83], v[138:139], v[82:83]
    v_pk_mul_f32 v[84:85], v[140:141], v[84:85]
    v_pk_mul_f32 v[86:87], v[142:143], v[86:87]
    v_pk_add_f32 v[168:169], v[72:73], v[74:75]
    v_pk_mul_f32 v[170:171], v[72:73], v[72:73]
    v_pk_fma_f32 v[170:171], v[74:75], v[74:75], v[170:171]
    v_pk_add_f32 v[168:169], v[168:169], v[76:77]
    v_pk_fma_f32 v[170:171], v[76:77], v[76:77], v[170:171]
    v_pk_add_f32 v[168:169], v[168:169], v[78:79]
    v_pk_fma_f32 v[170:171], v[78:79], v[78:79], v[170:171]
    v_pk_add_f32 v[168:169], v[168:169], v[80:81]
    v_pk_fma_f32 v[170:171], v[80:81], v[80:81], v[170:171]
    v_pk_add_f32 v[168:169], v[168:169], v[82:83]
    v_pk_fma_f32 v[170:171], v[82:83], v[82:83], v[170:171]
    v_pk_add_f32 v[168:169], v[168:169], v[84:85]
    v_pk_fma_f32 v[170:171], v[84:85], v[84:85], v[170:171]
    v_pk_add_f32 v[168:169], v[168:169], v[86:87]
    v_pk_fma_f32 v[170:171], v[86:87], v[86:87], v[170:171]
    v_add_f32 v164, v168, v169
    v_add_f32 v165, v170, v171
    v_pk_mul_f32 v[144:145], v[100:101], v[100:101]
    v_pk_mul_f32 v[146:147], v[102:103], v[102:103]
    v_pk_mul_f32 v[148:149], v[104:105], v[104:105]
    v_pk_mul_f32 v[150:151], v[106:107], v[106:107]
    v_pk_mul_f32 v[152:153], v[108:109], v[108:109]
    v_pk_mul_f32 v[154:155], v[110:111], v[110:111]
    v_pk_mul_f32 v[156:157], v[112:113], v[112:113]
    v_pk_mul_f32 v[158:159], v[114:115], v[114:115]
    v_pk_fma_f32 v[144:145], v[144:145], s[72:73], v[12:13]
    v_pk_fma_f32 v[146:147], v[146:147], s[72:73], v[12:13]
    v_pk_fma_f32 v[148:149], v[148:149], s[72:73], v[12:13]
    v_pk_fma_f32 v[150:151], v[150:151], s[72:73], v[12:13]
    v_pk_fma_f32 v[152:153], v[152:153], s[72:73], v[12:13]
    v_pk_fma_f32 v[154:155], v[154:155], s[72:73], v[12:13]
    v_pk_fma_f32 v[156:157], v[156:157], s[72:73], v[12:13]
    v_pk_fma_f32 v[158:159], v[158:159], s[72:73], v[12:13]
    v_pk_mul_f32 v[144:145], v[144:145], v[100:101]
    v_pk_mul_f32 v[146:147], v[146:147], v[102:103]
    v_pk_mul_f32 v[148:149], v[148:149], v[104:105]
    v_pk_mul_f32 v[150:151], v[150:151], v[106:107]
    v_pk_mul_f32 v[152:153], v[152:153], v[108:109]
    v_pk_mul_f32 v[154:155], v[154:155], v[110:111]
    v_pk_mul_f32 v[156:157], v[156:157], v[112:113]
    v_pk_mul_f32 v[158:159], v[158:159], v[114:115]
    v_exp_f32 v144, v144
    v_exp_f32 v145, v145
    v_exp_f32 v146, v146
    v_exp_f32 v147, v147
    v_exp_f32 v148, v148
    v_exp_f32 v149, v149
    v_exp_f32 v150, v150
    v_exp_f32 v151, v151
    v_exp_f32 v152, v152
    v_exp_f32 v153, v153
    v_exp_f32 v154, v154
    v_exp_f32 v155, v155
    v_exp_f32 v156, v156
    v_exp_f32 v157, v157
    v_exp_f32 v158, v158
    v_exp_f32 v159, v159
    v_pk_add_f32 v[144:145], v[144:145], 1.0 op_sel_hi:[1,0]
    v_pk_add_f32 v[146:147], v[146:147], 1.0 op_sel_hi:[1,0]
    v_pk_add_f32 v[148:149], v[148:149], 1.0 op_sel_hi:[1,0]
    v_pk_add_f32 v[150:151], v[150:151], 1.0 op_sel_hi:[1,0]
    v_pk_add_f32 v[152:153], v[152:153], 1.0 op_sel_hi:[1,0]
    v_pk_add_f32 v[154:155], v[154:155], 1.0 op_sel_hi:[1,0]
    v_pk_add_f32 v[156:157], v[156:157], 1.0 op_sel_hi:[1,0]
    v_pk_add_f32 v[158:159], v[158:159], 1.0 op_sel_hi:[1,0]
    v_rcp_f32 v144, v144
    v_rcp_f32 v145, v145
    v_rcp_f32 v146, v146
    v_rcp_f32 v147, v147
    v_rcp_f32 v148, v148
    v_rcp_f32 v149, v149
    v_rcp_f32 v150, v150
    v_rcp_f32 v151, v151
    v_rcp_f32 v152, v152
    v_rcp_f32 v153, v153
    v_rcp_f32 v154, v154
    v_rcp_f32 v155, v155
    v_rcp_f32 v156, v156
    v_rcp_f32 v157, v157
    v_rcp_f32 v158, v158
    v_rcp_f32 v159, v159
    v_pk_mul_f32 v[100:101], v[144:145], v[100:101]
    v_pk_mul_f32 v[102:103], v[146:147], v[102:103]
    v_pk_mul_f32 v[104:105], v[148:149], v[104:105]
    v_pk_mul_f32 v[106:107], v[150:151], v[106:107]
    v_pk_mul_f32 v[108:109], v[152:153], v[108:109]
    v_pk_mul_f32 v[110:111], v[154:155], v[110:111]
    v_pk_mul_f32 v[112:113], v[156:157], v[112:113]
    v_pk_mul_f32 v[114:115], v[158:159], v[114:115]
    v_pk_add_f32 v[168:169], v[100:101], v[102:103]
    v_pk_mul_f32 v[170:171], v[100:101], v[100:101]
    v_pk_fma_f32 v[170:171], v[102:103], v[102:103], v[170:171]
    v_pk_add_f32 v[168:169], v[168:169], v[104:105]
    v_pk_fma_f32 v[170:171], v[104:105], v[104:105], v[170:171]
    v_pk_add_f32 v[168:169], v[168:169], v[106:107]
    v_pk_fma_f32 v[170:171], v[106:107], v[106:107], v[170:171]
    v_pk_add_f32 v[168:169], v[168:169], v[108:109]
    v_pk_fma_f32 v[170:171], v[108:109], v[108:109], v[170:171]
    v_pk_add_f32 v[168:169], v[168:169], v[110:111]
    v_pk_fma_f32 v[170:171], v[110:111], v[110:111], v[170:171]
    v_pk_add_f32 v[168:169], v[168:169], v[112:113]
    v_pk_fma_f32 v[170:171], v[112:113], v[112:113], v[170:171]
    v_pk_add_f32 v[168:169], v[168:169], v[114:115]
    v_pk_fma_f32 v[170:171], v[114:115], v[114:115], v[170:171]
    v_add_f32 v166, v168, v169
    v_add_f32 v167, v170, v171
    v_permlane16_swap_b32 v160, v161
    v_permlane16_swap_b32 v162, v163
    v_permlane16_swap_b32 v164, v165
    v_permlane16_swap_b32 v166, v167
    v_add_f32 v160, v160, v161
    v_add_f32 v162, v162, v163
    v_add_f32 v164, v164, v165
    v_add_f32 v166, v166, v167
    v_permlane32_swap_b32 v160, v162
    s_nop 0
    v_permlane32_swap_b32 v164, v166
    v_add_f32 v160, v160, v162
    v_add_f32 v161, v164, v166
    s_nop 1
    v_permlane16_swap_b32 v160, v161
    ds_write_b64 v6, v[160:161]
    s_waitcnt lgkmcnt(0)
    s_barrier
    v_pk_mul_f32 v[128:129], v[32:33], v[32:33]
    v_pk_mul_f32 v[130:131], v[34:35], v[34:35]
    v_pk_mul_f32 v[132:133], v[60:61], v[60:61]
    v_pk_mul_f32 v[134:135], v[62:63], v[62:63]
    v_pk_fma_f32 v[128:129], v[128:129], s[72:73], v[12:13]
    v_pk_fma_f32 v[130:131], v[130:131], s[72:73], v[12:13]
    v_pk_fma_f32 v[132:133], v[132:133], s[72:73], v[12:13]
    v_pk_fma_f32 v[134:135], v[134:135], s[72:73], v[12:13]
    v_pk_mul_f32 v[128:129], v[128:129], v[32:33]
    v_pk_mul_f32 v[130:131], v[130:131], v[34:35]
    v_pk_mul_f32 v[132:133], v[132:133], v[60:61]
    v_pk_mul_f32 v[134:135], v[134:135], v[62:63]
    v_exp_f32 v128, v128
    v_exp_f32 v129, v129
    v_exp_f32 v130, v130
    v_exp_f32 v131, v131
    v_exp_f32 v132, v132
    v_exp_f32 v133, v133
    v_exp_f32 v134, v134
    v_exp_f32 v135, v135
    v_pk_add_f32 v[128:129], v[128:129], 1.0 op_sel_hi:[1,0]
    v_pk_add_f32 v[130:131], v[130:131], 1.0 op_sel_hi:[1,0]
    v_pk_add_f32 v[132:133], v[132:133], 1.0 op_sel_hi:[1,0]
    v_pk_add_f32 v[134:135], v[134:135], 1.0 op_sel_hi:[1,0]
    v_rcp_f32 v128, v128
    v_rcp_f32 v129, v129
    v_rcp_f32 v130, v130
    v_rcp_f32 v131, v131
    v_rcp_f32 v132, v132
    v_rcp_f32 v133, v133
    v_rcp_f32 v134, v134
    v_rcp_f32 v135, v135
    v_pk_mul_f32 v[32:33], v[128:129], v[32:33]
    v_pk_mul_f32 v[34:35], v[130:131], v[34:35]
    v_pk_mul_f32 v[60:61], v[132:133], v[60:61]
    v_pk_mul_f32 v[62:63], v[134:135], v[62:63]
    v_cvt_pk_bf16_f32 v176, v32, v33
    v_cvt_pk_bf16_f32 v177, v34, v35
    v_cvt_pk_bf16_f32 v178, v60, v61
    v_cvt_pk_bf16_f32 v179, v62, v63
    buffer_store_dwordx4 v[176:179], v5, s[24:27], s68 offen sc1
    v_pk_mul_f32 v[136:137], v[36:37], v[36:37]
    v_pk_mul_f32 v[138:139], v[38:39], v[38:39]
    v_pk_mul_f32 v[140:141], v[64:65], v[64:65]
    v_pk_mul_f32 v[142:143], v[66:67], v[66:67]
    v_pk_fma_f32 v[136:137], v[136:137], s[72:73], v[12:13]
    v_pk_fma_f32 v[138:139], v[138:139], s[72:73], v[12:13]
    v_pk_fma_f32 v[140:141], v[140:141], s[72:73], v[12:13]
    v_pk_fma_f32 v[142:143], v[142:143], s[72:73], v[12:13]
    v_pk_mul_f32 v[136:137], v[136:137], v[36:37]
    v_pk_mul_f32 v[138:139], v[138:139], v[38:39]
    v_pk_mul_f32 v[140:141], v[140:141], v[64:65]
    v_pk_mul_f32 v[142:143], v[142:143], v[66:67]
    v_exp_f32 v136, v136
    v_exp_f32 v137, v137
    v_exp_f32 v138, v138
    v_exp_f32 v139, v139
    v_exp_f32 v140, v140
    v_exp_f32 v141, v141
    v_exp_f32 v142, v142
    v_exp_f32 v143, v143
    v_pk_add_f32 v[136:137], v[136:137], 1.0 op_sel_hi:[1,0]
    v_pk_add_f32 v[138:139], v[138:139], 1.0 op_sel_hi:[1,0]
    v_pk_add_f32 v[140:141], v[140:141], 1.0 op_sel_hi:[1,0]
    v_pk_add_f32 v[142:143], v[142:143], 1.0 op_sel_hi:[1,0]
    v_rcp_f32 v136, v136
    v_rcp_f32 v137, v137
    v_rcp_f32 v138, v138
    v_rcp_f32 v139, v139
    v_rcp_f32 v140, v140
    v_rcp_f32 v141, v141
    v_rcp_f32 v142, v142
    v_rcp_f32 v143, v143
    v_pk_mul_f32 v[36:37], v[136:137], v[36:37]
    v_pk_mul_f32 v[38:39], v[138:139], v[38:39]
    v_pk_mul_f32 v[64:65], v[140:141], v[64:65]
    v_pk_mul_f32 v[66:67], v[142:143], v[66:67]
    v_cvt_pk_bf16_f32 v180, v36, v37
    v_cvt_pk_bf16_f32 v181, v38, v39
    v_cvt_pk_bf16_f32 v182, v64, v65
    v_cvt_pk_bf16_f32 v183, v66, v67
    buffer_store_dwordx4 v[180:183], v5, s[24:27], s69 offen sc1
    v_pk_mul_f32 v[144:145], v[40:41], v[40:41]
    v_pk_mul_f32 v[146:147], v[42:43], v[42:43]
    v_pk_mul_f32 v[148:149], v[68:69], v[68:69]
    v_pk_mul_f32 v[150:151], v[70:71], v[70:71]
    v_pk_fma_f32 v[144:145], v[144:145], s[72:73], v[12:13]
    v_pk_fma_f32 v[146:147], v[146:147], s[72:73], v[12:13]
    v_pk_fma_f32 v[148:149], v[148:149], s[72:73], v[12:13]
    v_pk_fma_f32 v[150:151], v[150:151], s[72:73], v[12:13]
    v_pk_mul_f32 v[144:145], v[144:145], v[40:41]
    v_pk_mul_f32 v[146:147], v[146:147], v[42:43]
    v_pk_mul_f32 v[148:149], v[148:149], v[68:69]
    v_pk_mul_f32 v[150:151], v[150:151], v[70:71]
    v_exp_f32 v144, v144
    v_exp_f32 v145, v145
    v_exp_f32 v146, v146
    v_exp_f32 v147, v147
    v_exp_f32 v148, v148
    v_exp_f32 v149, v149
    v_exp_f32 v150, v150
    v_exp_f32 v151, v151
    v_pk_add_f32 v[144:145], v[144:145], 1.0 op_sel_hi:[1,0]
    v_pk_add_f32 v[146:147], v[146:147], 1.0 op_sel_hi:[1,0]
    v_pk_add_f32 v[148:149], v[148:149], 1.0 op_sel_hi:[1,0]
    v_pk_add_f32 v[150:151], v[150:151], 1.0 op_sel_hi:[1,0]
    v_rcp_f32 v144, v144
    v_rcp_f32 v145, v145
    v_rcp_f32 v146, v146
    v_rcp_f32 v147, v147
    v_rcp_f32 v148, v148
    v_rcp_f32 v149, v149
    v_rcp_f32 v150, v150
    v_rcp_f32 v151, v151
    v_pk_mul_f32 v[40:41], v[144:145], v[40:41]
    v_pk_mul_f32 v[42:43], v[146:147], v[42:43]
    v_pk_mul_f32 v[68:69], v[148:149], v[68:69]
    v_pk_mul_f32 v[70:71], v[150:151], v[70:71]
    v_cvt_pk_bf16_f32 v184, v40, v41
    v_cvt_pk_bf16_f32 v185, v42, v43
    v_cvt_pk_bf16_f32 v186, v68, v69
    v_cvt_pk_bf16_f32 v187, v70, v71
    buffer_store_dwordx4 v[184:187], v5, s[24:27], s70 offen sc1
    v_pk_mul_f32 v[152:153], v[88:89], v[88:89]
    v_pk_mul_f32 v[154:155], v[90:91], v[90:91]
    v_pk_mul_f32 v[156:157], v[116:117], v[116:117]
    v_pk_mul_f32 v[158:159], v[118:119], v[118:119]
    v_pk_fma_f32 v[152:153], v[152:153], s[72:73], v[12:13]
    v_pk_fma_f32 v[154:155], v[154:155], s[72:73], v[12:13]
    v_pk_fma_f32 v[156:157], v[156:157], s[72:73], v[12:13]
    v_pk_fma_f32 v[158:159], v[158:159], s[72:73], v[12:13]
    v_pk_mul_f32 v[152:153], v[152:153], v[88:89]
    v_pk_mul_f32 v[154:155], v[154:155], v[90:91]
    v_pk_mul_f32 v[156:157], v[156:157], v[116:117]
    v_pk_mul_f32 v[158:159], v[158:159], v[118:119]
    v_exp_f32 v152, v152
    v_exp_f32 v153, v153
    v_exp_f32 v154, v154
    v_exp_f32 v155, v155
    v_exp_f32 v156, v156
    v_exp_f32 v157, v157
    v_exp_f32 v158, v158
    v_exp_f32 v159, v159
    v_pk_add_f32 v[152:153], v[152:153], 1.0 op_sel_hi:[1,0]
    v_pk_add_f32 v[154:155], v[154:155], 1.0 op_sel_hi:[1,0]
    v_pk_add_f32 v[156:157], v[156:157], 1.0 op_sel_hi:[1,0]
    v_pk_add_f32 v[158:159], v[158:159], 1.0 op_sel_hi:[1,0]
    v_rcp_f32 v152, v152
    v_rcp_f32 v153, v153
    v_rcp_f32 v154, v154
    v_rcp_f32 v155, v155
    v_rcp_f32 v156, v156
    v_rcp_f32 v157, v157
    v_rcp_f32 v158, v158
    v_rcp_f32 v159, v159
    v_pk_mul_f32 v[88:89], v[152:153], v[88:89]
    v_pk_mul_f32 v[90:91], v[154:155], v[90:91]
    v_pk_mul_f32 v[116:117], v[156:157], v[116:117]
    v_pk_mul_f32 v[118:119], v[158:159], v[118:119]
    v_cvt_pk_bf16_f32 v188, v88, v89
    v_cvt_pk_bf16_f32 v189, v90, v91
    v_cvt_pk_bf16_f32 v190, v116, v117
    v_cvt_pk_bf16_f32 v191, v118, v119
    s_add_u32 s68, s68, 114688
    buffer_store_dwordx4 v[188:191], v5, s[24:27], s68 offen sc1
    v_pk_mul_f32 v[128:129], v[92:93], v[92:93]
    v_pk_mul_f32 v[130:131], v[94:95], v[94:95]
    v_pk_mul_f32 v[132:133], v[120:121], v[120:121]
    v_pk_mul_f32 v[134:135], v[122:123], v[122:123]
    v_pk_fma_f32 v[128:129], v[128:129], s[72:73], v[12:13]
    v_pk_fma_f32 v[130:131], v[130:131], s[72:73], v[12:13]
    v_pk_fma_f32 v[132:133], v[132:133], s[72:73], v[12:13]
    v_pk_fma_f32 v[134:135], v[134:135], s[72:73], v[12:13]
    v_pk_mul_f32 v[128:129], v[128:129], v[92:93]
    v_pk_mul_f32 v[130:131], v[130:131], v[94:95]
    v_pk_mul_f32 v[132:133], v[132:133], v[120:121]
    v_pk_mul_f32 v[134:135], v[134:135], v[122:123]
    v_exp_f32 v128, v128
    v_exp_f32 v129, v129
    v_exp_f32 v130, v130
    v_exp_f32 v131, v131
    v_exp_f32 v132, v132
    v_exp_f32 v133, v133
    v_exp_f32 v134, v134
    v_exp_f32 v135, v135
    v_pk_add_f32 v[128:129], v[128:129], 1.0 op_sel_hi:[1,0]
    v_pk_add_f32 v[130:131], v[130:131], 1.0 op_sel_hi:[1,0]
    v_pk_add_f32 v[132:133], v[132:133], 1.0 op_sel_hi:[1,0]
    v_pk_add_f32 v[134:135], v[134:135], 1.0 op_sel_hi:[1,0]
    v_rcp_f32 v128, v128
    v_rcp_f32 v129, v129
    v_rcp_f32 v130, v130
    v_rcp_f32 v131, v131
    v_rcp_f32 v132, v132
    v_rcp_f32 v133, v133
    v_rcp_f32 v134, v134
    v_rcp_f32 v135, v135
    v_pk_mul_f32 v[92:93], v[128:129], v[92:93]
    v_pk_mul_f32 v[94:95], v[130:131], v[94:95]
    v_pk_mul_f32 v[120:121], v[132:133], v[120:121]
    v_pk_mul_f32 v[122:123], v[134:135], v[122:123]
    v_cvt_pk_bf16_f32 v192, v92, v93
    v_cvt_pk_bf16_f32 v193, v94, v95
    v_cvt_pk_bf16_f32 v194, v120, v121
    v_cvt_pk_bf16_f32 v195, v122, v123
    s_add_u32 s69, s69, 114688
    buffer_store_dwordx4 v[192:195], v5, s[24:27], s69 offen sc1
    v_pk_mul_f32 v[136:137], v[96:97], v[96:97]
    v_pk_mul_f32 v[138:139], v[98:99], v[98:99]
    v_pk_mul_f32 v[140:141], v[124:125], v[124:125]
    v_pk_mul_f32 v[142:143], v[126:127], v[126:127]
    v_pk_fma_f32 v[136:137], v[136:137], s[72:73], v[12:13]
    v_pk_fma_f32 v[138:139], v[138:139], s[72:73], v[12:13]
    v_pk_fma_f32 v[140:141], v[140:141], s[72:73], v[12:13]
    v_pk_fma_f32 v[142:143], v[142:143], s[72:73], v[12:13]
    v_pk_mul_f32 v[136:137], v[136:137], v[96:97]
    v_pk_mul_f32 v[138:139], v[138:139], v[98:99]
    v_pk_mul_f32 v[140:141], v[140:141], v[124:125]
    v_pk_mul_f32 v[142:143], v[142:143], v[126:127]
    v_exp_f32 v136, v136
    v_exp_f32 v137, v137
    v_exp_f32 v138, v138
    v_exp_f32 v139, v139
    v_exp_f32 v140, v140
    v_exp_f32 v141, v141
    v_exp_f32 v142, v142
    v_exp_f32 v143, v143
    v_pk_add_f32 v[136:137], v[136:137], 1.0 op_sel_hi:[1,0]
    v_pk_add_f32 v[138:139], v[138:139], 1.0 op_sel_hi:[1,0]
    v_pk_add_f32 v[140:141], v[140:141], 1.0 op_sel_hi:[1,0]
    v_pk_add_f32 v[142:143], v[142:143], 1.0 op_sel_hi:[1,0]
    v_rcp_f32 v136, v136
    v_rcp_f32 v137, v137
    v_rcp_f32 v138, v138
    v_rcp_f32 v139, v139
    v_rcp_f32 v140, v140
    v_rcp_f32 v141, v141
    v_rcp_f32 v142, v142
    v_rcp_f32 v143, v143
    v_pk_mul_f32 v[96:97], v[136:137], v[96:97]
    v_pk_mul_f32 v[98:99], v[138:139], v[98:99]
    v_pk_mul_f32 v[124:125], v[140:141], v[124:125]
    v_pk_mul_f32 v[126:127], v[142:143], v[126:127]
    v_cvt_pk_bf16_f32 v196, v96, v97
    v_cvt_pk_bf16_f32 v197, v98, v99
    v_cvt_pk_bf16_f32 v198, v124, v125
    v_cvt_pk_bf16_f32 v199, v126, v127
    s_add_u32 s70, s70, 114688
    buffer_store_dwordx4 v[196:199], v5, s[24:27], s70 offen sc1
    s_barrier
    ds_read_b64 v[160:161], v9 offset:0
    ds_read_b64 v[164:165], v9 offset:128
    ds_read_b64 v[168:169], v9 offset:256
    ds_read_b64 v[172:173], v9 offset:384
    s_waitcnt lgkmcnt(0)
    v_mov_b32 v162, v161
    v_mov_b32 v163, v161
    v_mov_b32 v161, v160
    v_mov_b32 v166, v165
    v_mov_b32 v167, v165
    v_mov_b32 v165, v164
    v_mov_b32 v170, v169
    v_mov_b32 v171, v169
    v_mov_b32 v169, v168
    v_mov_b32 v174, v173
    v_mov_b32 v175, v173
    v_mov_b32 v173, v172
    v_pk_fma_f32 v[16:17], v[16:17], v[162:163], v[160:161]
    v_pk_fma_f32 v[18:19], v[18:19], v[162:163], v[160:161]
    v_pk_fma_f32 v[44:45], v[44:45], v[166:167], v[164:165]
    v_pk_fma_f32 v[46:47], v[46:47], v[166:167], v[164:165]
    v_cvt_pk_bf16_f32 v208, v16, v17
    v_cvt_pk_bf16_f32 v209, v18, v19
    v_cvt_pk_bf16_f32 v210, v44, v45
    v_cvt_pk_bf16_f32 v211, v46, v47
    ds_write_b64 v10, v[208:209] offset:0
    ds_write_b64 v10, v[210:211] offset:640
    ds_read_b64_tr_b16 v[128:129], v11 offset:0
    ds_read_b64_tr_b16 v[130:131], v11 offset:160
    v_pk_fma_f32 v[20:21], v[20:21], v[162:163], v[160:161]
    v_pk_fma_f32 v[22:23], v[22:23], v[162:163], v[160:161]
    v_pk_fma_f32 v[48:49], v[48:49], v[166:167], v[164:165]
    v_pk_fma_f32 v[50:51], v[50:51], v[166:167], v[164:165]
    v_cvt_pk_bf16_f32 v212, v20, v21
    v_cvt_pk_bf16_f32 v213, v22, v23
    v_cvt_pk_bf16_f32 v214, v48, v49
    v_cvt_pk_bf16_f32 v215, v50, v51
    ds_write_b64 v10, v[212:213] offset:1280
    ds_write_b64 v10, v[214:215] offset:1920
    ds_read_b64_tr_b16 v[132:133], v11 offset:1280
    ds_read_b64_tr_b16 v[134:135], v11 offset:1440
    s_waitcnt lgkmcnt(4)
    buffer_store_dwordx4 v[128:131], v7, s[28:31], s64 offen sc1
    v_pk_fma_f32 v[24:25], v[24:25], v[162:163], v[160:161]
    v_pk_fma_f32 v[26:27], v[26:27], v[162:163], v[160:161]
    v_pk_fma_f32 v[52:53], v[52:53], v[166:167], v[164:165]
    v_pk_fma_f32 v[54:55], v[54:55], v[166:167], v[164:165]
    v_cvt_pk_bf16_f32 v208, v24, v25
    v_cvt_pk_bf16_f32 v209, v26, v27
    v_cvt_pk_bf16_f32 v210, v52, v53
    v_cvt_pk_bf16_f32 v211, v54, v55
    ds_write_b64 v10, v[208:209] offset:2560
    ds_write_b64 v10, v[210:211] offset:3200
    ds_read_b64_tr_b16 v[136:137], v11 offset:2560
    ds_read_b64_tr_b16 v[138:139], v11 offset:2720
    s_waitcnt lgkmcnt(4)
    buffer_store_dwordx4 v[132:135], v7, s[28:31], s65 offen sc1
    v_pk_fma_f32 v[28:29], v[28:29], v[162:163], v[160:161]
    v_pk_fma_f32 v[30:31], v[30:31], v[162:163], v[160:161]
    v_pk_fma_f32 v[56:57], v[56:57], v[166:167], v[164:165]
    v_pk_fma_f32 v[58:59], v[58:59], v[166:167], v[164:165]
    v_cvt_pk_bf16_f32 v212, v28, v29
    v_cvt_pk_bf16_f32 v213, v30, v31
    v_cvt_pk_bf16_f32 v214, v56, v57
    v_cvt_pk_bf16_f32 v215, v58, v59
    ds_write_b64 v10, v[212:213] offset:3840
    ds_write_b64 v10, v[214:215] offset:4480
    ds_read_b64_tr_b16 v[140:141], v11 offset:3840
    ds_read_b64_tr_b16 v[142:143], v11 offset:4000
    s_waitcnt lgkmcnt(4)
    buffer_store_dwordx4 v[136:139], v7, s[28:31], s66 offen sc1
    v_pk_fma_f32 v[72:73], v[72:73], v[170:171], v[168:169]
    v_pk_fma_f32 v[74:75], v[74:75], v[170:171], v[168:169]
    v_pk_fma_f32 v[100:101], v[100:101], v[174:175], v[172:173]
    v_pk_fma_f32 v[102:103], v[102:103], v[174:175], v[172:173]
    v_cvt_pk_bf16_f32 v208, v72, v73
    v_cvt_pk_bf16_f32 v209, v74, v75
    v_cvt_pk_bf16_f32 v210, v100, v101
    v_cvt_pk_bf16_f32 v211, v102, v103
    ds_write_b64 v10, v[208:209] offset:0
    ds_write_b64 v10, v[210:211] offset:640
    ds_read_b64_tr_b16 v[144:145], v11 offset:0
    ds_read_b64_tr_b16 v[146:147], v11 offset:160
    s_waitcnt lgkmcnt(4)
    buffer_store_dwordx4 v[140:143], v7, s[28:31], s67 offen sc1
    v_pk_fma_f32 v[76:77], v[76:77], v[170:171], v[168:169]
    v_pk_fma_f32 v[78:79], v[78:79], v[170:171], v[168:169]
    v_pk_fma_f32 v[104:105], v[104:105], v[174:175], v[172:173]
    v_pk_fma_f32 v[106:107], v[106:107], v[174:175], v[172:173]
    v_cvt_pk_bf16_f32 v212, v76, v77
    v_cvt_pk_bf16_f32 v213, v78, v79
    v_cvt_pk_bf16_f32 v214, v104, v105
    v_cvt_pk_bf16_f32 v215, v106, v107
    ds_write_b64 v10, v[212:213] offset:1280
    ds_write_b64 v10, v[214:215] offset:1920
    ds_read_b64_tr_b16 v[148:149], v11 offset:1280
    ds_read_b64_tr_b16 v[150:151], v11 offset:1440
    s_waitcnt lgkmcnt(4)
    s_add_u32 s64, s64, 7168
    buffer_store_dwordx4 v[144:147], v7, s[28:31], s64 offen sc1
    v_pk_fma_f32 v[80:81], v[80:81], v[170:171], v[168:169]
    v_pk_fma_f32 v[82:83], v[82:83], v[170:171], v[168:169]
    v_pk_fma_f32 v[108:109], v[108:109], v[174:175], v[172:173]
    v_pk_fma_f32 v[110:111], v[110:111], v[174:175], v[172:173]
    v_cvt_pk_bf16_f32 v208, v80, v81
    v_cvt_pk_bf16_f32 v209, v82, v83
    v_cvt_pk_bf16_f32 v210, v108, v109
    v_cvt_pk_bf16_f32 v211, v110, v111
    ds_write_b64 v10, v[208:209] offset:2560
    ds_write_b64 v10, v[210:211] offset:3200
    ds_read_b64_tr_b16 v[152:153], v11 offset:2560
    ds_read_b64_tr_b16 v[154:155], v11 offset:2720
    s_waitcnt lgkmcnt(4)
    s_add_u32 s65, s65, 7168
    buffer_store_dwordx4 v[148:151], v7, s[28:31], s65 offen sc1
    v_pk_fma_f32 v[84:85], v[84:85], v[170:171], v[168:169]
    v_pk_fma_f32 v[86:87], v[86:87], v[170:171], v[168:169]
    v_pk_fma_f32 v[112:113], v[112:113], v[174:175], v[172:173]
    v_pk_fma_f32 v[114:115], v[114:115], v[174:175], v[172:173]
    v_cvt_pk_bf16_f32 v212, v84, v85
    v_cvt_pk_bf16_f32 v213, v86, v87
    v_cvt_pk_bf16_f32 v214, v112, v113
    v_cvt_pk_bf16_f32 v215, v114, v115
    ds_write_b64 v10, v[212:213] offset:3840
    ds_write_b64 v10, v[214:215] offset:4480
    ds_read_b64_tr_b16 v[156:157], v11 offset:3840
    ds_read_b64_tr_b16 v[158:159], v11 offset:4000
    s_waitcnt lgkmcnt(4)
    s_add_u32 s66, s66, 7168
    buffer_store_dwordx4 v[152:155], v7, s[28:31], s66 offen sc1
    s_waitcnt lgkmcnt(0)
    s_add_u32 s67, s67, 7168
    buffer_store_dwordx4 v[156:159], v7, s[28:31], s67 offen sc1
win_epi_done:
    s_waitcnt vmcnt(0)
    s_barrier
    s_lshr_b32 s40, s43, 1
    s_and_b32 s41, s43, 1
    s_lshl_b32 s40, s40, 2
    s_lshl_b32 s41, s41, 3
    s_lshr_b32 s46, s44, 3
    s_and_b32 s47, s44, 7
    s_add_u32 s40, s40, s46
    s_add_u32 s41, s41, s47
    s_add_u32 s24, s4, 34603008
    s_addc_u32 s25, s5, 0
    s_mov_b32 s26, 7340032
    s_mov_b32 s27, 0x20000
    s_mov_b32 s28, s16
    s_mov_b32 s29, s17
    s_mov_b32 s30, 4096
    s_mov_b32 s31, 0x20000
    s_add_u32 s32, s4, 49283072
    s_addc_u32 s33, s5, 0
    s_mov_b32 s34, 7397376
    s_mov_b32 s35, 0x20000
    s_mov_b32 s54, 0
    s_lshl_b32 s53, s42, 5
    s_lshl_b32 s56, s40, 2
    s_add_u32 s56, s56, s42
    s_mul_i32 s57, s56, 112
    s_mul_i32 s58, s41, 7
    s_add_u32 s57, s57, s58
    s_lshl_b32 s57, s57, 10
    s_lshl_b32 s58, s56, 6
    v_and_b32 v7, 15, v1
    v_lshlrev_b32 v7, 1, v7
    buffer_load_ushort v184, v7, s[28:31], s58 offen
    buffer_load_ushort v185, v7, s[28:31], s58 offen offset:32
    v_and_b32 v3, 15, v1
    v_lshrrev_b32 v4, 4, v1
    v_add_u32 v5, s53, v3
    v_lshrrev_b32 v6, 1, v3
    v_add_u32 v7, 0, v4
    v_xor_b32 v7, v7, v6
    v_lshlrev_b32 v7, 4, v7
    v_lshl_add_u32 v144, v5, 7, v7
    v_add_u32 v7, 4, v4
    v_xor_b32 v7, v7, v6
    v_lshlrev_b32 v7, 4, v7
    v_lshl_add_u32 v145, v5, 7, v7
    v_lshrrev_b32 v4, 4, v1
    v_bfe_u32 v6, v1, 2, 2
    v_and_b32 v7, 3, v1
    v_mul_u32_u24 v8, 1792, v4
    v_and_b32 v9, 15, v1
    v_lshl_add_u32 v8, v9, 4, v8
    v_add_u32 v146, 16384, v8
    v_mov_b32 v16, 0
    v_mov_b32 v17, 0
    v_mov_b32 v18, 0
    v_mov_b32 v19, 0
    v_mov_b32 v20, 0
    v_mov_b32 v21, 0
    v_mov_b32 v22, 0
    v_mov_b32 v23, 0
    v_mov_b32 v24, 0
    v_mov_b32 v25, 0
    v_mov_b32 v26, 0
    v_mov_b32 v27, 0
    v_mov_b32 v28, 0
    v_mov_b32 v29, 0
    v_mov_b32 v30, 0
    v_mov_b32 v31, 0
    v_mov_b32 v32, 0
    v_mov_b32 v33, 0
    v_mov_b32 v34, 0
    v_mov_b32 v35, 0
    v_mov_b32 v36, 0
    v_mov_b32 v37, 0
    v_mov_b32 v38, 0
    v_mov_b32 v39, 0
    v_mov_b32 v40, 0
    v_mov_b32 v41, 0
    v_mov_b32 v42, 0
    v_mov_b32 v43, 0
    v_mov_b32 v44, 0
    v_mov_b32 v45, 0
    v_mov_b32 v46, 0
    v_mov_b32 v47, 0
    v_mov_b32 v48, 0
    v_mov_b32 v49, 0
    v_mov_b32 v50, 0
    v_mov_b32 v51, 0
    v_mov_b32 v52, 0
    v_mov_b32 v53, 0
    v_mov_b32 v54, 0
    v_mov_b32 v55, 0
    v_mov_b32 v56, 0
    v_mov_b32 v57, 0
    v_mov_b32 v58, 0
    v_mov_b32 v59, 0
    v_mov_b32 v60, 0
    v_mov_b32 v61, 0
    v_mov_b32 v62, 0
    v_mov_b32 v63, 0
    v_mov_b32 v64, 0
    v_mov_b32 v65, 0
    v_mov_b32 v66, 0
    v_mov_b32 v67, 0
    v_mov_b32 v68, 0
    v_mov_b32 v69, 0
    v_mov_b32 v70, 0
    v_mov_b32 v71, 0
    s_mov_b32 s46, 0
    s_mov_b32 s47, 31
    s_mov_b32 s49, 30720
    v_lshlrev_b32 v14, 4, v1
    v_add_u32 v15, 4096, v14
    s_barrier
    s_add_u32 s46, s46, 30720
    s_cmp_eq_u32 s46, 153600
    s_cselect_b32 s48, 4294844416, s49
    s_cselect_b32 s46, 0, s46
    s_barrier
    ds_read_b128 v[72:75], v144 offset:0
    ds_read_b128 v[80:83], v146 offset:0
    ds_read_b128 v[76:79], v144 offset:2048
    ds_read_b128 v[84:87], v146 offset:256
    ds_read_b128 v[88:91], v146 offset:512
    ds_read_b128 v[92:95], v146 offset:768
    ds_read_b128 v[96:99], v146 offset:1024
    ds_read_b128 v[100:103], v146 offset:1280
    ds_read_b128 v[104:107], v146 offset:1536
    buffer_load_dwordx4 v[156:159], v14, s[24:27], s57 offen offset:0 sc1
    buffer_load_dwordx4 v[160:163], v14, s[24:27], s57 offen offset:1024 sc1
    buffer_load_dwordx4 v[164:167], v14, s[24:27], s57 offen offset:2048 sc1
    buffer_load_dwordx4 v[168:171], v14, s[24:27], s57 offen offset:3072 sc1
    buffer_load_dwordx4 v[172:175], v15, s[24:27], s57 offen offset:0 sc1
    buffer_load_dwordx4 v[176:179], v15, s[24:27], s57 offen offset:1024 sc1
    buffer_load_dwordx4 v[180:183], v15, s[24:27], s57 offen offset:2048 sc1
    s_mov_b32 s47, 15
wsp_loop:
    s_waitcnt lgkmcnt(0)
    v_mfma_f32_16x16x32_bf16 v[16:19], v[80:83], v[72:75], v[16:19]
    ds_read_b128 v[108:111], v145 offset:0
    v_mfma_f32_16x16x32_bf16 v[44:47], v[80:83], v[76:79], v[44:47]
    ds_read_b128 v[116:119], v146 offset:7168
    v_mfma_f32_16x16x32_bf16 v[48:51], v[84:87], v[76:79], v[48:51]
    ds_read_b128 v[112:115], v145 offset:2048
    v_mfma_f32_16x16x32_bf16 v[20:23], v[84:87], v[72:75], v[20:23]
    ds_read_b128 v[120:123], v146 offset:7424
    v_mfma_f32_16x16x32_bf16 v[24:27], v[88:91], v[72:75], v[24:27]
    ds_read_b128 v[124:127], v146 offset:7680
    v_mfma_f32_16x16x32_bf16 v[52:55], v[88:91], v[76:79], v[52:55]
    ds_read_b128 v[128:131], v146 offset:7936
    v_mfma_f32_16x16x32_bf16 v[56:59], v[92:95], v[76:79], v[56:59]
    ds_read_b128 v[132:135], v146 offset:8192
    v_mfma_f32_16x16x32_bf16 v[28:31], v[92:95], v[72:75], v[28:31]
    ds_read_b128 v[136:139], v146 offset:8448
    v_mfma_f32_16x16x32_bf16 v[32:35], v[96:99], v[72:75], v[32:35]
    ds_read_b128 v[140:143], v146 offset:8704
    v_mfma_f32_16x16x32_bf16 v[60:63], v[96:99], v[76:79], v[60:63]
    v_add_u32 v147, s48, v144
    v_mfma_f32_16x16x32_bf16 v[64:67], v[100:103], v[76:79], v[64:67]
    v_add_u32 v148, s48, v145
    v_mfma_f32_16x16x32_bf16 v[36:39], v[100:103], v[72:75], v[36:39]
    v_add_u32 v149, s48, v146
    v_mfma_f32_16x16x32_bf16 v[40:43], v[104:107], v[72:75], v[40:43]
    v_mfma_f32_16x16x32_bf16 v[68:71], v[104:107], v[76:79], v[68:71]
    s_waitcnt lgkmcnt(0)
    s_barrier
    v_mfma_f32_16x16x32_bf16 v[16:19], v[116:119], v[108:111], v[16:19]
    ds_read_b128 v[72:75], v147 offset:0
    v_mfma_f32_16x16x32_bf16 v[44:47], v[116:119], v[112:115], v[44:47]
    ds_read_b128 v[80:83], v149 offset:0
    v_mfma_f32_16x16x32_bf16 v[48:51], v[120:123], v[112:115], v[48:51]
    ds_read_b128 v[76:79], v147 offset:2048
    v_mfma_f32_16x16x32_bf16 v[20:23], v[120:123], v[108:111], v[20:23]
    ds_read_b128 v[84:87], v149 offset:256
    v_mfma_f32_16x16x32_bf16 v[24:27], v[124:127], v[108:111], v[24:27]
    ds_read_b128 v[88:91], v149 offset:512
    v_mfma_f32_16x16x32_bf16 v[52:55], v[124:127], v[112:115], v[52:55]
    ds_read_b128 v[92:95], v149 offset:768
    v_mfma_f32_16x16x32_bf16 v[56:59], v[128:131], v[112:115], v[56:59]
    ds_read_b128 v[96:99], v149 offset:1024
    v_mfma_f32_16x16x32_bf16 v[28:31], v[128:131], v[108:111], v[28:31]
    ds_read_b128 v[100:103], v149 offset:1280
    v_mfma_f32_16x16x32_bf16 v[32:35], v[132:135], v[108:111], v[32:35]
    ds_read_b128 v[104:107], v149 offset:1536
    v_mfma_f32_16x16x32_bf16 v[60:63], v[132:135], v[112:115], v[60:63]
    s_add_u32 s46, s46, 30720
    v_mfma_f32_16x16x32_bf16 v[64:67], v[136:139], v[112:115], v[64:67]
    s_cmp_eq_u32 s46, 153600
    v_mfma_f32_16x16x32_bf16 v[36:39], v[136:139], v[108:111], v[36:39]
    s_cselect_b32 s48, 4294844416, s49
    v_mfma_f32_16x16x32_bf16 v[40:43], v[140:143], v[108:111], v[40:43]
    s_cselect_b32 s46, 0, s46
    v_mfma_f32_16x16x32_bf16 v[68:71], v[140:143], v[112:115], v[68:71]
    s_waitcnt lgkmcnt(0)
    v_mfma_f32_16x16x32_bf16 v[16:19], v[80:83], v[72:75], v[16:19]
    ds_read_b128 v[108:111], v148 offset:0
    v_mfma_f32_16x16x32_bf16 v[44:47], v[80:83], v[76:79], v[44:47]
    ds_read_b128 v[116:119], v149 offset:7168
    v_mfma_f32_16x16x32_bf16 v[48:51], v[84:87], v[76:79], v[48:51]
    ds_read_b128 v[112:115], v148 offset:2048
    v_mfma_f32_16x16x32_bf16 v[20:23], v[84:87], v[72:75], v[20:23]
    ds_read_b128 v[120:123], v149 offset:7424
    v_mfma_f32_16x16x32_bf16 v[24:27], v[88:91], v[72:75], v[24:27]
    ds_read_b128 v[124:127], v149 offset:7680
    v_mfma_f32_16x16x32_bf16 v[52:55], v[88:91], v[76:79], v[52:55]
    ds_read_b128 v[128:131], v149 offset:7936
    v_mfma_f32_16x16x32_bf16 v[56:59], v[92:95], v[76:79], v[56:59]
    ds_read_b128 v[132:135], v149 offset:8192
    v_mfma_f32_16x16x32_bf16 v[28:31], v[92:95], v[72:75], v[28:31]
    ds_read_b128 v[136:139], v149 offset:8448
    v_mfma_f32_16x16x32_bf16 v[32:35], v[96:99], v[72:75], v[32:35]
    ds_read_b128 v[140:143], v149 offset:8704
    v_mfma_f32_16x16x32_bf16 v[60:63], v[96:99], v[76:79], v[60:63]
    v_add_u32 v144, s48, v147
    v_mfma_f32_16x16x32_bf16 v[64:67], v[100:103], v[76:79], v[64:67]
    v_add_u32 v145, s48, v148
    v_mfma_f32_16x16x32_bf16 v[36:39], v[100:103], v[72:75], v[36:39]
    v_add_u32 v146, s48, v149
    v_mfma_f32_16x16x32_bf16 v[40:43], v[104:107], v[72:75], v[40:43]
    v_mfma_f32_16x16x32_bf16 v[68:71], v[104:107], v[76:79], v[68:71]
    s_waitcnt lgkmcnt(0)
    s_barrier
    v_mfma_f32_16x16x32_bf16 v[16:19], v[116:119], v[108:111], v[16:19]
    ds_read_b128 v[72:75], v144 offset:0
    v_mfma_f32_16x16x32_bf16 v[44:47], v[116:119], v[112:115], v[44:47]
    ds_read_b128 v[80:83], v146 offset:0
    v_mfma_f32_16x16x32_bf16 v[48:51], v[120:123], v[112:115], v[48:51]
    ds_read_b128 v[76:79], v144 offset:2048
    v_mfma_f32_16x16x32_bf16 v[20:23], v[120:123], v[108:111], v[20:23]
    ds_read_b128 v[84:87], v146 offset:256
    v_mfma_f32_16x16x32_bf16 v[24:27], v[124:127], v[108:111], v[24:27]
    ds_read_b128 v[88:91], v146 offset:512
    v_mfma_f32_16x16x32_bf16 v[52:55], v[124:127], v[112:115], v[52:55]
    ds_read_b128 v[92:95], v146 offset:768
    v_mfma_f32_16x16x32_bf16 v[56:59], v[128:131], v[112:115], v[56:59]
    ds_read_b128 v[96:99], v146 offset:1024
    v_mfma_f32_16x16x32_bf16 v[28:31], v[128:131], v[108:111], v[28:31]
    ds_read_b128 v[100:103], v146 offset:1280
    v_mfma_f32_16x16x32_bf16 v[32:35], v[132:135], v[108:111], v[32:35]
    ds_read_b128 v[104:107], v146 offset:1536
    v_mfma_f32_16x16x32_bf16 v[60:63], v[132:135], v[112:115], v[60:63]
    s_add_u32 s46, s46, 30720
    v_mfma_f32_16x16x32_bf16 v[64:67], v[136:139], v[112:115], v[64:67]
    s_cmp_eq_u32 s46, 153600
    v_mfma_f32_16x16x32_bf16 v[36:39], v[136:139], v[108:111], v[36:39]
    s_cselect_b32 s48, 4294844416, s49
    v_mfma_f32_16x16x32_bf16 v[40:43], v[140:143], v[108:111], v[40:43]
    s_cselect_b32 s46, 0, s46
    v_mfma_f32_16x16x32_bf16 v[68:71], v[140:143], v[112:115], v[68:71]
    s_sub_u32 s47, s47, 1
    s_cmp_lg_u32 s47, 0
    s_cbranch_scc1 wsp_loop
    s_waitcnt lgkmcnt(0)
    v_mfma_f32_16x16x32_bf16 v[16:19], v[80:83], v[72:75], v[16:19]
    ds_read_b128 v[108:111], v145 offset:0
    v_mfma_f32_16x16x32_bf16 v[44:47], v[80:83], v[76:79], v[44:47]
    ds_read_b128 v[116:119], v146 offset:7168
    v_mfma_f32_16x16x32_bf16 v[48:51], v[84:87], v[76:79], v[48:51]
    ds_read_b128 v[112:115], v145 offset:2048
    v_mfma_f32_16x16x32_bf16 v[20:23], v[84:87], v[72:75], v[20:23]
    ds_read_b128 v[120:123], v146 offset:7424
    v_mfma_f32_16x16x32_bf16 v[24:27], v[88:91], v[72:75], v[24:27]
    ds_read_b128 v[124:127], v146 offset:7680
    v_mfma_f32_16x16x32_bf16 v[52:55], v[88:91], v[76:79], v[52:55]
    ds_read_b128 v[128:131], v146 offset:7936
    v_mfma_f32_16x16x32_bf16 v[56:59], v[92:95], v[76:79], v[56:59]
    ds_read_b128 v[132:135], v146 offset:8192
    v_mfma_f32_16x16x32_bf16 v[28:31], v[92:95], v[72:75], v[28:31]
    ds_read_b128 v[136:139], v146 offset:8448
    v_mfma_f32_16x16x32_bf16 v[32:35], v[96:99], v[72:75], v[32:35]
    ds_read_b128 v[140:143], v146 offset:8704
    v_mfma_f32_16x16x32_bf16 v[60:63], v[96:99], v[76:79], v[60:63]
    v_add_u32 v147, s48, v144
    v_mfma_f32_16x16x32_bf16 v[64:67], v[100:103], v[76:79], v[64:67]
    v_add_u32 v148, s48, v145
    v_mfma_f32_16x16x32_bf16 v[36:39], v[100:103], v[72:75], v[36:39]
    v_add_u32 v149, s48, v146
    v_mfma_f32_16x16x32_bf16 v[40:43], v[104:107], v[72:75], v[40:43]
    v_mfma_f32_16x16x32_bf16 v[68:71], v[104:107], v[76:79], v[68:71]
    s_waitcnt lgkmcnt(0)
    s_barrier
    v_mfma_f32_16x16x32_bf16 v[16:19], v[116:119], v[108:111], v[16:19]
    ds_read_b128 v[72:75], v147 offset:0
    v_mfma_f32_16x16x32_bf16 v[44:47], v[116:119], v[112:115], v[44:47]
    ds_read_b128 v[80:83], v149 offset:0
    v_mfma_f32_16x16x32_bf16 v[48:51], v[120:123], v[112:115], v[48:51]
    ds_read_b128 v[76:79], v147 offset:2048
    v_mfma_f32_16x16x32_bf16 v[20:23], v[120:123], v[108:111], v[20:23]
    ds_read_b128 v[84:87], v149 offset:256
    v_mfma_f32_16x16x32_bf16 v[24:27], v[124:127], v[108:111], v[24:27]
    ds_read_b128 v[88:91], v149 offset:512
    v_mfma_f32_16x16x32_bf16 v[52:55], v[124:127], v[112:115], v[52:55]
    ds_read_b128 v[92:95], v149 offset:768
    v_mfma_f32_16x16x32_bf16 v[56:59], v[128:131], v[112:115], v[56:59]
    ds_read_b128 v[96:99], v149 offset:1024
    v_mfma_f32_16x16x32_bf16 v[28:31], v[128:131], v[108:111], v[28:31]
    ds_read_b128 v[100:103], v149 offset:1280
    v_mfma_f32_16x16x32_bf16 v[32:35], v[132:135], v[108:111], v[32:35]
    ds_read_b128 v[104:107], v149 offset:1536
    v_mfma_f32_16x16x32_bf16 v[60:63], v[132:135], v[112:115], v[60:63]
    s_add_u32 s46, s46, 30720
    v_mfma_f32_16x16x32_bf16 v[64:67], v[136:139], v[112:115], v[64:67]
    s_cmp_eq_u32 s46, 153600
    v_mfma_f32_16x16x32_bf16 v[36:39], v[136:139], v[108:111], v[36:39]
    s_cselect_b32 s48, 4294844416, s49
    v_mfma_f32_16x16x32_bf16 v[40:43], v[140:143], v[108:111], v[40:43]
    s_cselect_b32 s46, 0, s46
    v_mfma_f32_16x16x32_bf16 v[68:71], v[140:143], v[112:115], v[68:71]
    s_waitcnt lgkmcnt(0)
    v_mfma_f32_16x16x32_bf16 v[16:19], v[80:83], v[72:75], v[16:19]
    ds_read_b128 v[108:111], v148 offset:0
    v_mfma_f32_16x16x32_bf16 v[44:47], v[80:83], v[76:79], v[44:47]
    ds_read_b128 v[116:119], v149 offset:7168
    v_mfma_f32_16x16x32_bf16 v[48:51], v[84:87], v[76:79], v[48:51]
    ds_read_b128 v[112:115], v148 offset:2048
    v_mfma_f32_16x16x32_bf16 v[20:23], v[84:87], v[72:75], v[20:23]
    ds_read_b128 v[120:123], v149 offset:7424
    v_mfma_f32_16x16x32_bf16 v[24:27], v[88:91], v[72:75], v[24:27]
    ds_read_b128 v[124:127], v149 offset:7680
    v_mfma_f32_16x16x32_bf16 v[52:55], v[88:91], v[76:79], v[52:55]
    ds_read_b128 v[128:131], v149 offset:7936
    v_mfma_f32_16x16x32_bf16 v[56:59], v[92:95], v[76:79], v[56:59]
    ds_read_b128 v[132:135], v149 offset:8192
    v_mfma_f32_16x16x32_bf16 v[28:31], v[92:95], v[72:75], v[28:31]
    ds_read_b128 v[136:139], v149 offset:8448
    v_mfma_f32_16x16x32_bf16 v[32:35], v[96:99], v[72:75], v[32:35]
    ds_read_b128 v[140:143], v149 offset:8704
    v_mfma_f32_16x16x32_bf16 v[60:63], v[96:99], v[76:79], v[60:63]
    v_mfma_f32_16x16x32_bf16 v[64:67], v[100:103], v[76:79], v[64:67]
    v_mfma_f32_16x16x32_bf16 v[36:39], v[100:103], v[72:75], v[36:39]
    v_mfma_f32_16x16x32_bf16 v[40:43], v[104:107], v[72:75], v[40:43]
    v_mfma_f32_16x16x32_bf16 v[68:71], v[104:107], v[76:79], v[68:71]
    s_waitcnt lgkmcnt(0)
    v_mfma_f32_16x16x32_bf16 v[16:19], v[116:119], v[108:111], v[16:19]
    v_mfma_f32_16x16x32_bf16 v[44:47], v[116:119], v[112:115], v[44:47]
    v_mfma_f32_16x16x32_bf16 v[48:51], v[120:123], v[112:115], v[48:51]
    v_mfma_f32_16x16x32_bf16 v[20:23], v[120:123], v[108:111], v[20:23]
    v_mfma_f32_16x16x32_bf16 v[24:27], v[124:127], v[108:111], v[24:27]
    v_mfma_f32_16x16x32_bf16 v[52:55], v[124:127], v[112:115], v[52:55]
    v_mfma_f32_16x16x32_bf16 v[56:59], v[128:131], v[112:115], v[56:59]
    v_mfma_f32_16x16x32_bf16 v[28:31], v[128:131], v[108:111], v[28:31]
    v_mfma_f32_16x16x32_bf16 v[32:35], v[132:135], v[108:111], v[32:35]
    v_mfma_f32_16x16x32_bf16 v[60:63], v[132:135], v[112:115], v[60:63]
    v_mfma_f32_16x16x32_bf16 v[64:67], v[136:139], v[112:115], v[64:67]
    v_mfma_f32_16x16x32_bf16 v[36:39], v[136:139], v[108:111], v[36:39]
    v_mfma_f32_16x16x32_bf16 v[40:43], v[140:143], v[108:111], v[40:43]
    v_mfma_f32_16x16x32_bf16 v[68:71], v[140:143], v[112:115], v[68:71]
    s_mul_i32 s57, s41, 462336
    s_lshl_b32 s58, s56, 9
    s_add_u32 s57, s57, s58
    v_and_b32 v3, 31, v1
    v_lshrrev_b32 v4, 5, v1
    v_mul_u32_u24 v4, 33024, v4
    v_lshl_add_u32 v3, v3, 4, v4
    s_waitcnt vmcnt(0)
    v_lshlrev_b32 v186, 16, v185
    v_lshlrev_b32 v187, 16, v185
    v_lshlrev_b32 v185, 16, v184
    v_lshlrev_b32 v184, 16, v184
    v_lshlrev_b32 v8, 16, v156
    v_and_b32 v9, 0xffff0000, v156
    v_lshlrev_b32 v10, 16, v157
    v_and_b32 v11, 0xffff0000, v157
    v_pk_add_f32 v[16:17], v[16:17], v[184:185]
    v_pk_add_f32 v[18:19], v[18:19], v[184:185]
    v_pk_mul_f32 v[16:17], v[16:17], v[8:9]
    v_pk_mul_f32 v[18:19], v[18:19], v[10:11]
    v_cvt_pk_bf16_f32 v72, v16, v17
    v_cvt_pk_bf16_f32 v73, v18, v19
    v_lshlrev_b32 v8, 16, v158
    v_and_b32 v9, 0xffff0000, v158
    v_lshlrev_b32 v10, 16, v159
    v_and_b32 v11, 0xffff0000, v159
    v_pk_add_f32 v[44:45], v[44:45], v[186:187]
    v_pk_add_f32 v[46:47], v[46:47], v[186:187]
    v_pk_mul_f32 v[44:45], v[44:45], v[8:9]
    v_pk_mul_f32 v[46:47], v[46:47], v[10:11]
    v_cvt_pk_bf16_f32 v74, v44, v45
    v_cvt_pk_bf16_f32 v75, v46, v47
    s_nop 0
    v_permlane16_swap_b32 v72, v74
    v_permlane16_swap_b32 v73, v75
    buffer_store_dwordx4 v[72:75], v3, s[32:35], s57 offen sc1
    s_add_u32 s57, s57, 66048
    v_lshlrev_b32 v8, 16, v160
    v_and_b32 v9, 0xffff0000, v160
    v_lshlrev_b32 v10, 16, v161
    v_and_b32 v11, 0xffff0000, v161
    v_pk_add_f32 v[20:21], v[20:21], v[184:185]
    v_pk_add_f32 v[22:23], v[22:23], v[184:185]
    v_pk_mul_f32 v[20:21], v[20:21], v[8:9]
    v_pk_mul_f32 v[22:23], v[22:23], v[10:11]
    v_cvt_pk_bf16_f32 v76, v20, v21
    v_cvt_pk_bf16_f32 v77, v22, v23
    v_lshlrev_b32 v8, 16, v162
    v_and_b32 v9, 0xffff0000, v162
    v_lshlrev_b32 v10, 16, v163
    v_and_b32 v11, 0xffff0000, v163
    v_pk_add_f32 v[48:49], v[48:49], v[186:187]
    v_pk_add_f32 v[50:51], v[50:51], v[186:187]
    v_pk_mul_f32 v[48:49], v[48:49], v[8:9]
    v_pk_mul_f32 v[50:51], v[50:51], v[10:11]
    v_cvt_pk_bf16_f32 v78, v48, v49
    v_cvt_pk_bf16_f32 v79, v50, v51
    s_nop 0
    v_permlane16_swap_b32 v76, v78
    v_permlane16_swap_b32 v77, v79
    buffer_store_dwordx4 v[76:79], v3, s[32:35], s57 offen sc1
    s_add_u32 s57, s57, 66048
    v_lshlrev_b32 v8, 16, v164
    v_and_b32 v9, 0xffff0000, v164
    v_lshlrev_b32 v10, 16, v165
    v_and_b32 v11, 0xffff0000, v165
    v_pk_add_f32 v[24:25], v[24:25], v[184:185]
    v_pk_add_f32 v[26:27], v[26:27], v[184:185]
    v_pk_mul_f32 v[24:25], v[24:25], v[8:9]
    v_pk_mul_f32 v[26:27], v[26:27], v[10:11]
    v_cvt_pk_bf16_f32 v80, v24, v25
    v_cvt_pk_bf16_f32 v81, v26, v27
    v_lshlrev_b32 v8, 16, v166
    v_and_b32 v9, 0xffff0000, v166
    v_lshlrev_b32 v10, 16, v167
    v_and_b32 v11, 0xffff0000, v167
    v_pk_add_f32 v[52:53], v[52:53], v[186:187]
    v_pk_add_f32 v[54:55], v[54:55], v[186:187]
    v_pk_mul_f32 v[52:53], v[52:53], v[8:9]
    v_pk_mul_f32 v[54:55], v[54:55], v[10:11]
    v_cvt_pk_bf16_f32 v82, v52, v53
    v_cvt_pk_bf16_f32 v83, v54, v55
    s_nop 0
    v_permlane16_swap_b32 v80, v82
    v_permlane16_swap_b32 v81, v83
    buffer_store_dwordx4 v[80:83], v3, s[32:35], s57 offen sc1
    s_add_u32 s57, s57, 66048
    v_lshlrev_b32 v8, 16, v168
    v_and_b32 v9, 0xffff0000, v168
    v_lshlrev_b32 v10, 16, v169
    v_and_b32 v11, 0xffff0000, v169
    v_pk_add_f32 v[28:29], v[28:29], v[184:185]
    v_pk_add_f32 v[30:31], v[30:31], v[184:185]
    v_pk_mul_f32 v[28:29], v[28:29], v[8:9]
    v_pk_mul_f32 v[30:31], v[30:31], v[10:11]
    v_cvt_pk_bf16_f32 v84, v28, v29
    v_cvt_pk_bf16_f32 v85, v30, v31
    v_lshlrev_b32 v8, 16, v170
    v_and_b32 v9, 0xffff0000, v170
    v_lshlrev_b32 v10, 16, v171
    v_and_b32 v11, 0xffff0000, v171
    v_pk_add_f32 v[56:57], v[56:57], v[186:187]
    v_pk_add_f32 v[58:59], v[58:59], v[186:187]
    v_pk_mul_f32 v[56:57], v[56:57], v[8:9]
    v_pk_mul_f32 v[58:59], v[58:59], v[10:11]
    v_cvt_pk_bf16_f32 v86, v56, v57
    v_cvt_pk_bf16_f32 v87, v58, v59
    s_nop 0
    v_permlane16_swap_b32 v84, v86
    v_permlane16_swap_b32 v85, v87
    buffer_store_dwordx4 v[84:87], v3, s[32:35], s57 offen sc1
    s_add_u32 s57, s57, 66048
    v_lshlrev_b32 v8, 16, v172
    v_and_b32 v9, 0xffff0000, v172
    v_lshlrev_b32 v10, 16, v173
    v_and_b32 v11, 0xffff0000, v173
    v_pk_add_f32 v[32:33], v[32:33], v[184:185]
    v_pk_add_f32 v[34:35], v[34:35], v[184:185]
    v_pk_mul_f32 v[32:33], v[32:33], v[8:9]
    v_pk_mul_f32 v[34:35], v[34:35], v[10:11]
    v_cvt_pk_bf16_f32 v72, v32, v33
    v_cvt_pk_bf16_f32 v73, v34, v35
    v_lshlrev_b32 v8, 16, v174
    v_and_b32 v9, 0xffff0000, v174
    v_lshlrev_b32 v10, 16, v175
    v_and_b32 v11, 0xffff0000, v175
    v_pk_add_f32 v[60:61], v[60:61], v[186:187]
    v_pk_add_f32 v[62:63], v[62:63], v[186:187]
    v_pk_mul_f32 v[60:61], v[60:61], v[8:9]
    v_pk_mul_f32 v[62:63], v[62:63], v[10:11]
    v_cvt_pk_bf16_f32 v74, v60, v61
    v_cvt_pk_bf16_f32 v75, v62, v63
    s_nop 0
    v_permlane16_swap_b32 v72, v74
    v_permlane16_swap_b32 v73, v75
    buffer_store_dwordx4 v[72:75], v3, s[32:35], s57 offen sc1
    s_add_u32 s57, s57, 66048
    v_lshlrev_b32 v8, 16, v176
    v_and_b32 v9, 0xffff0000, v176
    v_lshlrev_b32 v10, 16, v177
    v_and_b32 v11, 0xffff0000, v177
    v_pk_add_f32 v[36:37], v[36:37], v[184:185]
    v_pk_add_f32 v[38:39], v[38:39], v[184:185]
    v_pk_mul_f32 v[36:37], v[36:37], v[8:9]
    v_pk_mul_f32 v[38:39], v[38:39], v[10:11]
    v_cvt_pk_bf16_f32 v76, v36, v37
    v_cvt_pk_bf16_f32 v77, v38, v39
    v_lshlrev_b32 v8, 16, v178
    v_and_b32 v9, 0xffff0000, v178
    v_lshlrev_b32 v10, 16, v179
    v_and_b32 v11, 0xffff0000, v179
    v_pk_add_f32 v[64:65], v[64:65], v[186:187]
    v_pk_add_f32 v[66:67], v[66:67], v[186:187]
    v_pk_mul_f32 v[64:65], v[64:65], v[8:9]
    v_pk_mul_f32 v[66:67], v[66:67], v[10:11]
    v_cvt_pk_bf16_f32 v78, v64, v65
    v_cvt_pk_bf16_f32 v79, v66, v67
    s_nop 0
    v_permlane16_swap_b32 v76, v78
    v_permlane16_swap_b32 v77, v79
    buffer_store_dwordx4 v[76:79], v3, s[32:35], s57 offen sc1
    s_add_u32 s57, s57, 66048
    v_lshlrev_b32 v8, 16, v180
    v_and_b32 v9, 0xffff0000, v180
    v_lshlrev_b32 v10, 16, v181
    v_and_b32 v11, 0xffff0000, v181
    v_pk_add_f32 v[40:41], v[40:41], v[184:185]
    v_pk_add_f32 v[42:43], v[42:43], v[184:185]
    v_pk_mul_f32 v[40:41], v[40:41], v[8:9]
    v_pk_mul_f32 v[42:43], v[42:43], v[10:11]
    v_cvt_pk_bf16_f32 v80, v40, v41
    v_cvt_pk_bf16_f32 v81, v42, v43
    v_lshlrev_b32 v8, 16, v182
    v_and_b32 v9, 0xffff0000, v182
    v_lshlrev_b32 v10, 16, v183
    v_and_b32 v11, 0xffff0000, v183
    v_pk_add_f32 v[68:69], v[68:69], v[186:187]
    v_pk_add_f32 v[70:71], v[70:71], v[186:187]
    v_pk_mul_f32 v[68:69], v[68:69], v[8:9]
    v_pk_mul_f32 v[70:71], v[70:71], v[10:11]
    v_cvt_pk_bf16_f32 v82, v68, v69
    v_cvt_pk_bf16_f32 v83, v70, v71
    s_nop 0
    v_permlane16_swap_b32 v80, v82
    v_permlane16_swap_b32 v81, v83
    buffer_store_dwordx4 v[80:83], v3, s[32:35], s57 offen sc1
    s_add_u32 s57, s57, 66048
    s_waitcnt vmcnt(0)
    s_barrier
    s_lshr_b32 s40, s43, 1
    s_and_b32 s41, s43, 1
    s_lshl_b32 s40, s40, 3
    s_lshl_b32 s41, s41, 2
    s_lshr_b32 s46, s44, 2
    s_and_b32 s47, s44, 3
    s_add_u32 s40, s40, s46
    s_add_u32 s41, s41, s47
    s_and_b32 s54, s42, 1
    s_lshr_b32 s53, s42, 1
    s_lshl_b32 s53, s53, 5
    s_mov_b32 s24, s20
    s_mov_b32 s25, s21
    s_mov_b32 s26, 4194304
    s_mov_b32 s27, 0x20000
    s_mov_b32 s28, s4
    s_mov_b32 s29, s5
    s_mov_b32 s30, 65536
    s_mov_b32 s31, 0x20000
    v_cmp_gt_u32 vcc, 32, v0
    s_nop 0
    s_and_saveexec_b64 s[62:63], vcc
    s_cbranch_execz wout_nostage3
    v_lshrrev_b32 v6, 5, v0
    v_and_b32 v7, 31, v0
    v_mov_b32 v8, 12288
    v_mov_b32 v232, 0
    v_lshl_add_u32 v8, v7, 4, v8
    s_lshl_b32 s61, s41, 9
    buffer_load_dwordx4 v[216:219], v8, s[28:31], s61 offen sc1
    s_add_u32 s61, s61, 16384
    buffer_load_dwordx4 v[220:223], v8, s[28:31], s61 offen sc1
    s_add_u32 s61, s61, 16384
    buffer_load_dwordx4 v[224:227], v8, s[28:31], s61 offen sc1
    s_add_u32 s61, s61, 16384
    buffer_load_dwordx4 v[228:231], v8, s[28:31], s61 offen sc1
    s_add_u32 s61, s61, 16384
    v_lshlrev_b32 v9, 4, v0
    v_add_u32 v9, 159744, v9
    s_waitcnt vmcnt(0)
    v_add_f32 v216, v216, v220
    v_add_f32 v224, v224, v228
    v_add_f32 v217, v217, v221
    v_add_f32 v225, v225, v229
    v_add_f32 v218, v218, v222
    v_add_f32 v226, v226, v230
    v_add_f32 v219, v219, v223
    v_add_f32 v227, v227, v231
    v_add_f32 v216, v216, v232
    v_add_f32 v217, v217, v232
    v_add_f32 v218, v218, v232
    v_add_f32 v219, v219, v232
    v_add_f32 v216, v216, v224
    v_add_f32 v217, v217, v225
    v_add_f32 v218, v218, v226
    v_add_f32 v219, v219, v227
    ds_write_b128 v9, v[216:219]
    s_waitcnt lgkmcnt(0)
wout_nostage3:
    s_mov_b64 exec, s[62:63]
    v_and_b32 v3, 31, v1
    v_lshrrev_b32 v4, 5, v1
    v_add_u32 v5, s53, v3
    v_mul_u32_u24 v6, 1024, v4
    v_lshl_add_u32 v160, v5, 4, v6
    v_lshrrev_b32 v4, 4, v1
    v_bfe_u32 v6, v1, 2, 2
    v_and_b32 v7, 3, v1
    v_lshrrev_b32 v8, 1, v4
    v_lshl_add_u32 v8, v8, 3, v6
    v_lshlrev_b32 v8, 7, v8
    v_and_b32 v9, 1, v4
    v_lshl_add_u32 v8, v9, 5, v8
    v_lshl_add_u32 v8, v7, 3, v8
    v_lshrrev_b32 v9, 1, v6
    s_mul_i32 s48, s54, 8192
    s_add_u32 s48, s48, 8192
    v_xor_b32 v10, 0, v9
    v_lshl_add_u32 v161, v10, 6, v8
    v_add_u32 v161, s48, v161
    v_xor_b32 v10, 1, v9
    v_lshl_add_u32 v162, v10, 6, v8
    v_add_u32 v162, s48, v162
    v_add_u32 v160, 73728, v160
    v_add_u32 v161, 73728, v161
    v_add_u32 v162, 73728, v162
    v_mov_b32 v16, 0
    v_mov_b32 v17, 0
    v_mov_b32 v18, 0
    v_mov_b32 v19, 0
    v_mov_b32 v20, 0
    v_mov_b32 v21, 0
    v_mov_b32 v22, 0
    v_mov_b32 v23, 0
    v_mov_b32 v24, 0
    v_mov_b32 v25, 0
    v_mov_b32 v26, 0
    v_mov_b32 v27, 0
    v_mov_b32 v28, 0
    v_mov_b32 v29, 0
    v_mov_b32 v30, 0
    v_mov_b32 v31, 0
    v_mov_b32 v32, 0
    v_mov_b32 v33, 0
    v_mov_b32 v34, 0
    v_mov_b32 v35, 0
    v_mov_b32 v36, 0
    v_mov_b32 v37, 0
    v_mov_b32 v38, 0
    v_mov_b32 v39, 0
    v_mov_b32 v40, 0
    v_mov_b32 v41, 0
    v_mov_b32 v42, 0
    v_mov_b32 v43, 0
    v_mov_b32 v44, 0
    v_mov_b32 v45, 0
    v_mov_b32 v46, 0
    v_mov_b32 v47, 0
    s_mov_b32 s46, 73728
    s_mov_b32 s47, 27
    s_mov_b32 s49, 24576
    v_lshlrev_b32 v164, 16, v240
    v_and_b32 v165, 0xffff0000, v240
    v_lshlrev_b32 v166, 16, v241
    v_and_b32 v167, 0xffff0000, v241
    v_lshlrev_b32 v168, 16, v242
    v_and_b32 v169, 0xffff0000, v242
    v_lshlrev_b32 v170, 16, v243
    v_and_b32 v171, 0xffff0000, v243
    v_lshlrev_b32 v172, 16, v244
    v_and_b32 v173, 0xffff0000, v244
    v_lshlrev_b32 v174, 16, v245
    v_and_b32 v175, 0xffff0000, v245
    v_lshlrev_b32 v176, 16, v246
    v_and_b32 v177, 0xffff0000, v246
    v_lshlrev_b32 v178, 16, v247
    v_and_b32 v179, 0xffff0000, v247
    v_lshlrev_b32 v180, 16, v248
    v_and_b32 v181, 0xffff0000, v248
    v_lshlrev_b32 v182, 16, v249
    v_and_b32 v183, 0xffff0000, v249
    v_lshlrev_b32 v184, 16, v250
    v_and_b32 v185, 0xffff0000, v250
    v_lshlrev_b32 v186, 16, v251
    v_and_b32 v187, 0xffff0000, v251
    v_lshlrev_b32 v188, 16, v252
    v_and_b32 v189, 0xffff0000, v252
    v_lshlrev_b32 v190, 16, v253
    v_and_b32 v191, 0xffff0000, v253
    v_lshlrev_b32 v192, 16, v254
    v_and_b32 v193, 0xffff0000, v254
    v_lshlrev_b32 v194, 16, v255
    v_and_b32 v195, 0xffff0000, v255
    v_and_b32 v3, 31, v1
    v_lshrrev_b32 v4, 5, v1
    s_lshl_b32 s58, s42, 12
    s_add_u32 s58, s58, 24576
    v_and_b32 v7, 7, v3
    v_xor_b32 v7, v7, v4
    v_lshlrev_b32 v12, 7, v3
    v_add_u32 v12, s58, v12
    v_lshrrev_b32 v13, 3, v1
    v_and_b32 v14, 7, v1
    v_xor_b32 v15, v14, v13
    v_lshlrev_b32 v15, 4, v15
    v_lshl_add_u32 v15, v13, 7, v15
    v_add_u32 v15, s58, v15
    v_lshlrev_b32 v13, 11, v13
    v_lshl_add_u32 v13, v14, 4, v13
    s_lshl_b32 s56, s40, 6
    s_add_u32 s56, s56, s53
    s_lshl_b32 s57, s56, 11
    s_lshl_b32 s59, s41, 8
    s_add_u32 s57, s57, s59
    s_lshl_b32 s59, s54, 7
    s_add_u32 s57, s57, s59
    s_barrier
    s_barrier
    ds_read_b128 v[48:51], v160 offset:0
    ds_read_b64_tr_b16 v[52:53], v161 offset:0
    ds_read_b64_tr_b16 v[54:55], v161 offset:512
    ds_read_b64_tr_b16 v[56:57], v162 offset:0
    ds_read_b64_tr_b16 v[58:59], v162 offset:512
    ds_read_b128 v[60:63], v160 offset:2048
    ds_read_b64_tr_b16 v[64:65], v161 offset:2048
    ds_read_b64_tr_b16 v[66:67], v161 offset:2560
    ds_read_b64_tr_b16 v[68:69], v162 offset:2048
    ds_read_b64_tr_b16 v[70:71], v162 offset:2560
    ds_read_b128 v[72:75], v160 offset:4096
    ds_read_b64_tr_b16 v[76:77], v161 offset:4096
    ds_read_b64_tr_b16 v[78:79], v161 offset:4608
    ds_read_b64_tr_b16 v[80:81], v162 offset:4096
    ds_read_b64_tr_b16 v[82:83], v162 offset:4608
    ds_read_b128 v[84:87], v160 offset:6144
    ds_read_b64_tr_b16 v[88:89], v161 offset:6144
    ds_read_b64_tr_b16 v[90:91], v161 offset:6656
    ds_read_b64_tr_b16 v[92:93], v162 offset:6144
    ds_read_b64_tr_b16 v[94:95], v162 offset:6656
    s_add_u32 s46, s46, 24576
    s_cmp_eq_u32 s46, 147456
    s_cselect_b32 s48, 4294844416, s49
    s_cselect_b32 s46, 0, s46
    s_mov_b32 s47, 13
wout_loop:
    s_barrier
    s_waitcnt lgkmcnt(15)
    v_mfma_f32_32x32x16_bf16 v[16:31], v[52:55], v[48:51], v[16:31]
    v_add_u32 v160, s48, v160
    v_add_u32 v161, s48, v161
    v_add_u32 v162, s48, v162
    s_waitcnt lgkmcnt(15)
    v_mfma_f32_32x32x16_bf16 v[32:47], v[56:59], v[48:51], v[32:47]
    ds_read_b128 v[96:99], v160 offset:0
    ds_read_b64_tr_b16 v[100:101], v161 offset:0
    ds_read_b64_tr_b16 v[102:103], v161 offset:512
    s_waitcnt lgkmcnt(15)
    v_mfma_f32_32x32x16_bf16 v[16:31], v[64:67], v[60:63], v[16:31]
    ds_read_b64_tr_b16 v[104:105], v162 offset:0
    ds_read_b64_tr_b16 v[106:107], v162 offset:512
    ds_read_b128 v[108:111], v160 offset:2048
    s_waitcnt lgkmcnt(15)
    v_mfma_f32_32x32x16_bf16 v[32:47], v[68:71], v[60:63], v[32:47]
    ds_read_b64_tr_b16 v[112:113], v161 offset:2048
    ds_read_b64_tr_b16 v[114:115], v161 offset:2560
    ds_read_b64_tr_b16 v[116:117], v162 offset:2048
    s_waitcnt lgkmcnt(15)
    v_mfma_f32_32x32x16_bf16 v[16:31], v[76:79], v[72:75], v[16:31]
    ds_read_b64_tr_b16 v[118:119], v162 offset:2560
    ds_read_b128 v[120:123], v160 offset:4096
    ds_read_b64_tr_b16 v[124:125], v161 offset:4096
    s_waitcnt lgkmcnt(15)
    v_mfma_f32_32x32x16_bf16 v[32:47], v[80:83], v[72:75], v[32:47]
    ds_read_b64_tr_b16 v[126:127], v161 offset:4608
    ds_read_b64_tr_b16 v[128:129], v162 offset:4096
    ds_read_b64_tr_b16 v[130:131], v162 offset:4608
    s_waitcnt lgkmcnt(15)
    v_mfma_f32_32x32x16_bf16 v[16:31], v[88:91], v[84:87], v[16:31]
    ds_read_b128 v[132:135], v160 offset:6144
    ds_read_b64_tr_b16 v[136:137], v161 offset:6144
    ds_read_b64_tr_b16 v[138:139], v161 offset:6656
    s_waitcnt lgkmcnt(15)
    v_mfma_f32_32x32x16_bf16 v[32:47], v[92:95], v[84:87], v[32:47]
    ds_read_b64_tr_b16 v[140:141], v162 offset:6144
    ds_read_b64_tr_b16 v[142:143], v162 offset:6656
    s_add_u32 s46, s46, 24576
    s_cmp_eq_u32 s46, 147456
    s_cselect_b32 s48, 4294844416, s49
    s_cselect_b32 s46, 0, s46
    s_barrier
    s_waitcnt lgkmcnt(15)
    v_mfma_f32_32x32x16_bf16 v[16:31], v[100:103], v[96:99], v[16:31]
    v_add_u32 v160, s48, v160
    v_add_u32 v161, s48, v161
    v_add_u32 v162, s48, v162
    s_waitcnt lgkmcnt(15)
    v_mfma_f32_32x32x16_bf16 v[32:47], v[104:107], v[96:99], v[32:47]
    ds_read_b128 v[48:51], v160 offset:0
    ds_read_b64_tr_b16 v[52:53], v161 offset:0
    ds_read_b64_tr_b16 v[54:55], v161 offset:512
    s_waitcnt lgkmcnt(15)
    v_mfma_f32_32x32x16_bf16 v[16:31], v[112:115], v[108:111], v[16:31]
    ds_read_b64_tr_b16 v[56:57], v162 offset:0
    ds_read_b64_tr_b16 v[58:59], v162 offset:512
    ds_read_b128 v[60:63], v160 offset:2048
    s_waitcnt lgkmcnt(15)
    v_mfma_f32_32x32x16_bf16 v[32:47], v[116:119], v[108:111], v[32:47]
    ds_read_b64_tr_b16 v[64:65], v161 offset:2048
    ds_read_b64_tr_b16 v[66:67], v161 offset:2560
    ds_read_b64_tr_b16 v[68:69], v162 offset:2048
    s_waitcnt lgkmcnt(15)
    v_mfma_f32_32x32x16_bf16 v[16:31], v[124:127], v[120:123], v[16:31]
    ds_read_b64_tr_b16 v[70:71], v162 offset:2560
    ds_read_b128 v[72:75], v160 offset:4096
    ds_read_b64_tr_b16 v[76:77], v161 offset:4096
    s_waitcnt lgkmcnt(15)
    v_mfma_f32_32x32x16_bf16 v[32:47], v[128:131], v[120:123], v[32:47]
    ds_read_b64_tr_b16 v[78:79], v161 offset:4608
    ds_read_b64_tr_b16 v[80:81], v162 offset:4096
    ds_read_b64_tr_b16 v[82:83], v162 offset:4608
    s_waitcnt lgkmcnt(15)
    v_mfma_f32_32x32x16_bf16 v[16:31], v[136:139], v[132:135], v[16:31]
    ds_read_b128 v[84:87], v160 offset:6144
    ds_read_b64_tr_b16 v[88:89], v161 offset:6144
    ds_read_b64_tr_b16 v[90:91], v161 offset:6656
    s_waitcnt lgkmcnt(15)
    v_mfma_f32_32x32x16_bf16 v[32:47], v[140:143], v[132:135], v[32:47]
    ds_read_b64_tr_b16 v[92:93], v162 offset:6144
    ds_read_b64_tr_b16 v[94:95], v162 offset:6656
    s_add_u32 s46, s46, 24576
    s_cmp_eq_u32 s46, 147456
    s_cselect_b32 s48, 4294844416, s49
    s_cselect_b32 s46, 0, s46
    s_sub_u32 s47, s47, 1
    s_cmp_lg_u32 s47, 0
    s_cbranch_scc1 wout_loop
    s_barrier
    s_waitcnt lgkmcnt(15)
    v_mfma_f32_32x32x16_bf16 v[16:31], v[52:55], v[48:51], v[16:31]
    v_add_u32 v160, s48, v160
    v_add_u32 v161, s48, v161
    v_add_u32 v162, s48, v162
    s_waitcnt lgkmcnt(15)
    v_mfma_f32_32x32x16_bf16 v[32:47], v[56:59], v[48:51], v[32:47]
    ds_read_b128 v[96:99], v160 offset:0
    ds_read_b64_tr_b16 v[100:101], v161 offset:0
    ds_read_b64_tr_b16 v[102:103], v161 offset:512
    s_waitcnt lgkmcnt(15)
    v_mfma_f32_32x32x16_bf16 v[16:31], v[64:67], v[60:63], v[16:31]
    ds_read_b64_tr_b16 v[104:105], v162 offset:0
    ds_read_b64_tr_b16 v[106:107], v162 offset:512
    ds_read_b128 v[108:111], v160 offset:2048
    s_waitcnt lgkmcnt(15)
    v_mfma_f32_32x32x16_bf16 v[32:47], v[68:71], v[60:63], v[32:47]
    ds_read_b64_tr_b16 v[112:113], v161 offset:2048
    ds_read_b64_tr_b16 v[114:115], v161 offset:2560
    ds_read_b64_tr_b16 v[116:117], v162 offset:2048
    s_waitcnt lgkmcnt(15)
    v_mfma_f32_32x32x16_bf16 v[16:31], v[76:79], v[72:75], v[16:31]
    ds_read_b64_tr_b16 v[118:119], v162 offset:2560
    ds_read_b128 v[120:123], v160 offset:4096
    ds_read_b64_tr_b16 v[124:125], v161 offset:4096
    s_waitcnt lgkmcnt(15)
    v_mfma_f32_32x32x16_bf16 v[32:47], v[80:83], v[72:75], v[32:47]
    ds_read_b64_tr_b16 v[126:127], v161 offset:4608
    ds_read_b64_tr_b16 v[128:129], v162 offset:4096
    ds_read_b64_tr_b16 v[130:131], v162 offset:4608
    s_waitcnt lgkmcnt(15)
    v_mfma_f32_32x32x16_bf16 v[16:31], v[88:91], v[84:87], v[16:31]
    ds_read_b128 v[132:135], v160 offset:6144
    ds_read_b64_tr_b16 v[136:137], v161 offset:6144
    ds_read_b64_tr_b16 v[138:139], v161 offset:6656
    s_waitcnt lgkmcnt(15)
    v_mfma_f32_32x32x16_bf16 v[32:47], v[92:95], v[84:87], v[32:47]
    ds_read_b64_tr_b16 v[140:141], v162 offset:6144
    ds_read_b64_tr_b16 v[142:143], v162 offset:6656
    s_add_u32 s46, s46, 24576
    s_cmp_eq_u32 s46, 147456
    s_cselect_b32 s48, 4294844416, s49
    s_cselect_b32 s46, 0, s46
    s_waitcnt lgkmcnt(15)
    v_mfma_f32_32x32x16_bf16 v[16:31], v[100:103], v[96:99], v[16:31]
    v_lshrrev_b32 v4, 5, v1
    s_lshl_b32 s58, s54, 8
    s_add_u32 s58, s58, 159744
    s_waitcnt lgkmcnt(15)
    v_mfma_f32_32x32x16_bf16 v[32:47], v[104:107], v[96:99], v[32:47]
    v_lshl_add_u32 v6, v4, 4, s58
    ds_read_b128 v[48:51], v6 offset:0
    ds_read_b128 v[52:55], v6 offset:32
    s_waitcnt lgkmcnt(14)
    v_mfma_f32_32x32x16_bf16 v[16:31], v[112:115], v[108:111], v[16:31]
    ds_read_b128 v[56:59], v6 offset:64
    ds_read_b128 v[60:63], v6 offset:96
    ds_read_b128 v[64:67], v6 offset:128
    s_waitcnt lgkmcnt(15)
    v_mfma_f32_32x32x16_bf16 v[32:47], v[116:119], v[108:111], v[32:47]
    ds_read_b128 v[68:71], v6 offset:160
    ds_read_b128 v[72:75], v6 offset:192
    ds_read_b128 v[76:79], v6 offset:224
    s_waitcnt lgkmcnt(15)
    v_mfma_f32_32x32x16_bf16 v[16:31], v[124:127], v[120:123], v[16:31]
    s_waitcnt lgkmcnt(13)
    v_mfma_f32_32x32x16_bf16 v[32:47], v[128:131], v[120:123], v[32:47]
    s_waitcnt lgkmcnt(10)
    v_mfma_f32_32x32x16_bf16 v[16:31], v[136:139], v[132:135], v[16:31]
    s_waitcnt lgkmcnt(8)
    v_mfma_f32_32x32x16_bf16 v[32:47], v[140:143], v[132:135], v[32:47]
    s_waitcnt lgkmcnt(0)
    s_nop 8
    v_pk_fma_f32 v[16:17], v[16:17], v[48:49], v[164:165]
    v_pk_fma_f32 v[18:19], v[18:19], v[50:51], v[166:167]
    v_pk_fma_f32 v[20:21], v[20:21], v[52:53], v[168:169]
    v_pk_fma_f32 v[22:23], v[22:23], v[54:55], v[170:171]
    v_pk_fma_f32 v[24:25], v[24:25], v[56:57], v[172:173]
    v_pk_fma_f32 v[26:27], v[26:27], v[58:59], v[174:175]
    v_pk_fma_f32 v[28:29], v[28:29], v[60:61], v[176:177]
    v_pk_fma_f32 v[30:31], v[30:31], v[62:63], v[178:179]
    v_cvt_pk_bf16_f32 v144, v16, v17
    v_cvt_pk_bf16_f32 v145, v18, v19
    v_cvt_pk_bf16_f32 v146, v20, v21
    v_cvt_pk_bf16_f32 v147, v22, v23
    v_cvt_pk_bf16_f32 v148, v24, v25
    v_cvt_pk_bf16_f32 v149, v26, v27
    v_cvt_pk_bf16_f32 v150, v28, v29
    v_cvt_pk_bf16_f32 v151, v30, v31
    v_permlane32_swap_b32 v144, v146
    v_permlane32_swap_b32 v145, v147
    v_permlane32_swap_b32 v148, v150
    v_permlane32_swap_b32 v149, v151
    v_xor_b32 v14, 0, v7
    v_lshl_add_u32 v14, v14, 4, v12
    ds_write_b128 v14, v[144:147]
    v_xor_b32 v14, 2, v7
    v_lshl_add_u32 v14, v14, 4, v12
    ds_write_b128 v14, v[148:151]
    v_pk_fma_f32 v[32:33], v[32:33], v[64:65], v[180:181]
    v_pk_fma_f32 v[34:35], v[34:35], v[66:67], v[182:183]
    v_pk_fma_f32 v[36:37], v[36:37], v[68:69], v[184:185]
    v_pk_fma_f32 v[38:39], v[38:39], v[70:71], v[186:187]
    v_pk_fma_f32 v[40:41], v[40:41], v[72:73], v[188:189]
    v_pk_fma_f32 v[42:43], v[42:43], v[74:75], v[190:191]
    v_pk_fma_f32 v[44:45], v[44:45], v[76:77], v[192:193]
    v_pk_fma_f32 v[46:47], v[46:47], v[78:79], v[194:195]
    v_cvt_pk_bf16_f32 v152, v32, v33
    v_cvt_pk_bf16_f32 v153, v34, v35
    v_cvt_pk_bf16_f32 v154, v36, v37
    v_cvt_pk_bf16_f32 v155, v38, v39
    v_cvt_pk_bf16_f32 v156, v40, v41
    v_cvt_pk_bf16_f32 v157, v42, v43
    v_cvt_pk_bf16_f32 v158, v44, v45
    v_cvt_pk_bf16_f32 v159, v46, v47
    v_permlane32_swap_b32 v152, v154
    v_permlane32_swap_b32 v153, v155
    v_permlane32_swap_b32 v156, v158
    v_permlane32_swap_b32 v157, v159
    v_xor_b32 v14, 4, v7
    v_lshl_add_u32 v14, v14, 4, v12
    ds_write_b128 v14, v[152:155]
    v_xor_b32 v14, 6, v7
    v_lshl_add_u32 v14, v14, 4, v12
    ds_write_b128 v14, v[156:159]
    s_waitcnt lgkmcnt(0)
    ds_read_b128 v[48:51], v15 offset:0
    ds_read_b128 v[52:55], v15 offset:1024
    ds_read_b128 v[56:59], v15 offset:2048
    ds_read_b128 v[60:63], v15 offset:3072
    s_waitcnt lgkmcnt(3)
    buffer_store_dwordx4 v[48:51], v13, s[24:27], s57 offen sc1
    s_add_u32 s57, s57, 16384
    s_waitcnt lgkmcnt(2)
    buffer_store_dwordx4 v[52:55], v13, s[24:27], s57 offen sc1
    s_add_u32 s57, s57, 16384
    s_waitcnt lgkmcnt(1)
    buffer_store_dwordx4 v[56:59], v13, s[24:27], s57 offen sc1
    s_add_u32 s57, s57, 16384
    s_waitcnt lgkmcnt(0)
    buffer_store_dwordx4 v[60:63], v13, s[24:27], s57 offen sc1
    s_add_u32 s57, s57, 16384
    s_endpgm
attn_slow0:
    v_mov_b32 v180, 0xff800000
    s_mov_b32 s56, s52
    s_mov_b32 s59, 64
attn_slow0_1:
    s_add_u32 s46, s56, 66048
    buffer_load_dwordx4 v[140:143], v6, s[24:27], s56 offen sc1
    buffer_load_dwordx4 v[144:147], v6, s[24:27], s46 offen sc1
    s_waitcnt vmcnt(0)
    v_mfma_f32_32x32x16_bf16 v[56:71], v[140:143], v[200:203], 0
    v_mfma_f32_32x32x16_bf16 v[56:71], v[144:147], v[204:207], v[56:71]
    s_nop 11
    v_max3_f32 v160, v56, v57, v58
    v_max3_f32 v161, v59, v60, v61
    v_max3_f32 v160, v160, v62, v63
    v_max3_f32 v161, v161, v64, v65
    v_max3_f32 v160, v160, v66, v67
    v_max3_f32 v161, v161, v68, v69
    v_max3_f32 v160, v160, v70, v71
    v_max_f32 v160, v160, v161
    v_max_f32 v180, v180, v160
    s_add_u32 s56, s56, 512
    s_sub_u32 s59, s59, 1
    s_cmp_lg_u32 s59, 0
    s_cbranch_scc1 attn_slow0_1
    v_mov_b32 v161, v180
    s_nop 1
    v_permlane32_swap_b32 v180, v161
    v_max_f32 v180, v180, v161
    v_sub_f32 v24, 0, v180
    v_mov_b32 v25, v24
    v_mov_b32 v26, v24
    v_mov_b32 v27, v24
    v_mov_b32 v28, v24
    v_mov_b32 v29, v24
    v_mov_b32 v30, v24
    v_mov_b32 v31, v24
    v_mov_b32 v32, v24
    v_mov_b32 v33, v24
    v_mov_b32 v34, v24
    v_mov_b32 v35, v24
    v_mov_b32 v36, v24
    v_mov_b32 v37, v24
    v_mov_b32 v38, v24
    v_mov_b32 v39, v24
    v_mov_b32 v96, 0
    v_mov_b32 v97, 0
    v_mov_b32 v98, 0
    v_mov_b32 v99, 0
    v_mov_b32 v100, 0
    v_mov_b32 v101, 0
    v_mov_b32 v102, 0
    v_mov_b32 v103, 0
    v_mov_b32 v104, 0
    v_mov_b32 v105, 0
    v_mov_b32 v106, 0
    v_mov_b32 v107, 0
    v_mov_b32 v108, 0
    v_mov_b32 v109, 0
    v_mov_b32 v110, 0
    v_mov_b32 v111, 0
    v_mov_b32 v128, 0
    v_mov_b32 v129, 0
    v_mov_b32 v130, 0
    v_mov_b32 v131, 0
    s_mov_b32 s56, s52
    s_mov_b32 s57, s50
    s_mov_b32 s59, 64
attn_slow0_2:
    s_add_u32 s46, s56, 66048
    buffer_load_dwordx4 v[140:143], v6, s[24:27], s56 offen sc1
    buffer_load_dwordx4 v[144:147], v6, s[24:27], s46 offen sc1
    buffer_load_dwordx4 v[148:151], v5, s[28:31], s57 offen sc1
    buffer_load_dwordx4 v[152:155], v5, s[28:31], s57 offen offset:1024 sc1
    s_waitcnt vmcnt(0)
    v_mfma_f32_32x32x16_bf16 v[56:71], v[140:143], v[200:203], v[24:39]
    v_mfma_f32_32x32x16_bf16 v[56:71], v[144:147], v[204:207], v[56:71]
    s_nop 11
    v_exp_f32 v56, v56
    v_exp_f32 v57, v57
    v_exp_f32 v58, v58
    v_exp_f32 v59, v59
    v_exp_f32 v60, v60
    v_exp_f32 v61, v61
    v_exp_f32 v62, v62
    v_exp_f32 v63, v63
    v_exp_f32 v64, v64
    v_exp_f32 v65, v65
    v_exp_f32 v66, v66
    v_exp_f32 v67, v67
    v_exp_f32 v68, v68
    v_exp_f32 v69, v69
    v_exp_f32 v70, v70
    v_exp_f32 v71, v71
    v_cvt_pk_bf16_f32 v88, v56, v57
    v_cvt_pk_bf16_f32 v89, v58, v59
    v_cvt_pk_bf16_f32 v90, v60, v61
    v_cvt_pk_bf16_f32 v91, v62, v63
    v_cvt_pk_bf16_f32 v92, v64, v65
    v_cvt_pk_bf16_f32 v93, v66, v67
    v_cvt_pk_bf16_f32 v94, v68, v69
    v_cvt_pk_bf16_f32 v95, v70, v71
    v_mfma_f32_32x32x16_bf16 v[96:111], v[148:151], v[88:91], v[96:111]
    v_mfma_f32_16x16x32_bf16 v[128:131], v[136:139], v[88:91], v[128:131]
    v_mfma_f32_32x32x16_bf16 v[96:111], v[152:155], v[92:95], v[96:111]
    v_mfma_f32_16x16x32_bf16 v[128:131], v[136:139], v[92:95], v[128:131]
    s_add_u32 s56, s56, 512
    s_add_u32 s57, s57, 2048
    s_sub_u32 s59, s59, 1
    s_cmp_lg_u32 s59, 0
    s_nop 7
    s_cbranch_scc1 attn_slow0_2
    s_nop 7
    s_branch attn_fin0
attn_slow1:
    v_mov_b32 v180, 0xff800000
    s_mov_b32 s56, s52
    s_mov_b32 s59, 64
attn_slow1_1:
    s_add_u32 s46, s56, 66048
    buffer_load_dwordx4 v[140:143], v6, s[24:27], s56 offen sc1
    buffer_load_dwordx4 v[144:147], v6, s[24:27], s46 offen sc1
    s_waitcnt vmcnt(0)
    v_mfma_f32_32x32x16_bf16 v[56:71], v[140:143], v[208:211], 0
    v_mfma_f32_32x32x16_bf16 v[56:71], v[144:147], v[212:215], v[56:71]
    s_nop 11
    v_max3_f32 v160, v56, v57, v58
    v_max3_f32 v161, v59, v60, v61
    v_max3_f32 v160, v160, v62, v63
    v_max3_f32 v161, v161, v64, v65
    v_max3_f32 v160, v160, v66, v67
    v_max3_f32 v161, v161, v68, v69
    v_max3_f32 v160, v160, v70, v71
    v_max_f32 v160, v160, v161
    v_max_f32 v180, v180, v160
    s_add_u32 s56, s56, 512
    s_sub_u32 s59, s59, 1
    s_cmp_lg_u32 s59, 0
    s_cbranch_scc1 attn_slow1_1
    v_mov_b32 v161, v180
    s_nop 1
    v_permlane32_swap_b32 v180, v161
    v_max_f32 v180, v180, v161
    v_sub_f32 v40, 0, v180
    v_mov_b32 v41, v40
    v_mov_b32 v42, v40
    v_mov_b32 v43, v40
    v_mov_b32 v44, v40
    v_mov_b32 v45, v40
    v_mov_b32 v46, v40
    v_mov_b32 v47, v40
    v_mov_b32 v48, v40
    v_mov_b32 v49, v40
    v_mov_b32 v50, v40
    v_mov_b32 v51, v40
    v_mov_b32 v52, v40
    v_mov_b32 v53, v40
    v_mov_b32 v54, v40
    v_mov_b32 v55, v40
    v_mov_b32 v112, 0
    v_mov_b32 v113, 0
    v_mov_b32 v114, 0
    v_mov_b32 v115, 0
    v_mov_b32 v116, 0
    v_mov_b32 v117, 0
    v_mov_b32 v118, 0
    v_mov_b32 v119, 0
    v_mov_b32 v120, 0
    v_mov_b32 v121, 0
    v_mov_b32 v122, 0
    v_mov_b32 v123, 0
    v_mov_b32 v124, 0
    v_mov_b32 v125, 0
    v_mov_b32 v126, 0
    v_mov_b32 v127, 0
    v_mov_b32 v132, 0
    v_mov_b32 v133, 0
    v_mov_b32 v134, 0
    v_mov_b32 v135, 0
    s_mov_b32 s56, s52
    s_mov_b32 s57, s50
    s_mov_b32 s59, 64
attn_slow1_2:
    s_add_u32 s46, s56, 66048
    buffer_load_dwordx4 v[140:143], v6, s[24:27], s56 offen sc1
    buffer_load_dwordx4 v[144:147], v6, s[24:27], s46 offen sc1
    buffer_load_dwordx4 v[148:151], v5, s[28:31], s57 offen sc1
    buffer_load_dwordx4 v[152:155], v5, s[28:31], s57 offen offset:1024 sc1
    s_waitcnt vmcnt(0)
    v_mfma_f32_32x32x16_bf16 v[56:71], v[140:143], v[208:211], v[40:55]
    v_mfma_f32_32x32x16_bf16 v[56:71], v[144:147], v[212:215], v[56:71]
    s_nop 11
    v_exp_f32 v56, v56
    v_exp_f32 v57, v57
    v_exp_f32 v58, v58
    v_exp_f32 v59, v59
    v_exp_f32 v60, v60
    v_exp_f32 v61, v61
    v_exp_f32 v62, v62
    v_exp_f32 v63, v63
    v_exp_f32 v64, v64
    v_exp_f32 v65, v65
    v_exp_f32 v66, v66
    v_exp_f32 v67, v67
    v_exp_f32 v68, v68
    v_exp_f32 v69, v69
    v_exp_f32 v70, v70
    v_exp_f32 v71, v71
    v_cvt_pk_bf16_f32 v88, v56, v57
    v_cvt_pk_bf16_f32 v89, v58, v59
    v_cvt_pk_bf16_f32 v90, v60, v61
    v_cvt_pk_bf16_f32 v91, v62, v63
    v_cvt_pk_bf16_f32 v92, v64, v65
    v_cvt_pk_bf16_f32 v93, v66, v67
    v_cvt_pk_bf16_f32 v94, v68, v69
    v_cvt_pk_bf16_f32 v95, v70, v71
    v_mfma_f32_32x32x16_bf16 v[112:127], v[148:151], v[88:91], v[112:127]
    v_mfma_f32_16x16x32_bf16 v[132:135], v[136:139], v[88:91], v[132:135]
    v_mfma_f32_32x32x16_bf16 v[112:127], v[152:155], v[92:95], v[112:127]
    v_mfma_f32_16x16x32_bf16 v[132:135], v[136:139], v[92:95], v[132:135]
    s_add_u32 s56, s56, 512
    s_add_u32 s57, s57, 2048
    s_sub_u32 s59, s59, 1
    s_cmp_lg_u32 s59, 0
    s_nop 7
    s_cbranch_scc1 attn_slow1_2
    s_nop 7
    s_branch attn_fin1
mega_L:
    s_setprio 1
    s_sub_u32 s45, s42, 4
    s_mov_b32 s91, s2
    s_add_u32 s32, s4, 655360
    s_addc_u32 s33, s5, 0
    s_mov_b32 s34, 32768
    s_mov_b32 s35, 0x20000
    s_lshr_b32 s40, s43, 2
    s_and_b32 s41, s43, 3
    s_lshl_b32 s40, s40, 3
    s_lshl_b32 s41, s41, 2
    s_lshr_b32 s46, s44, 2
    s_and_b32 s47, s44, 3
    s_add_u32 s40, s40, s46
    s_add_u32 s41, s41, s47
    s_and_b32 s41, s43, 3
    s_lshl_b32 s47, s47, 2
    s_add_u32 s41, s41, s47
    s_add_u32 s24, s4, 1048576
    s_addc_u32 s25, s5, 0
    s_mov_b32 s26, 4227072
    s_mov_b32 s27, 0x20000
    s_mov_b32 s28, s8
    s_mov_b32 s29, s9
    s_mov_b32 s30, 6291456
    s_mov_b32 s31, 0x20000
    s_lshl_b32 s50, s40, 11
    s_add_u32 s46, s41, 0
    s_and_b32 s46, s46, 15
    s_lshl_b32 s46, s46, 7
    s_add_u32 s51, s46, 0
    s_add_u32 s46, s41, 1
    s_and_b32 s46, s46, 15
    s_lshl_b32 s46, s46, 7
    s_add_u32 s52, s46, 2048
    s_add_u32 s46, s41, 2
    s_and_b32 s46, s46, 15
    s_lshl_b32 s46, s46, 7
    s_add_u32 s53, s46, 4096
    v_lshrrev_b32 v3, 3, v1
    v_and_b32 v4, 7, v1
    v_lshlrev_b32 v5, 4, v1
    s_lshl_b32 s60, s45, 10
    s_lshr_b32 s46, s45, 1
    s_mul_i32 s46, s46, 33024
    s_and_b32 s47, s45, 1
    s_lshl_b32 s47, s47, 10
    s_add_u32 s46, s46, s47
    v_add_u32 v16, s46, v5
    v_add_u32 v17, 66048, v16
    v_add_u32 v18, 132096, v16
    v_add_u32 v19, 198144, v16
    v_bfe_u32 v6, v1, 4, 1
    s_and_b32 s46, s45, 1
    s_lshl_b32 s46, s46, 2
    v_lshlrev_b32 v6, 1, v6
    v_or_b32 v6, s46, v6
    v_xor_b32 v6, v6, v4
    s_lshl_b32 s46, s45, 3
    v_add_u32 v7, s46, v3
    v_mul_u32_u24 v7, 6144, v7
    v_lshl_add_u32 v8, v6, 4, v7
    v_add_u32 v20, 0, v8
    v_add_u32 v21, 196608, v8
    s_barrier
    s_barrier
    s_cmp_eq_u32 s45, 0
    s_cbranch_scc1 qpf_skip
    s_mul_i32 s46, s2, 24576
    s_sub_u32 s47, s45, 1
    s_lshl_b32 s47, s47, 13
    s_add_u32 s46, s46, s47
    v_lshlrev_b32 v5, 4, v1
    s_mov_b32 m0, 162816
    s_nop 0
    buffer_load_dwordx4 v5, s[28:31], s46 offen lds
    s_add_u32 s46, s46, 1024
    buffer_load_dwordx4 v5, s[28:31], s46 offen lds
    s_add_u32 s46, s46, 1024
    buffer_load_dwordx4 v5, s[28:31], s46 offen lds
    s_add_u32 s46, s46, 1024
    buffer_load_dwordx4 v5, s[28:31], s46 offen lds
    s_add_u32 s46, s46, 1024
    buffer_load_dwordx4 v5, s[28:31], s46 offen lds
    s_add_u32 s46, s46, 1024
    buffer_load_dwordx4 v5, s[28:31], s46 offen lds
    s_add_u32 s46, s46, 1024
    buffer_load_dwordx4 v5, s[28:31], s46 offen lds
    s_add_u32 s46, s46, 1024
    buffer_load_dwordx4 v5, s[28:31], s46 offen lds
    s_add_u32 s46, s46, 1024
qpf_skip:
    s_add_u32 m0, s60, 16384
    s_nop 0
    buffer_load_dwordx4 v20, s[28:31], s51 offen lds
    s_add_u32 m0, s60, 20480
    s_nop 0
    buffer_load_dwordx4 v21, s[28:31], s51 offen lds
    s_add_u32 m0, s60, 24576
    s_nop 0
    buffer_load_dwordx4 v20, s[28:31], s52 offen lds
    s_add_u32 m0, s60, 28672
    s_nop 0
    buffer_load_dwordx4 v21, s[28:31], s52 offen lds
    s_add_u32 m0, s60, 32768
    s_nop 0
    buffer_load_dwordx4 v20, s[28:31], s53 offen lds
    s_add_u32 m0, s60, 36864
    s_nop 0
    buffer_load_dwordx4 v21, s[28:31], s53 offen lds
    s_add_u32 s51, s51, 393216
    s_add_u32 s52, s52, 393216
    s_add_u32 s53, s53, 393216
    s_add_u32 m0, s60, 57344
    s_nop 0
    buffer_load_dwordx4 v20, s[28:31], s51 offen lds
    s_add_u32 m0, s60, 61440
    s_nop 0
    buffer_load_dwordx4 v21, s[28:31], s51 offen lds
    s_add_u32 m0, s60, 65536
    s_nop 0
    buffer_load_dwordx4 v20, s[28:31], s52 offen lds
    s_add_u32 m0, s60, 69632
    s_nop 0
    buffer_load_dwordx4 v21, s[28:31], s52 offen lds
    s_add_u32 m0, s60, 73728
    s_nop 0
    buffer_load_dwordx4 v20, s[28:31], s53 offen lds
    s_add_u32 m0, s60, 77824
    s_nop 0
    buffer_load_dwordx4 v21, s[28:31], s53 offen lds
    s_add_u32 s51, s51, 393216
    s_add_u32 s52, s52, 393216
    s_add_u32 s53, s53, 393216
    s_cmp_lg_u32 s45, 0
    s_cbranch_scc1 modl_done
    s_mov_b32 s36, s100
    s_mov_b32 s37, s101
    s_mov_b32 s38, 256
    s_mov_b32 s39, 0x20000
    v_mov_b32 v3, 128
    s_mov_b32 s47, 524288
modl_loop:
    buffer_load_dword v2, v3, s[36:39], 0 offen sc1
    s_waitcnt vmcnt(0)
    v_cmp_eq_u32 vcc, 0, v2
    s_nop 0
    s_cbranch_vccz modl_done
    s_sleep 2
    s_sub_u32 s47, s47, 1
    s_cmp_lg_u32 s47, 0
    s_cbranch_scc1 modl_loop
modl_done:
    s_barrier
    s_barrier
    s_mov_b32 s36, s22
    s_mov_b32 s37, s23
    s_mov_b32 s38, 2048
    s_mov_b32 s39, 0x20000
    s_and_b32 s57, s91, 3
    s_lshl_b32 s57, s57, 9
    s_lshl_b32 s58, s45, 7
    s_add_u32 s57, s57, s58
    v_lshrrev_b32 v138, 4, v1
    v_lshlrev_b32 v138, 4, v138
    buffer_load_dwordx4 v[140:143], v138, s[36:39], s57 offen
    buffer_load_dwordx4 v[144:147], v138, s[36:39], s57 offen offset:64
    s_waitcnt vmcnt(0)
    s_barrier
    s_lshr_b32 s55, s2, 4
    s_cmp_lg_u32 s45, 0
    s_cbranch_scc1 sig_H
    s_add_u32 s46, s55, 0
    s_lshl_b32 s46, s46, 7
    v_mov_b32 v2, 1
    v_mov_b32 v3, 0
    s_mov_b64 exec, 1
    buffer_atomic_add v2, v3, s[32:35], s46 offen sc1
    s_mov_b64 exec, -1
sig_H:
    v_lshlrev_b32 v148, 16, v140
    v_and_b32 v149, 0xffff0000, v140
    v_lshlrev_b32 v150, 16, v141
    v_and_b32 v151, 0xffff0000, v141
    v_lshlrev_b32 v152, 16, v142
    v_and_b32 v153, 0xffff0000, v142
    v_lshlrev_b32 v154, 16, v143
    v_and_b32 v155, 0xffff0000, v143
    v_lshlrev_b32 v156, 16, v144
    v_and_b32 v157, 0xffff0000, v144
    v_lshlrev_b32 v158, 16, v145
    v_and_b32 v159, 0xffff0000, v145
    v_lshlrev_b32 v160, 16, v146
    v_and_b32 v161, 0xffff0000, v146
    v_lshlrev_b32 v162, 16, v147
    v_and_b32 v163, 0xffff0000, v147
    v_mul_f32 v164, 0xbfb8aa3b, v148
    v_mul_f32 v165, 0xbfb8aa3b, v149
    v_mul_f32 v166, 0xbfb8aa3b, v150
    v_mul_f32 v167, 0xbfb8aa3b, v151
    v_mul_f32 v168, 0xbfb8aa3b, v152
    v_mul_f32 v169, 0xbfb8aa3b, v153
    v_mul_f32 v170, 0xbfb8aa3b, v154
    v_mul_f32 v171, 0xbfb8aa3b, v155
    v_mul_f32 v172, 0xbfb8aa3b, v156
    v_mul_f32 v173, 0xbfb8aa3b, v157
    v_mul_f32 v174, 0xbfb8aa3b, v158
    v_mul_f32 v175, 0xbfb8aa3b, v159
    v_mul_f32 v176, 0xbfb8aa3b, v160
    v_mul_f32 v177, 0xbfb8aa3b, v161
    v_mul_f32 v178, 0xbfb8aa3b, v162
    v_mul_f32 v179, 0xbfb8aa3b, v163
    v_exp_f32 v164, v164
    v_exp_f32 v165, v165
    v_exp_f32 v166, v166
    v_exp_f32 v167, v167
    v_exp_f32 v168, v168
    v_exp_f32 v169, v169
    v_exp_f32 v170, v170
    v_exp_f32 v171, v171
    v_exp_f32 v172, v172
    v_exp_f32 v173, v173
    v_exp_f32 v174, v174
    v_exp_f32 v175, v175
    v_exp_f32 v176, v176
    v_exp_f32 v177, v177
    v_exp_f32 v178, v178
    v_exp_f32 v179, v179
    v_add_f32 v164, 1.0, v164
    v_add_f32 v165, 1.0, v165
    v_add_f32 v166, 1.0, v166
    v_add_f32 v167, 1.0, v167
    v_add_f32 v168, 1.0, v168
    v_add_f32 v169, 1.0, v169
    v_add_f32 v170, 1.0, v170
    v_add_f32 v171, 1.0, v171
    v_add_f32 v172, 1.0, v172
    v_add_f32 v173, 1.0, v173
    v_add_f32 v174, 1.0, v174
    v_add_f32 v175, 1.0, v175
    v_add_f32 v176, 1.0, v176
    v_add_f32 v177, 1.0, v177
    v_add_f32 v178, 1.0, v178
    v_add_f32 v179, 1.0, v179
    v_rcp_f32 v164, v164
    v_rcp_f32 v165, v165
    v_rcp_f32 v166, v166
    v_rcp_f32 v167, v167
    v_rcp_f32 v168, v168
    v_rcp_f32 v169, v169
    v_rcp_f32 v170, v170
    v_rcp_f32 v171, v171
    v_rcp_f32 v172, v172
    v_rcp_f32 v173, v173
    v_rcp_f32 v174, v174
    v_rcp_f32 v175, v175
    v_rcp_f32 v176, v176
    v_rcp_f32 v177, v177
    v_rcp_f32 v178, v178
    v_rcp_f32 v179, v179
    v_mul_f32 v148, v148, v164
    v_mul_f32 v149, v149, v165
    v_mul_f32 v150, v150, v166
    v_mul_f32 v151, v151, v167
    v_mul_f32 v152, v152, v168
    v_mul_f32 v153, v153, v169
    v_mul_f32 v154, v154, v170
    v_mul_f32 v155, v155, v171
    v_mul_f32 v156, v156, v172
    v_mul_f32 v157, v157, v173
    v_mul_f32 v158, v158, v174
    v_mul_f32 v159, v159, v175
    v_mul_f32 v160, v160, v176
    v_mul_f32 v161, v161, v177
    v_mul_f32 v162, v162, v178
    v_mul_f32 v163, v163, v179
    v_cvt_pk_bf16_f32 v224, v148, v149
    v_cvt_pk_bf16_f32 v225, v150, v151
    v_cvt_pk_bf16_f32 v226, v152, v153
    v_cvt_pk_bf16_f32 v227, v154, v155
    v_cvt_pk_bf16_f32 v228, v156, v157
    v_cvt_pk_bf16_f32 v229, v158, v159
    v_cvt_pk_bf16_f32 v230, v160, v161
    v_cvt_pk_bf16_f32 v231, v162, v163
    s_cmp_lg_u32 s45, 0
    s_cbranch_scc1 dep_H_done
    s_add_u32 s46, s40, 0
    s_lshl_b32 s46, s46, 7
    s_mov_b32 s47, 524288
    v_mov_b32 v3, 0
    v_mov_b32 v4, 16
dep_H_loop:
    buffer_load_dword v2, v3, s[32:35], s46 offen sc1
    s_waitcnt vmcnt(0)
    v_cmp_gt_u32 vcc, v4, v2
    s_nop 0
    s_cbranch_vccz dep_H_done
    s_sleep 1
    s_sub_u32 s47, s47, 1
    s_cmp_lg_u32 s47, 0
    s_cbranch_scc1 dep_H_loop
dep_H_done:
    s_barrier
    s_add_u32 m0, s60, 0
    s_nop 0
    buffer_load_dwordx4 v16, s[24:27], s50 offen sc1 lds
    s_add_u32 m0, s60, 4096
    s_nop 0
    buffer_load_dwordx4 v17, s[24:27], s50 offen sc1 lds
    s_add_u32 m0, s60, 8192
    s_nop 0
    buffer_load_dwordx4 v18, s[24:27], s50 offen sc1 lds
    s_add_u32 m0, s60, 12288
    s_nop 0
    buffer_load_dwordx4 v19, s[24:27], s50 offen sc1 lds
    s_add_u32 s50, s50, 264192
    s_add_u32 m0, s60, 40960
    s_nop 0
    buffer_load_dwordx4 v16, s[24:27], s50 offen sc1 lds
    s_add_u32 m0, s60, 45056
    s_nop 0
    buffer_load_dwordx4 v17, s[24:27], s50 offen sc1 lds
    s_add_u32 m0, s60, 49152
    s_nop 0
    buffer_load_dwordx4 v18, s[24:27], s50 offen sc1 lds
    s_add_u32 m0, s60, 53248
    s_nop 0
    buffer_load_dwordx4 v19, s[24:27], s50 offen sc1 lds
    s_add_u32 s50, s50, 264192
    s_waitcnt vmcnt(4)
    s_barrier
    s_add_u32 m0, s60, 81920
    s_nop 0
    buffer_load_dwordx4 v16, s[24:27], s50 offen sc1 lds
    s_add_u32 m0, s60, 86016
    s_nop 0
    buffer_load_dwordx4 v17, s[24:27], s50 offen sc1 lds
    s_add_u32 m0, s60, 90112
    s_nop 0
    buffer_load_dwordx4 v18, s[24:27], s50 offen sc1 lds
    s_add_u32 m0, s60, 94208
    s_nop 0
    buffer_load_dwordx4 v19, s[24:27], s50 offen sc1 lds
    s_add_u32 m0, s60, 98304
    s_nop 0
    buffer_load_dwordx4 v20, s[28:31], s51 offen lds
    s_add_u32 m0, s60, 102400
    s_nop 0
    buffer_load_dwordx4 v21, s[28:31], s51 offen lds
    s_add_u32 m0, s60, 106496
    s_nop 0
    buffer_load_dwordx4 v20, s[28:31], s52 offen lds
    s_add_u32 m0, s60, 110592
    s_nop 0
    buffer_load_dwordx4 v21, s[28:31], s52 offen lds
    s_add_u32 m0, s60, 114688
    s_nop 0
    buffer_load_dwordx4 v20, s[28:31], s53 offen lds
    s_add_u32 m0, s60, 118784
    s_nop 0
    buffer_load_dwordx4 v21, s[28:31], s53 offen lds
    s_add_u32 s50, s50, 264192
    s_add_u32 s51, s51, 393216
    s_add_u32 s52, s52, 393216
    s_add_u32 s53, s53, 393216
    s_mov_b32 s46, 0
    s_mov_b32 s47, 13
qkv_ldloopB:
    s_add_u32 s62, s46, s60
    s_waitcnt vmcnt(10)
    s_barrier
    s_add_u32 m0, s62, 0
    s_nop 0
    buffer_load_dwordx4 v16, s[24:27], s50 offen sc1 lds
    s_add_u32 m0, s62, 4096
    s_nop 0
    buffer_load_dwordx4 v17, s[24:27], s50 offen sc1 lds
    s_add_u32 m0, s62, 8192
    s_nop 0
    buffer_load_dwordx4 v18, s[24:27], s50 offen sc1 lds
    s_add_u32 m0, s62, 12288
    s_nop 0
    buffer_load_dwordx4 v19, s[24:27], s50 offen sc1 lds
    s_add_u32 m0, s62, 16384
    s_nop 0
    buffer_load_dwordx4 v20, s[28:31], s51 offen lds
    s_add_u32 m0, s62, 20480
    s_nop 0
    buffer_load_dwordx4 v21, s[28:31], s51 offen lds
    s_add_u32 m0, s62, 24576
    s_nop 0
    buffer_load_dwordx4 v20, s[28:31], s52 offen lds
    s_add_u32 m0, s62, 28672
    s_nop 0
    buffer_load_dwordx4 v21, s[28:31], s52 offen lds
    s_add_u32 m0, s62, 32768
    s_nop 0
    buffer_load_dwordx4 v20, s[28:31], s53 offen lds
    s_add_u32 m0, s62, 36864
    s_nop 0
    buffer_load_dwordx4 v21, s[28:31], s53 offen lds
    s_add_u32 s50, s50, 264192
    s_add_u32 s51, s51, 393216
    s_add_u32 s52, s52, 393216
    s_add_u32 s53, s53, 393216
    s_add_u32 s46, s46, 40960
    s_cmp_eq_u32 s46, 122880
    s_cselect_b32 s46, 0, s46
    s_sub_u32 s47, s47, 1
    s_cmp_lg_u32 s47, 0
    s_cbranch_scc1 qkv_ldloopB
    s_waitcnt vmcnt(10)
    s_barrier
    s_waitcnt vmcnt(0)
    s_barrier
    s_lshl_b32 s83, s41, 3
    s_lshr_b32 s46, s40, 1
    s_add_u32 s83, s83, s46
    s_add_u32 s24, s4, 6291456
    s_addc_u32 s25, s5, 0
    s_mov_b32 s26, 8454144
    s_mov_b32 s27, 0x20000
    s_add_u32 s28, s4, 15728640
    s_addc_u32 s29, s5, 0
    s_mov_b32 s30, 4194304
    s_mov_b32 s31, 0x20000
    v_lshlrev_b32 v5, 4, v1
    s_lshl_b32 s60, s45, 10
    s_lshr_b32 s46, s45, 1
    s_and_b32 s47, s45, 1
    s_lshl_b32 s53, s46, 14
    s_lshl_b32 s54, s47, 12
    s_add_u32 s54, s54, s53
    s_lshl_b32 s48, s47, 10
    s_add_u32 s53, s53, s48
    v_add_u32 v16, s48, v5
    s_lshl_b32 s48, s47, 12
    v_add_u32 v20, s48, v5
    v_add_u32 v17, 33024, v16
    v_add_u32 v21, 1024, v20
    v_add_u32 v18, 66048, v16
    v_add_u32 v22, 2048, v20
    v_add_u32 v19, 99072, v16
    v_add_u32 v23, 3072, v20
    s_lshl_b32 s47, s41, 1
    s_add_u32 s46, s46, s47
    s_lshl_b32 s51, s46, 17
    s_mul_i32 s50, s46, 132096
    s_add_u32 s50, s50, 4227072
    s_lshl_b32 s46, s2, 2
    s_add_u32 s46, s46, s45
    s_lshl_b32 s46, s46, 10
    v_add_u32 v24, s46, v5
    s_mov_b32 s64, s10
    s_mov_b32 s65, s11
    s_mov_b32 s66, 2097152
    s_mov_b32 s67, 0x20000
    s_mov_b32 s68, s12
    s_mov_b32 s69, s13
    s_mov_b32 s70, 7340032
    s_mov_b32 s71, 0x20000
    s_mov_b32 s72, s14
    s_mov_b32 s73, s15
    s_mov_b32 s74, 8388608
    s_mov_b32 s75, 0x20000
    s_mov_b32 s76, s18
    s_mov_b32 s77, s19
    s_mov_b32 s78, 3670016
    s_mov_b32 s79, 0x20000
    s_barrier
    s_cmp_lg_u32 s45, 0
    s_cbranch_scc1 sig_QKV
    s_add_u32 s46, s83, 128
    s_lshl_b32 s46, s46, 7
    v_mov_b32 v2, 1
    v_mov_b32 v3, 0
    s_mov_b64 exec, 1
    buffer_atomic_add v2, v3, s[32:35], s46 offen sc1
    s_mov_b64 exec, -1
sig_QKV:
    s_cmp_lg_u32 s45, 0
    s_cbranch_scc1 qw0_done
    s_mov_b32 s46, s41
    s_mov_b32 s47, 524288
    v_and_b32 v4, 3, v1
    v_mov_b32 v3, 15
    v_cmp_eq_u32 vcc, 1, v4
    s_nop 1
    v_cndmask_b32 v3, v3, 14, vcc
    v_add_u32 v3, s46, v3
    v_and_b32 v3, 15, v3
    v_lshrrev_b32 v4, 2, v1
    v_min_u32 v4, 7, v4
    v_add_u32 v4, 0, v4
    v_and_b32 v4, 7, v4
    v_lshl_add_u32 v3, v3, 3, v4
    v_lshlrev_b32 v3, 7, v3
    s_mov_b32 s46, 16384
qw0_loop:
    buffer_load_dword v2, v3, s[32:35], s46 offen sc1
    s_waitcnt vmcnt(0)
    v_cmp_gt_u32 vcc, 2, v2
    s_nop 0
    s_cbranch_vccz qw0_done
    s_sleep 1
    s_sub_u32 s47, s47, 1
    s_cmp_lg_u32 s47, 0
    s_cbranch_scc1 qw0_loop
qw0_done:
    s_barrier
    s_add_u32 m0, s53, 61440
    s_nop 0
    buffer_load_dwordx4 v16, s[24:27], s50 offen sc1 lds
    s_add_u32 m0, s53, 63488
    s_nop 0
    buffer_load_dwordx4 v17, s[24:27], s50 offen sc1 lds
    s_add_u32 m0, s53, 65536
    s_nop 0
    buffer_load_dwordx4 v18, s[24:27], s50 offen sc1 lds
    s_add_u32 m0, s53, 67584
    s_nop 0
    buffer_load_dwordx4 v19, s[24:27], s50 offen sc1 lds
    s_add_u32 m0, s54, 69632
    s_nop 0
    buffer_load_dwordx4 v20, s[28:31], s51 offen sc1 lds
    s_add_u32 m0, s54, 70656
    s_nop 0
    buffer_load_dwordx4 v21, s[28:31], s51 offen sc1 lds
    s_add_u32 m0, s54, 71680
    s_nop 0
    buffer_load_dwordx4 v22, s[28:31], s51 offen sc1 lds
    s_add_u32 m0, s54, 72704
    s_nop 0
    buffer_load_dwordx4 v23, s[28:31], s51 offen sc1 lds
    s_add_u32 s50, s50, 2048
    s_add_u32 s51, s51, 8192
    s_waitcnt vmcnt(4)
    s_barrier
    s_waitcnt vmcnt(0)
    s_barrier
    s_setprio 0
    s_add_u32 m0, s53, 94208
    s_nop 0
    buffer_load_dwordx4 v16, s[24:27], s50 offen sc1 lds
    s_add_u32 m0, s53, 96256
    s_nop 0
    buffer_load_dwordx4 v17, s[24:27], s50 offen sc1 lds
    s_add_u32 m0, s53, 98304
    s_nop 0
    buffer_load_dwordx4 v18, s[24:27], s50 offen sc1 lds
    s_add_u32 m0, s53, 100352
    s_nop 0
    buffer_load_dwordx4 v19, s[24:27], s50 offen sc1 lds
    s_add_u32 m0, s54, 102400
    s_nop 0
    buffer_load_dwordx4 v20, s[28:31], s51 offen sc1 lds
    s_add_u32 m0, s54, 103424
    s_nop 0
    buffer_load_dwordx4 v21, s[28:31], s51 offen sc1 lds
    s_add_u32 m0, s54, 104448
    s_nop 0
    buffer_load_dwordx4 v22, s[28:31], s51 offen sc1 lds
    s_add_u32 m0, s54, 105472
    s_nop 0
    buffer_load_dwordx4 v23, s[28:31], s51 offen sc1 lds
    s_add_u32 s50, s50, 2048
    s_add_u32 s51, s51, 8192
    s_add_u32 m0, s53, 126976
    s_nop 0
    buffer_load_dwordx4 v16, s[24:27], s50 offen sc1 lds
    s_add_u32 m0, s53, 129024
    s_nop 0
    buffer_load_dwordx4 v17, s[24:27], s50 offen sc1 lds
    s_add_u32 m0, s53, 131072
    s_nop 0
    buffer_load_dwordx4 v18, s[24:27], s50 offen sc1 lds
    s_add_u32 m0, s53, 133120
    s_nop 0
    buffer_load_dwordx4 v19, s[24:27], s50 offen sc1 lds
    s_add_u32 m0, s54, 135168
    s_nop 0
    buffer_load_dwordx4 v20, s[28:31], s51 offen sc1 lds
    s_add_u32 m0, s54, 136192
    s_nop 0
    buffer_load_dwordx4 v21, s[28:31], s51 offen sc1 lds
    s_add_u32 m0, s54, 137216
    s_nop 0
    buffer_load_dwordx4 v22, s[28:31], s51 offen sc1 lds
    s_add_u32 m0, s54, 138240
    s_nop 0
    buffer_load_dwordx4 v23, s[28:31], s51 offen sc1 lds
    s_add_u32 s50, s50, 2048
    s_add_u32 s51, s51, 8192
    s_waitcnt vmcnt(8)
    s_barrier
    s_add_u32 m0, s53, 61440
    s_nop 0
    buffer_load_dwordx4 v16, s[24:27], s50 offen sc1 lds
    s_add_u32 m0, s53, 63488
    s_nop 0
    buffer_load_dwordx4 v17, s[24:27], s50 offen sc1 lds
    s_add_u32 m0, s53, 65536
    s_nop 0
    buffer_load_dwordx4 v18, s[24:27], s50 offen sc1 lds
    s_add_u32 m0, s53, 67584
    s_nop 0
    buffer_load_dwordx4 v19, s[24:27], s50 offen sc1 lds
    s_add_u32 m0, s54, 69632
    s_nop 0
    buffer_load_dwordx4 v20, s[28:31], s51 offen sc1 lds
    s_add_u32 m0, s54, 70656
    s_nop 0
    buffer_load_dwordx4 v21, s[28:31], s51 offen sc1 lds
    s_add_u32 m0, s54, 71680
    s_nop 0
    buffer_load_dwordx4 v22, s[28:31], s51 offen sc1 lds
    s_add_u32 m0, s54, 72704
    s_nop 0
    buffer_load_dwordx4 v23, s[28:31], s51 offen sc1 lds
    s_add_u32 s50, s50, 2048
    s_add_u32 s51, s51, 8192
    s_mov_b32 s84, s98
    s_mov_b32 s85, s99
    s_mov_b32 s86, 12582912
    s_mov_b32 s87, 0x20000
    s_and_b32 s57, s91, 3
    s_lshl_b32 s57, s57, 8
    s_lshl_b32 s58, s45, 6
    s_add_u32 s57, s57, s58
    s_mul_i32 s57, s57, 12288
    s_lshr_b32 s58, s91, 2
    s_lshl_b32 s58, s58, 7
    s_add_u32 s57, s57, s58
    s_add_u32 s57, s57, 4096
    v_bfe_u32 v136, v1, 4, 1
    v_lshlrev_b32 v136, 1, v136
    v_and_b32 v137, 7, v1
    v_xor_b32 v136, v136, v137
    v_lshrrev_b32 v137, 3, v1
    v_mul_u32_u24 v137, 12288, v137
    v_lshl_add_u32 v136, v136, 4, v137
    v_xor_b32 v137, 64, v136
    s_lshl_b32 s58, s45, 13
    s_add_u32 s58, s58, 0
    s_add_u32 m0, s58, 0
    s_nop 0
    buffer_load_dwordx4 v136, s[84:87], s57 offen nt lds
    s_add_u32 s57, s57, 98304
    s_add_u32 m0, s58, 1024
    s_nop 0
    buffer_load_dwordx4 v137, s[84:87], s57 offen nt lds
    s_add_u32 s57, s57, 98304
    s_waitcnt vmcnt(10)
    s_barrier
    s_add_u32 m0, s53, 94208
    s_nop 0
    buffer_load_dwordx4 v16, s[24:27], s50 offen sc1 lds
    s_add_u32 m0, s53, 96256
    s_nop 0
    buffer_load_dwordx4 v17, s[24:27], s50 offen sc1 lds
    s_add_u32 m0, s53, 98304
    s_nop 0
    buffer_load_dwordx4 v18, s[24:27], s50 offen sc1 lds
    s_add_u32 m0, s53, 100352
    s_nop 0
    buffer_load_dwordx4 v19, s[24:27], s50 offen sc1 lds
    s_add_u32 m0, s54, 102400
    s_nop 0
    buffer_load_dwordx4 v20, s[28:31], s51 offen sc1 lds
    s_add_u32 m0, s54, 103424
    s_nop 0
    buffer_load_dwordx4 v21, s[28:31], s51 offen sc1 lds
    s_add_u32 m0, s54, 104448
    s_nop 0
    buffer_load_dwordx4 v22, s[28:31], s51 offen sc1 lds
    s_add_u32 m0, s54, 105472
    s_nop 0
    buffer_load_dwordx4 v23, s[28:31], s51 offen sc1 lds
    s_add_u32 s50, s50, 2048
    s_add_u32 s51, s51, 8192
    s_add_u32 m0, s58, 2048
    s_nop 0
    buffer_load_dwordx4 v136, s[84:87], s57 offen nt lds
    s_add_u32 s57, s57, 98304
    s_add_u32 m0, s58, 3072
    s_nop 0
    buffer_load_dwordx4 v137, s[84:87], s57 offen nt lds
    s_add_u32 s57, s57, 98304
    s_waitcnt vmcnt(12)
    s_barrier
    s_add_u32 m0, s53, 126976
    s_nop 0
    buffer_load_dwordx4 v16, s[24:27], s50 offen sc1 lds
    s_add_u32 m0, s53, 129024
    s_nop 0
    buffer_load_dwordx4 v17, s[24:27], s50 offen sc1 lds
    s_add_u32 m0, s53, 131072
    s_nop 0
    buffer_load_dwordx4 v18, s[24:27], s50 offen sc1 lds
    s_add_u32 m0, s53, 133120
    s_nop 0
    buffer_load_dwordx4 v19, s[24:27], s50 offen sc1 lds
    s_add_u32 m0, s54, 135168
    s_nop 0
    buffer_load_dwordx4 v20, s[28:31], s51 offen sc1 lds
    s_add_u32 m0, s54, 136192
    s_nop 0
    buffer_load_dwordx4 v21, s[28:31], s51 offen sc1 lds
    s_add_u32 m0, s54, 137216
    s_nop 0
    buffer_load_dwordx4 v22, s[28:31], s51 offen sc1 lds
    s_add_u32 m0, s54, 138240
    s_nop 0
    buffer_load_dwordx4 v23, s[28:31], s51 offen sc1 lds
    s_add_u32 s50, s50, 2048
    s_add_u32 s51, s51, 8192
    s_add_u32 m0, s58, 4096
    s_nop 0
    buffer_load_dwordx4 v136, s[84:87], s57 offen nt lds
    s_add_u32 s57, s57, 98304
    s_add_u32 m0, s58, 5120
    s_nop 0
    buffer_load_dwordx4 v137, s[84:87], s57 offen nt lds
    s_add_u32 s57, s57, 98304
    s_waitcnt vmcnt(12)
    s_barrier
    s_add_u32 m0, s53, 61440
    s_nop 0
    buffer_load_dwordx4 v16, s[24:27], s50 offen sc1 lds
    s_add_u32 m0, s53, 63488
    s_nop 0
    buffer_load_dwordx4 v17, s[24:27], s50 offen sc1 lds
    s_add_u32 m0, s53, 65536
    s_nop 0
    buffer_load_dwordx4 v18, s[24:27], s50 offen sc1 lds
    s_add_u32 m0, s53, 67584
    s_nop 0
    buffer_load_dwordx4 v19, s[24:27], s50 offen sc1 lds
    s_add_u32 m0, s54, 69632
    s_nop 0
    buffer_load_dwordx4 v20, s[28:31], s51 offen sc1 lds
    s_add_u32 m0, s54, 70656
    s_nop 0
    buffer_load_dwordx4 v21, s[28:31], s51 offen sc1 lds
    s_add_u32 m0, s54, 71680
    s_nop 0
    buffer_load_dwordx4 v22, s[28:31], s51 offen sc1 lds
    s_add_u32 m0, s54, 72704
    s_nop 0
    buffer_load_dwordx4 v23, s[28:31], s51 offen sc1 lds
    s_add_u32 s50, s50, 2048
    s_add_u32 s51, s51, 8192
    s_add_u32 m0, s58, 6144
    s_nop 0
    buffer_load_dwordx4 v136, s[84:87], s57 offen nt lds
    s_add_u32 s57, s57, 98304
    s_add_u32 m0, s58, 7168
    s_nop 0
    buffer_load_dwordx4 v137, s[84:87], s57 offen nt lds
    s_add_u32 s57, s57, 98304
    s_waitcnt vmcnt(12)
    s_barrier
    s_add_u32 m0, s53, 94208
    s_nop 0
    buffer_load_dwordx4 v16, s[24:27], s50 offen sc1 lds
    s_add_u32 m0, s53, 96256
    s_nop 0
    buffer_load_dwordx4 v17, s[24:27], s50 offen sc1 lds
    s_add_u32 m0, s53, 98304
    s_nop 0
    buffer_load_dwordx4 v18, s[24:27], s50 offen sc1 lds
    s_add_u32 m0, s53, 100352
    s_nop 0
    buffer_load_dwordx4 v19, s[24:27], s50 offen sc1 lds
    s_add_u32 m0, s54, 102400
    s_nop 0
    buffer_load_dwordx4 v20, s[28:31], s51 offen sc1 lds
    s_add_u32 m0, s54, 103424
    s_nop 0
    buffer_load_dwordx4 v21, s[28:31], s51 offen sc1 lds
    s_add_u32 m0, s54, 104448
    s_nop 0
    buffer_load_dwordx4 v22, s[28:31], s51 offen sc1 lds
    s_add_u32 m0, s54, 105472
    s_nop 0
    buffer_load_dwordx4 v23, s[28:31], s51 offen sc1 lds
    s_add_u32 s50, s50, 2048
    s_add_u32 s51, s51, 8192
    s_mov_b32 m0, 49152
    s_mov_b32 s46, 0
    buffer_load_dwordx4 v24, s[64:67], s46 offen lds
    s_mov_b32 s46, 1048576
    buffer_load_dwordx4 v24, s[64:67], s46 offen lds
    s_waitcnt vmcnt(12)
    s_barrier
    s_add_u32 m0, s53, 126976
    s_nop 0
    buffer_load_dwordx4 v16, s[24:27], s50 offen sc1 lds
    s_add_u32 m0, s53, 129024
    s_nop 0
    buffer_load_dwordx4 v17, s[24:27], s50 offen sc1 lds
    s_add_u32 m0, s53, 131072
    s_nop 0
    buffer_load_dwordx4 v18, s[24:27], s50 offen sc1 lds
    s_add_u32 m0, s53, 133120
    s_nop 0
    buffer_load_dwordx4 v19, s[24:27], s50 offen sc1 lds
    s_add_u32 m0, s54, 135168
    s_nop 0
    buffer_load_dwordx4 v20, s[28:31], s51 offen sc1 lds
    s_add_u32 m0, s54, 136192
    s_nop 0
    buffer_load_dwordx4 v21, s[28:31], s51 offen sc1 lds
    s_add_u32 m0, s54, 137216
    s_nop 0
    buffer_load_dwordx4 v22, s[28:31], s51 offen sc1 lds
    s_add_u32 m0, s54, 138240
    s_nop 0
    buffer_load_dwordx4 v23, s[28:31], s51 offen sc1 lds
    s_add_u32 s50, s50, 2048
    s_add_u32 s51, s51, 8192
    s_mov_b32 m0, 49152
    s_mov_b32 s46, 0
    buffer_load_dwordx4 v24, s[68:71], s46 offen lds
    s_mov_b32 s46, 1048576
    buffer_load_dwordx4 v24, s[68:71], s46 offen lds
    s_setprio 2
    v_lshrrev_b32 v148, 4, v1
    v_bfe_u32 v149, v1, 2, 2
    v_and_b32 v150, 3, v1
    v_lshl_add_u32 v151, v148, 3, v149
    v_lshlrev_b32 v151, 7, v151
    v_lshl_add_u32 v151, v150, 3, v151
    s_lshl_b32 s58, s45, 13
    s_add_u32 s58, s58, 0
    v_add_u32 v151, s58, v151
    v_and_b32 v150, 1, v148
    v_lshrrev_b32 v149, 1, v149
    v_lshl_add_u32 v149, v150, 1, v149
    v_xor_b32 v150, 0, v149
    v_lshl_add_u32 v152, v150, 5, v151
    v_xor_b32 v150, 1, v149
    v_lshl_add_u32 v153, v150, 5, v151
    v_xor_b32 v150, 2, v149
    v_lshl_add_u32 v154, v150, 5, v151
    v_xor_b32 v150, 3, v149
    v_lshl_add_u32 v155, v150, 5, v151
    s_lshl_b32 s58, s45, 8
    s_add_u32 s58, s58, 159744
    v_lshl_add_u32 v148, v148, 4, s58
    s_waitcnt vmcnt(20)
    ds_read_b64_tr_b16 v[172:173], v152 offset:0
    ds_read_b64_tr_b16 v[174:175], v152 offset:512
    ds_read_b64_tr_b16 v[176:177], v153 offset:0
    ds_read_b64_tr_b16 v[178:179], v153 offset:512
    ds_read_b64_tr_b16 v[180:181], v154 offset:0
    ds_read_b64_tr_b16 v[182:183], v154 offset:512
    ds_read_b64_tr_b16 v[184:185], v155 offset:0
    ds_read_b64_tr_b16 v[186:187], v155 offset:512
    ds_read_b64_tr_b16 v[188:189], v152 offset:4096
    ds_read_b64_tr_b16 v[190:191], v152 offset:4608
    ds_read_b64_tr_b16 v[192:193], v153 offset:4096
    ds_read_b64_tr_b16 v[194:195], v153 offset:4608
    ds_read_b64_tr_b16 v[196:197], v154 offset:4096
    ds_read_b64_tr_b16 v[198:199], v154 offset:4608
    ds_read_b64_tr_b16 v[200:201], v155 offset:4096
    ds_read_b64_tr_b16 v[202:203], v155 offset:4608
    s_waitcnt lgkmcnt(8)
    v_mfma_f32_16x16x32_bf16 v[156:159], v[172:175], v[224:227], 0
    v_mfma_f32_16x16x32_bf16 v[160:163], v[176:179], v[224:227], 0
    v_mfma_f32_16x16x32_bf16 v[164:167], v[180:183], v[224:227], 0
    v_mfma_f32_16x16x32_bf16 v[168:171], v[184:187], v[224:227], 0
    s_waitcnt lgkmcnt(0)
    v_mfma_f32_16x16x32_bf16 v[156:159], v[188:191], v[228:231], v[156:159]
    v_mfma_f32_16x16x32_bf16 v[160:163], v[192:195], v[228:231], v[160:163]
    v_mfma_f32_16x16x32_bf16 v[164:167], v[196:199], v[228:231], v[164:167]
    v_mfma_f32_16x16x32_bf16 v[168:171], v[200:203], v[228:231], v[168:171]
    s_mov_b32 exec_lo, 0x00010001
    s_mov_b32 exec_hi, 0x00010001
    s_nop 2
    ds_write_b128 v148, v[156:159] offset:0
    ds_write_b128 v148, v[160:163] offset:64
    ds_write_b128 v148, v[164:167] offset:128
    ds_write_b128 v148, v[168:171] offset:192
    s_mov_b64 exec, -1
    s_setprio 0
    s_waitcnt lgkmcnt(0)
    s_waitcnt vmcnt(12)
    s_barrier
    s_add_u32 m0, s53, 61440
    s_nop 0
    buffer_load_dwordx4 v16, s[24:27], s50 offen sc1 lds
    s_add_u32 m0, s53, 63488
    s_nop 0
    buffer_load_dwordx4 v17, s[24:27], s50 offen sc1 lds
    s_add_u32 m0, s53, 65536
    s_nop 0
    buffer_load_dwordx4 v18, s[24:27], s50 offen sc1 lds
    s_add_u32 m0, s53, 67584
    s_nop 0
    buffer_load_dwordx4 v19, s[24:27], s50 offen sc1 lds
    s_add_u32 m0, s54, 69632
    s_nop 0
    buffer_load_dwordx4 v20, s[28:31], s51 offen sc1 lds
    s_add_u32 m0, s54, 70656
    s_nop 0
    buffer_load_dwordx4 v21, s[28:31], s51 offen sc1 lds
    s_add_u32 m0, s54, 71680
    s_nop 0
    buffer_load_dwordx4 v22, s[28:31], s51 offen sc1 lds
    s_add_u32 m0, s54, 72704
    s_nop 0
    buffer_load_dwordx4 v23, s[28:31], s51 offen sc1 lds
    s_add_u32 s50, s50, 2048
    s_add_u32 s51, s51, 8192
    s_mov_b32 m0, 49152
    s_mov_b32 s46, 2097152
    buffer_load_dwordx4 v24, s[68:71], s46 offen lds
    s_mov_b32 s46, 3145728
    buffer_load_dwordx4 v24, s[68:71], s46 offen lds
    s_cmp_lg_u32 s45, 0
    s_cbranch_scc1 mod2_nofin
    s_mov_b32 s36, s4
    s_mov_b32 s37, s5
    s_mov_b32 s38, 65536
    s_mov_b32 s39, 0x20000
    v_lshlrev_b32 v138, 2, v1
    v_add_u32 v137, 159744, v138
    ds_read_b32 v140, v137 offset:0
    ds_read_b32 v141, v137 offset:256
    ds_read_b32 v142, v137 offset:512
    ds_read_b32 v143, v137 offset:768
    s_and_b32 s59, s91, 3
    s_mul_i32 s59, s59, 16384
    s_lshr_b32 s58, s91, 2
    s_lshl_b32 s58, s58, 8
    s_add_u32 s57, s59, s58
    s_waitcnt lgkmcnt(0)
    v_add_f32 v140, v140, v141
    v_add_f32 v142, v142, v143
    v_add_f32 v140, v140, v142
    buffer_store_dword v140, v138, s[36:39], s57 offen sc1
mod2_nofin:
    s_waitcnt vmcnt(12)
    s_barrier
    s_add_u32 m0, s53, 94208
    s_nop 0
    buffer_load_dwordx4 v16, s[24:27], s50 offen sc1 lds
    s_add_u32 m0, s53, 96256
    s_nop 0
    buffer_load_dwordx4 v17, s[24:27], s50 offen sc1 lds
    s_add_u32 m0, s53, 98304
    s_nop 0
    buffer_load_dwordx4 v18, s[24:27], s50 offen sc1 lds
    s_add_u32 m0, s53, 100352
    s_nop 0
    buffer_load_dwordx4 v19, s[24:27], s50 offen sc1 lds
    s_add_u32 m0, s54, 102400
    s_nop 0
    buffer_load_dwordx4 v20, s[28:31], s51 offen sc1 lds
    s_add_u32 m0, s54, 103424
    s_nop 0
    buffer_load_dwordx4 v21, s[28:31], s51 offen sc1 lds
    s_add_u32 m0, s54, 104448
    s_nop 0
    buffer_load_dwordx4 v22, s[28:31], s51 offen sc1 lds
    s_add_u32 m0, s54, 105472
    s_nop 0
    buffer_load_dwordx4 v23, s[28:31], s51 offen sc1 lds
    s_add_u32 s50, s50, 2048
    s_add_u32 s51, s51, 8192
    s_mov_b32 m0, 49152
    s_mov_b32 s46, 4194304
    buffer_load_dwordx4 v24, s[68:71], s46 offen lds
    s_mov_b32 s46, 5242880
    buffer_load_dwordx4 v24, s[68:71], s46 offen lds
    s_mov_b32 s80, s40
    s_mov_b32 s81, s41
    s_lshr_b32 s40, s43, 1
    s_and_b32 s41, s43, 1
    s_lshl_b32 s40, s40, 3
    s_lshl_b32 s41, s41, 2
    s_lshr_b32 s46, s44, 2
    s_and_b32 s47, s44, 3
    s_add_u32 s40, s40, s46
    s_add_u32 s41, s41, s47
    s_mov_b32 s88, s6
    s_mov_b32 s89, s7
    s_mov_b32 s90, 4194304
    s_mov_b32 s91, 0x20000
    s_lshl_b32 s57, s40, 17
    s_lshl_b32 s58, s41, 8
    s_add_u32 s57, s57, s58
    s_mov_b32 s40, s80
    s_mov_b32 s41, s81
    v_lshrrev_b32 v10, 4, v1
    s_lshl_b32 s58, s45, 2
    v_add_u32 v10, s58, v10
    v_and_b32 v11, 15, v1
    v_xor_b32 v11, v11, v10
    v_lshlrev_b32 v10, 11, v10
    v_lshl_add_u32 v10, v11, 4, v10
    s_add_u32 m0, s60, 0
    s_nop 0
    buffer_load_dwordx4 v10, s[88:91], s57 offen nt lds
    s_add_u32 s57, s57, 32768
    s_add_u32 m0, s60, 4096
    s_nop 0
    buffer_load_dwordx4 v10, s[88:91], s57 offen nt lds
    s_add_u32 s57, s57, 32768
    s_add_u32 m0, s60, 8192
    s_nop 0
    buffer_load_dwordx4 v10, s[88:91], s57 offen nt lds
    s_add_u32 s57, s57, 32768
    s_add_u32 m0, s60, 12288
    s_nop 0
    buffer_load_dwordx4 v10, s[88:91], s57 offen nt lds
    s_add_u32 s57, s57, 32768
    s_waitcnt vmcnt(16)
    s_barrier
    s_add_u32 m0, s53, 126976
    s_nop 0
    buffer_load_dwordx4 v16, s[24:27], s50 offen sc1 lds
    s_add_u32 m0, s53, 129024
    s_nop 0
    buffer_load_dwordx4 v17, s[24:27], s50 offen sc1 lds
    s_add_u32 m0, s53, 131072
    s_nop 0
    buffer_load_dwordx4 v18, s[24:27], s50 offen sc1 lds
    s_add_u32 m0, s53, 133120
    s_nop 0
    buffer_load_dwordx4 v19, s[24:27], s50 offen sc1 lds
    s_add_u32 m0, s54, 135168
    s_nop 0
    buffer_load_dwordx4 v20, s[28:31], s51 offen sc1 lds
    s_add_u32 m0, s54, 136192
    s_nop 0
    buffer_load_dwordx4 v21, s[28:31], s51 offen sc1 lds
    s_add_u32 m0, s54, 137216
    s_nop 0
    buffer_load_dwordx4 v22, s[28:31], s51 offen sc1 lds
    s_add_u32 m0, s54, 138240
    s_nop 0
    buffer_load_dwordx4 v23, s[28:31], s51 offen sc1 lds
    s_add_u32 s50, s50, 2048
    s_add_u32 s51, s51, 8192
    s_mov_b32 m0, 49152
    s_mov_b32 s46, 6291456
    buffer_load_dwordx4 v24, s[68:71], s46 offen lds
    s_mov_b32 s46, 0
    buffer_load_dwordx4 v24, s[72:75], s46 offen lds
    s_waitcnt vmcnt(16)
    s_barrier
    s_mov_b32 s55, 0
    s_cmp_lg_u32 s45, 0
    s_cbranch_scc1 sig_MOD2
    s_add_u32 s46, s55, 88
    s_lshl_b32 s46, s46, 7
    v_mov_b32 v2, 1
    v_mov_b32 v3, 0
    s_mov_b64 exec, 1
    buffer_atomic_add v2, v3, s[32:35], s46 offen sc1
    s_mov_b64 exec, -1
sig_MOD2:
    s_add_u32 m0, s53, 61440
    s_nop 0
    buffer_load_dwordx4 v16, s[24:27], s50 offen sc1 lds
    s_add_u32 m0, s53, 63488
    s_nop 0
    buffer_load_dwordx4 v17, s[24:27], s50 offen sc1 lds
    s_add_u32 m0, s53, 65536
    s_nop 0
    buffer_load_dwordx4 v18, s[24:27], s50 offen sc1 lds
    s_add_u32 m0, s53, 67584
    s_nop 0
    buffer_load_dwordx4 v19, s[24:27], s50 offen sc1 lds
    s_add_u32 m0, s54, 69632
    s_nop 0
    buffer_load_dwordx4 v20, s[28:31], s51 offen sc1 lds
    s_add_u32 m0, s54, 70656
    s_nop 0
    buffer_load_dwordx4 v21, s[28:31], s51 offen sc1 lds
    s_add_u32 m0, s54, 71680
    s_nop 0
    buffer_load_dwordx4 v22, s[28:31], s51 offen sc1 lds
    s_add_u32 m0, s54, 72704
    s_nop 0
    buffer_load_dwordx4 v23, s[28:31], s51 offen sc1 lds
    s_add_u32 s50, s50, 2048
    s_add_u32 s51, s51, 8192
    s_mov_b32 m0, 49152
    s_mov_b32 s46, 1048576
    buffer_load_dwordx4 v24, s[72:75], s46 offen lds
    s_mov_b32 s46, 2097152
    buffer_load_dwordx4 v24, s[72:75], s46 offen lds
    s_waitcnt vmcnt(12)
    s_barrier
    s_add_u32 m0, s53, 94208
    s_nop 0
    buffer_load_dwordx4 v16, s[24:27], s50 offen sc1 lds
    s_add_u32 m0, s53, 96256
    s_nop 0
    buffer_load_dwordx4 v17, s[24:27], s50 offen sc1 lds
    s_add_u32 m0, s53, 98304
    s_nop 0
    buffer_load_dwordx4 v18, s[24:27], s50 offen sc1 lds
    s_add_u32 m0, s53, 100352
    s_nop 0
    buffer_load_dwordx4 v19, s[24:27], s50 offen sc1 lds
    s_add_u32 m0, s54, 102400
    s_nop 0
    buffer_load_dwordx4 v20, s[28:31], s51 offen sc1 lds
    s_add_u32 m0, s54, 103424
    s_nop 0
    buffer_load_dwordx4 v21, s[28:31], s51 offen sc1 lds
    s_add_u32 m0, s54, 104448
    s_nop 0
    buffer_load_dwordx4 v22, s[28:31], s51 offen sc1 lds
    s_add_u32 m0, s54, 105472
    s_nop 0
    buffer_load_dwordx4 v23, s[28:31], s51 offen sc1 lds
    s_add_u32 s50, s50, 2048
    s_add_u32 s51, s51, 8192
    s_mov_b32 m0, 49152
    s_mov_b32 s46, 3145728
    buffer_load_dwordx4 v24, s[72:75], s46 offen lds
    s_mov_b32 s46, 4194304
    buffer_load_dwordx4 v24, s[72:75], s46 offen lds
    s_waitcnt vmcnt(12)
    s_barrier
    s_add_u32 m0, s53, 126976
    s_nop 0
    buffer_load_dwordx4 v16, s[24:27], s50 offen sc1 lds
    s_add_u32 m0, s53, 129024
    s_nop 0
    buffer_load_dwordx4 v17, s[24:27], s50 offen sc1 lds
    s_add_u32 m0, s53, 131072
    s_nop 0
    buffer_load_dwordx4 v18, s[24:27], s50 offen sc1 lds
    s_add_u32 m0, s53, 133120
    s_nop 0
    buffer_load_dwordx4 v19, s[24:27], s50 offen sc1 lds
    s_add_u32 m0, s54, 135168
    s_nop 0
    buffer_load_dwordx4 v20, s[28:31], s51 offen sc1 lds
    s_add_u32 m0, s54, 136192
    s_nop 0
    buffer_load_dwordx4 v21, s[28:31], s51 offen sc1 lds
    s_add_u32 m0, s54, 137216
    s_nop 0
    buffer_load_dwordx4 v22, s[28:31], s51 offen sc1 lds
    s_add_u32 m0, s54, 138240
    s_nop 0
    buffer_load_dwordx4 v23, s[28:31], s51 offen sc1 lds
    s_add_u32 s50, s50, 2048
    s_add_u32 s51, s51, 8192
    s_mov_b32 m0, 49152
    s_mov_b32 s46, 5242880
    buffer_load_dwordx4 v24, s[72:75], s46 offen lds
    s_mov_b32 s46, 6291456
    buffer_load_dwordx4 v24, s[72:75], s46 offen lds
    s_waitcnt vmcnt(12)
    s_barrier
    s_add_u32 m0, s53, 61440
    s_nop 0
    buffer_load_dwordx4 v16, s[24:27], s50 offen sc1 lds
    s_add_u32 m0, s53, 63488
    s_nop 0
    buffer_load_dwordx4 v17, s[24:27], s50 offen sc1 lds
    s_add_u32 m0, s53, 65536
    s_nop 0
    buffer_load_dwordx4 v18, s[24:27], s50 offen sc1 lds
    s_add_u32 m0, s53, 67584
    s_nop 0
    buffer_load_dwordx4 v19, s[24:27], s50 offen sc1 lds
    s_add_u32 m0, s54, 69632
    s_nop 0
    buffer_load_dwordx4 v20, s[28:31], s51 offen sc1 lds
    s_add_u32 m0, s54, 70656
    s_nop 0
    buffer_load_dwordx4 v21, s[28:31], s51 offen sc1 lds
    s_add_u32 m0, s54, 71680
    s_nop 0
    buffer_load_dwordx4 v22, s[28:31], s51 offen sc1 lds
    s_add_u32 m0, s54, 72704
    s_nop 0
    buffer_load_dwordx4 v23, s[28:31], s51 offen sc1 lds
    s_add_u32 s50, s50, 2048
    s_add_u32 s51, s51, 8192
    s_mov_b32 m0, 49152
    s_mov_b32 s46, 7340032
    buffer_load_dwordx4 v24, s[72:75], s46 offen lds
    s_mov_b32 s46, 0
    buffer_load_dwordx4 v24, s[76:79], s46 offen lds
    s_mov_b32 s46, 1048576
    buffer_load_dwordx4 v24, s[76:79], s46 offen lds
    s_waitcnt vmcnt(13)
    s_barrier
    s_mov_b32 m0, 49152
    s_mov_b32 s46, 2097152
    buffer_load_dwordx4 v24, s[76:79], s46 offen lds
    s_mov_b32 s46, 3145728
    buffer_load_dwordx4 v24, s[76:79], s46 offen lds
    s_waitcnt vmcnt(5)
    s_barrier
    s_waitcnt vmcnt(0)
    s_barrier
    s_setprio 1
    s_mov_b32 s83, s40
    s_lshr_b32 s40, s43, 1
    s_and_b32 s41, s43, 1
    s_lshl_b32 s40, s40, 3
    s_lshl_b32 s41, s41, 2
    s_lshr_b32 s46, s44, 2
    s_and_b32 s47, s44, 3
    s_add_u32 s40, s40, s46
    s_add_u32 s41, s41, s47
    s_add_u32 s24, s4, 19922944
    s_addc_u32 s25, s5, 0
    s_mov_b32 s26, 4227072
    s_mov_b32 s27, 0x20000
    s_mov_b32 s28, s10
    s_mov_b32 s29, s11
    s_mov_b32 s30, 2097152
    s_mov_b32 s31, 0x20000
    s_lshl_b32 s50, s40, 10
    s_lshl_b32 s51, s41, 8
    v_lshrrev_b32 v3, 3, v1
    v_and_b32 v4, 7, v1
    v_lshlrev_b32 v5, 4, v1
    s_lshl_b32 s60, s45, 10
    s_mul_i32 s46, s45, 33024
    v_add_u32 v16, s46, v5
    v_add_u32 v17, 132096, v16
    v_bfe_u32 v6, v1, 4, 1
    v_lshlrev_b32 v6, 2, v6
    v_xor_b32 v6, v6, v4
    s_lshl_b32 s46, s45, 3
    v_add_u32 v7, s46, v3
    v_mul_u32_u24 v7, 2048, v7
    v_lshl_add_u32 v8, v6, 4, v7
    v_add_u32 v18, 0, v8
    v_add_u32 v19, 65536, v8
    v_add_u32 v20, 128, v8
    v_add_u32 v21, 65664, v8
    s_add_u32 m0, s60, 32768
    s_nop 0
    buffer_load_dwordx4 v18, s[28:31], s51 offen lds
    s_add_u32 m0, s60, 36864
    s_nop 0
    buffer_load_dwordx4 v19, s[28:31], s51 offen lds
    s_add_u32 m0, s60, 40960
    s_nop 0
    buffer_load_dwordx4 v20, s[28:31], s51 offen lds
    s_add_u32 m0, s60, 45056
    s_nop 0
    buffer_load_dwordx4 v21, s[28:31], s51 offen lds
    s_add_u32 s51, s51, 131072
    s_add_u32 m0, s60, 57344
    s_nop 0
    buffer_load_dwordx4 v18, s[28:31], s51 offen lds
    s_add_u32 m0, s60, 61440
    s_nop 0
    buffer_load_dwordx4 v19, s[28:31], s51 offen lds
    s_add_u32 m0, s60, 65536
    s_nop 0
    buffer_load_dwordx4 v20, s[28:31], s51 offen lds
    s_add_u32 m0, s60, 69632
    s_nop 0
    buffer_load_dwordx4 v21, s[28:31], s51 offen lds
    s_add_u32 s51, s51, 131072
    s_add_u32 m0, s60, 81920
    s_nop 0
    buffer_load_dwordx4 v18, s[28:31], s51 offen lds
    s_add_u32 m0, s60, 86016
    s_nop 0
    buffer_load_dwordx4 v19, s[28:31], s51 offen lds
    s_add_u32 m0, s60, 90112
    s_nop 0
    buffer_load_dwordx4 v20, s[28:31], s51 offen lds
    s_add_u32 m0, s60, 94208
    s_nop 0
    buffer_load_dwordx4 v21, s[28:31], s51 offen lds
    s_add_u32 s51, s51, 131072
    s_barrier
    s_cmp_lg_u32 s45, 0
    s_cbranch_scc1 sig_ATT
    s_add_u32 s46, s83, 16
    s_lshl_b32 s46, s46, 7
    v_mov_b32 v2, 1
    v_mov_b32 v3, 0
    s_mov_b64 exec, 1
    buffer_atomic_add v2, v3, s[32:35], s46 offen sc1
    s_mov_b64 exec, -1
sig_ATT:
    s_lshr_b32 s55, s40, 1
    s_cmp_lg_u32 s45, 0
    s_cbranch_scc1 dep_ATT_done
    s_add_u32 s46, s55, 16
    s_lshl_b32 s46, s46, 7
    s_mov_b32 s47, 524288
    v_mov_b32 v3, 0
    v_mov_b32 v4, 16
    s_sub_u32 s48, 11264, s46
    v_mov_b32 v5, s48
    v_mov_b32 v6, 0x100
    v_cmp_eq_u32 vcc, 1, v1
    s_nop 1
    v_cndmask_b32 v3, v3, v5, vcc
    v_cndmask_b32 v4, v4, v6, vcc
dep_ATT_loop:
    buffer_load_dword v2, v3, s[32:35], s46 offen sc1
    s_waitcnt vmcnt(0)
    v_cmp_gt_u32 vcc, v4, v2
    s_nop 0
    s_cbranch_vccz dep_ATT_done
    s_sleep 1
    s_sub_u32 s47, s47, 1
    s_cmp_lg_u32 s47, 0
    s_cbranch_scc1 dep_ATT_loop
dep_ATT_done:
    s_barrier
    s_add_u32 m0, s60, 24576
    s_nop 0
    buffer_load_dwordx4 v16, s[24:27], s50 offen sc1 lds
    s_add_u32 m0, s60, 28672
    s_nop 0
    buffer_load_dwordx4 v17, s[24:27], s50 offen sc1 lds
    s_add_u32 s50, s50, 264192
    s_add_u32 m0, s60, 49152
    s_nop 0
    buffer_load_dwordx4 v16, s[24:27], s50 offen sc1 lds
    s_add_u32 m0, s60, 53248
    s_nop 0
    buffer_load_dwordx4 v17, s[24:27], s50 offen sc1 lds
    s_add_u32 s50, s50, 264192
    s_add_u32 m0, s60, 73728
    s_nop 0
    buffer_load_dwordx4 v16, s[24:27], s50 offen sc1 lds
    s_add_u32 m0, s60, 77824
    s_nop 0
    buffer_load_dwordx4 v17, s[24:27], s50 offen sc1 lds
    s_add_u32 s50, s50, 264192
    s_and_b32 s64, s44, 3
    s_lshr_b32 s65, s44, 2
    s_mov_b32 s66, 3
    s_mov_b32 s67, 73728
    s_mov_b32 s68, 98304
    s_mov_b32 s69, 122880
    s_waitcnt vmcnt(4)
    s_barrier
    s_sub_u32 s70, s66, s64
    s_and_b32 s70, s70, 3
    s_cmp_lt_u32 s66, 15
    s_cselect_b32 s71, 3, 4
    s_cmp_eq_u32 s70, s71
    s_cselect_b32 s72, 264192, 0
    s_cselect_b32 s73, s69, s68
    s_cmp_gt_u32 s66, 3
    s_cselect_b32 s71, 0, 4
    s_cmp_eq_u32 s70, s71
    s_cselect_b32 s72, 4294703104, s72
    s_cselect_b32 s73, s67, s73
    s_add_u32 s74, s50, s72
    s_add_u32 s62, s73, s60
    s_add_u32 m0, s62, 0
    s_nop 0
    buffer_load_dwordx4 v16, s[24:27], s74 offen sc1 lds
    s_add_u32 m0, s62, 4096
    s_nop 0
    buffer_load_dwordx4 v17, s[24:27], s74 offen sc1 lds
    s_add_u32 s50, s50, 264192
    s_sub_u32 s70, s66, s65
    s_and_b32 s70, s70, 7
    s_cmp_lt_u32 s66, 15
    s_cselect_b32 s71, 7, 8
    s_cmp_eq_u32 s70, s71
    s_cselect_b32 s72, 131072, 0
    s_cselect_b32 s73, s69, s68
    s_cmp_gt_u32 s66, 3
    s_cselect_b32 s71, 0, 8
    s_cmp_eq_u32 s70, s71
    s_cselect_b32 s72, 4294836224, s72
    s_cselect_b32 s73, s67, s73
    s_add_u32 s74, s51, s72
    s_add_u32 s62, s73, s60
    s_add_u32 m0, s62, 8192
    s_nop 0
    buffer_load_dwordx4 v18, s[28:31], s74 offen lds
    s_add_u32 m0, s62, 12288
    s_nop 0
    buffer_load_dwordx4 v19, s[28:31], s74 offen lds
    s_add_u32 m0, s62, 16384
    s_nop 0
    buffer_load_dwordx4 v20, s[28:31], s74 offen lds
    s_add_u32 m0, s62, 20480
    s_nop 0
    buffer_load_dwordx4 v21, s[28:31], s74 offen lds
    s_add_u32 s51, s51, 131072
    s_add_u32 s66, s66, 1
    s_mov_b32 s67, s68
    s_mov_b32 s68, s69
    s_add_u32 s69, s69, 24576
    s_cmp_eq_u32 s69, 147456
    s_cselect_b32 s69, 0, s69
    s_waitcnt vmcnt(8)
    s_barrier
    s_sub_u32 s70, s66, s64
    s_and_b32 s70, s70, 3
    s_cmp_lt_u32 s66, 15
    s_cselect_b32 s71, 3, 4
    s_cmp_eq_u32 s70, s71
    s_cselect_b32 s72, 264192, 0
    s_cselect_b32 s73, s69, s68
    s_cmp_gt_u32 s66, 3
    s_cselect_b32 s71, 0, 4
    s_cmp_eq_u32 s70, s71
    s_cselect_b32 s72, 4294703104, s72
    s_cselect_b32 s73, s67, s73
    s_add_u32 s74, s50, s72
    s_add_u32 s62, s73, s60
    s_add_u32 m0, s62, 0
    s_nop 0
    buffer_load_dwordx4 v16, s[24:27], s74 offen sc1 lds
    s_add_u32 m0, s62, 4096
    s_nop 0
    buffer_load_dwordx4 v17, s[24:27], s74 offen sc1 lds
    s_add_u32 s50, s50, 264192
    s_sub_u32 s70, s66, s65
    s_and_b32 s70, s70, 7
    s_cmp_lt_u32 s66, 15
    s_cselect_b32 s71, 7, 8
    s_cmp_eq_u32 s70, s71
    s_cselect_b32 s72, 131072, 0
    s_cselect_b32 s73, s69, s68
    s_cmp_gt_u32 s66, 3
    s_cselect_b32 s71, 0, 8
    s_cmp_eq_u32 s70, s71
    s_cselect_b32 s72, 4294836224, s72
    s_cselect_b32 s73, s67, s73
    s_add_u32 s74, s51, s72
    s_add_u32 s62, s73, s60
    s_add_u32 m0, s62, 8192
    s_nop 0
    buffer_load_dwordx4 v18, s[28:31], s74 offen lds
    s_add_u32 m0, s62, 12288
    s_nop 0
    buffer_load_dwordx4 v19, s[28:31], s74 offen lds
    s_add_u32 m0, s62, 16384
    s_nop 0
    buffer_load_dwordx4 v20, s[28:31], s74 offen lds
    s_add_u32 m0, s62, 20480
    s_nop 0
    buffer_load_dwordx4 v21, s[28:31], s74 offen lds
    s_add_u32 s51, s51, 131072
    s_add_u32 s66, s66, 1
    s_mov_b32 s67, s68
    s_mov_b32 s68, s69
    s_add_u32 s69, s69, 24576
    s_cmp_eq_u32 s69, 147456
    s_cselect_b32 s69, 0, s69
    s_waitcnt vmcnt(12)
    s_barrier
    s_sub_u32 s70, s66, s64
    s_and_b32 s70, s70, 3
    s_cmp_lt_u32 s66, 15
    s_cselect_b32 s71, 3, 4
    s_cmp_eq_u32 s70, s71
    s_cselect_b32 s72, 264192, 0
    s_cselect_b32 s73, s69, s68
    s_cmp_gt_u32 s66, 3
    s_cselect_b32 s71, 0, 4
    s_cmp_eq_u32 s70, s71
    s_cselect_b32 s72, 4294703104, s72
    s_cselect_b32 s73, s67, s73
    s_add_u32 s74, s50, s72
    s_add_u32 s62, s73, s60
    s_add_u32 m0, s62, 0
    s_nop 0
    buffer_load_dwordx4 v16, s[24:27], s74 offen sc1 lds
    s_add_u32 m0, s62, 4096
    s_nop 0
    buffer_load_dwordx4 v17, s[24:27], s74 offen sc1 lds
    s_add_u32 s50, s50, 264192
    s_sub_u32 s70, s66, s65
    s_and_b32 s70, s70, 7
    s_cmp_lt_u32 s66, 15
    s_cselect_b32 s71, 7, 8
    s_cmp_eq_u32 s70, s71
    s_cselect_b32 s72, 131072, 0
    s_cselect_b32 s73, s69, s68
    s_cmp_gt_u32 s66, 3
    s_cselect_b32 s71, 0, 8
    s_cmp_eq_u32 s70, s71
    s_cselect_b32 s72, 4294836224, s72
    s_cselect_b32 s73, s67, s73
    s_add_u32 s74, s51, s72
    s_add_u32 s62, s73, s60
    s_add_u32 m0, s62, 8192
    s_nop 0
    buffer_load_dwordx4 v18, s[28:31], s74 offen lds
    s_add_u32 m0, s62, 12288
    s_nop 0
    buffer_load_dwordx4 v19, s[28:31], s74 offen lds
    s_add_u32 m0, s62, 16384
    s_nop 0
    buffer_load_dwordx4 v20, s[28:31], s74 offen lds
    s_add_u32 m0, s62, 20480
    s_nop 0
    buffer_load_dwordx4 v21, s[28:31], s74 offen lds
    s_add_u32 s51, s51, 131072
    s_add_u32 s66, s66, 1
    s_mov_b32 s67, s68
    s_mov_b32 s68, s69
    s_add_u32 s69, s69, 24576
    s_cmp_eq_u32 s69, 147456
    s_cselect_b32 s69, 0, s69
wo_ldloop:
    s_sub_u32 s70, s66, 2
    s_sub_u32 s71, s70, s64
    s_and_b32 s71, s71, 3
    s_sub_u32 s70, s70, s65
    s_and_b32 s70, s70, 7
    s_min_u32 s70, s70, s71
    s_cmp_eq_u32 s70, 0
    s_cbranch_scc1 wo_ldw1
    s_waitcnt vmcnt(12)
    s_branch wo_ldw2
wo_ldw1:
    s_waitcnt vmcnt(6)
wo_ldw2:
    s_barrier
    s_sub_u32 s70, s66, s64
    s_and_b32 s70, s70, 3
    s_cmp_lt_u32 s66, 15
    s_cselect_b32 s71, 3, 4
    s_cmp_eq_u32 s70, s71
    s_cselect_b32 s72, 264192, 0
    s_cselect_b32 s73, s69, s68
    s_cmp_gt_u32 s66, 3
    s_cselect_b32 s71, 0, 4
    s_cmp_eq_u32 s70, s71
    s_cselect_b32 s72, 4294703104, s72
    s_cselect_b32 s73, s67, s73
    s_add_u32 s74, s50, s72
    s_add_u32 s62, s73, s60
    s_add_u32 m0, s62, 0
    s_nop 0
    buffer_load_dwordx4 v16, s[24:27], s74 offen sc1 lds
    s_add_u32 m0, s62, 4096
    s_nop 0
    buffer_load_dwordx4 v17, s[24:27], s74 offen sc1 lds
    s_add_u32 s50, s50, 264192
    s_sub_u32 s70, s66, s65
    s_and_b32 s70, s70, 7
    s_cmp_lt_u32 s66, 15
    s_cselect_b32 s71, 7, 8
    s_cmp_eq_u32 s70, s71
    s_cselect_b32 s72, 131072, 0
    s_cselect_b32 s73, s69, s68
    s_cmp_gt_u32 s66, 3
    s_cselect_b32 s71, 0, 8
    s_cmp_eq_u32 s70, s71
    s_cselect_b32 s72, 4294836224, s72
    s_cselect_b32 s73, s67, s73
    s_add_u32 s74, s51, s72
    s_add_u32 s62, s73, s60
    s_add_u32 m0, s62, 8192
    s_nop 0
    buffer_load_dwordx4 v18, s[28:31], s74 offen lds
    s_add_u32 m0, s62, 12288
    s_nop 0
    buffer_load_dwordx4 v19, s[28:31], s74 offen lds
    s_add_u32 m0, s62, 16384
    s_nop 0
    buffer_load_dwordx4 v20, s[28:31], s74 offen lds
    s_add_u32 m0, s62, 20480
    s_nop 0
    buffer_load_dwordx4 v21, s[28:31], s74 offen lds
    s_add_u32 s51, s51, 131072
    s_add_u32 s66, s66, 1
    s_mov_b32 s67, s68
    s_mov_b32 s68, s69
    s_add_u32 s69, s69, 24576
    s_cmp_eq_u32 s69, 147456
    s_cselect_b32 s69, 0, s69
    s_cmp_lt_u32 s66, 16
    s_cbranch_scc1 wo_ldloop
    s_waitcnt vmcnt(6)
    s_barrier
    s_waitcnt vmcnt(0)
    s_barrier
    s_waitcnt vmcnt(0)
    s_barrier
    s_lshr_b32 s83, s40, 1
    s_lshr_b32 s40, s43, 2
    s_and_b32 s41, s43, 3
    s_lshl_b32 s40, s40, 3
    s_lshl_b32 s41, s41, 2
    s_lshr_b32 s46, s44, 2
    s_and_b32 s47, s44, 3
    s_add_u32 s40, s40, s46
    s_add_u32 s41, s41, s47
    s_add_u32 s24, s4, 29360128
    s_addc_u32 s25, s5, 0
    s_mov_b32 s26, 4227072
    s_mov_b32 s27, 0x20000
    s_mov_b32 s28, s12
    s_mov_b32 s29, s13
    s_mov_b32 s30, 7340032
    s_mov_b32 s31, 0x20000
    s_lshl_b32 s50, s40, 11
    s_lshr_b32 s55, s41, 1
    s_and_b32 s56, s55, 1
    s_mul_i32 s57, s55, 448
    s_and_b32 s58, s41, 1
    s_mul_i32 s58, s58, 3584
    s_sub_u32 s59, 3584, s58
    s_lshl_b32 s46, s56, 6
    s_add_u32 s46, s46, s57
    s_add_u32 s51, s46, s58
    s_add_u32 s52, s51, 128
    s_add_u32 s53, s46, s59
    s_add_u32 s53, s53, 256
    s_cmp_eq_u32 s56, 1
    s_cselect_b32 s46, 0, 384
    s_add_u32 s54, s46, s57
    s_add_u32 s54, s54, s59
    v_lshrrev_b32 v3, 3, v1
    v_and_b32 v4, 7, v1
    v_lshlrev_b32 v5, 4, v1
    s_lshl_b32 s60, s45, 10
    s_lshr_b32 s46, s45, 1
    s_mul_i32 s46, s46, 33024
    s_and_b32 s47, s45, 1
    s_lshl_b32 s47, s47, 10
    s_add_u32 s46, s46, s47
    v_add_u32 v16, s46, v5
    v_add_u32 v17, 66048, v16
    v_add_u32 v18, 132096, v16
    v_add_u32 v19, 198144, v16
    v_bfe_u32 v6, v1, 4, 1
    s_and_b32 s46, s45, 1
    s_lshl_b32 s46, s46, 2
    v_lshlrev_b32 v6, 1, v6
    v_or_b32 v6, s46, v6
    v_xor_b32 v6, v6, v4
    s_lshl_b32 s46, s45, 3
    v_add_u32 v7, s46, v3
    v_mul_u32_u24 v7, 7168, v7
    v_lshl_add_u32 v8, v6, 4, v7
    v_add_u32 v20, 0, v8
    v_add_u32 v21, 229376, v8
    v_lshrrev_b32 v6, 5, v1
    v_lshlrev_b32 v6, 1, v6
    v_and_b32 v9, 3, v1
    v_xor_b32 v6, v6, v9
    v_lshrrev_b32 v7, 2, v1
    s_lshl_b32 s46, s45, 4
    v_add_u32 v7, s46, v7
    v_mul_u32_u24 v7, 7168, v7
    v_lshl_add_u32 v22, v6, 4, v7
    s_add_u32 m0, s60, 131072
    s_nop 0
    buffer_load_dwordx4 v20, s[28:31], s51 offen lds
    s_add_u32 m0, s60, 135168
    s_nop 0
    buffer_load_dwordx4 v21, s[28:31], s51 offen lds
    s_add_u32 m0, s60, 139264
    s_nop 0
    buffer_load_dwordx4 v20, s[28:31], s52 offen lds
    s_add_u32 m0, s60, 143360
    s_nop 0
    buffer_load_dwordx4 v21, s[28:31], s52 offen lds
    s_add_u32 m0, s60, 147456
    s_nop 0
    buffer_load_dwordx4 v20, s[28:31], s53 offen lds
    s_add_u32 m0, s60, 151552
    s_nop 0
    buffer_load_dwordx4 v21, s[28:31], s53 offen lds
    s_add_u32 m0, s60, 155648
    s_nop 0
    buffer_load_dwordx4 v22, s[28:31], s54 offen lds
    s_add_u32 s51, s51, 458752
    s_add_u32 s52, s52, 458752
    s_add_u32 s53, s53, 458752
    s_add_u32 s54, s54, 458752
    s_add_u32 m0, s60, 40960
    s_nop 0
    buffer_load_dwordx4 v20, s[28:31], s51 offen lds
    s_add_u32 m0, s60, 45056
    s_nop 0
    buffer_load_dwordx4 v21, s[28:31], s51 offen lds
    s_add_u32 m0, s60, 49152
    s_nop 0
    buffer_load_dwordx4 v20, s[28:31], s52 offen lds
    s_add_u32 m0, s60, 53248
    s_nop 0
    buffer_load_dwordx4 v21, s[28:31], s52 offen lds
    s_add_u32 m0, s60, 57344
    s_nop 0
    buffer_load_dwordx4 v20, s[28:31], s53 offen lds
    s_add_u32 m0, s60, 61440
    s_nop 0
    buffer_load_dwordx4 v21, s[28:31], s53 offen lds
    s_add_u32 m0, s60, 65536
    s_nop 0
    buffer_load_dwordx4 v22, s[28:31], s54 offen lds
    s_add_u32 s51, s51, 458752
    s_add_u32 s52, s52, 458752
    s_add_u32 s53, s53, 458752
    s_add_u32 s54, s54, 458752
    s_barrier
    s_cmp_lg_u32 s45, 0
    s_cbranch_scc1 sig_WO
    s_add_u32 s46, s83, 40
    s_lshl_b32 s46, s46, 7
    v_mov_b32 v2, 1
    v_mov_b32 v3, 0
    s_mov_b64 exec, 1
    buffer_atomic_add v2, v3, s[32:35], s46 offen sc1
    s_mov_b64 exec, -1
sig_WO:
    s_cmp_lg_u32 s45, 0
    s_cbranch_scc1 dep_WO_done
    s_add_u32 s46, s40, 40
    s_lshl_b32 s46, s46, 7
    s_mov_b32 s47, 524288
    v_mov_b32 v3, 0
    v_mov_b32 v4, 16
dep_WO_loop:
    buffer_load_dword v2, v3, s[32:35], s46 offen sc1
    s_waitcnt vmcnt(0)
    v_cmp_gt_u32 vcc, v4, v2
    s_nop 0
    s_cbranch_vccz dep_WO_done
    s_sleep 1
    s_sub_u32 s47, s47, 1
    s_cmp_lg_u32 s47, 0
    s_cbranch_scc1 dep_WO_loop
dep_WO_done:
    s_barrier
    s_add_u32 m0, s60, 114688
    s_nop 0
    buffer_load_dwordx4 v16, s[24:27], s50 offen sc1 lds
    s_add_u32 m0, s60, 118784
    s_nop 0
    buffer_load_dwordx4 v17, s[24:27], s50 offen sc1 lds
    s_add_u32 m0, s60, 122880
    s_nop 0
    buffer_load_dwordx4 v18, s[24:27], s50 offen sc1 lds
    s_add_u32 m0, s60, 126976
    s_nop 0
    buffer_load_dwordx4 v19, s[24:27], s50 offen sc1 lds
    s_add_u32 s50, s50, 264192
    s_add_u32 m0, s60, 24576
    s_nop 0
    buffer_load_dwordx4 v16, s[24:27], s50 offen sc1 lds
    s_add_u32 m0, s60, 28672
    s_nop 0
    buffer_load_dwordx4 v17, s[24:27], s50 offen sc1 lds
    s_add_u32 m0, s60, 32768
    s_nop 0
    buffer_load_dwordx4 v18, s[24:27], s50 offen sc1 lds
    s_add_u32 m0, s60, 36864
    s_nop 0
    buffer_load_dwordx4 v19, s[24:27], s50 offen sc1 lds
    s_add_u32 s50, s50, 264192
    s_waitcnt vmcnt(4)
    s_barrier
    s_add_u32 m0, s60, 69632
    s_nop 0
    buffer_load_dwordx4 v16, s[24:27], s50 offen sc1 lds
    s_add_u32 m0, s60, 73728
    s_nop 0
    buffer_load_dwordx4 v17, s[24:27], s50 offen sc1 lds
    s_add_u32 m0, s60, 77824
    s_nop 0
    buffer_load_dwordx4 v18, s[24:27], s50 offen sc1 lds
    s_add_u32 m0, s60, 81920
    s_nop 0
    buffer_load_dwordx4 v19, s[24:27], s50 offen sc1 lds
    s_add_u32 m0, s60, 86016
    s_nop 0
    buffer_load_dwordx4 v20, s[28:31], s51 offen lds
    s_add_u32 m0, s60, 90112
    s_nop 0
    buffer_load_dwordx4 v21, s[28:31], s51 offen lds
    s_add_u32 m0, s60, 94208
    s_nop 0
    buffer_load_dwordx4 v20, s[28:31], s52 offen lds
    s_add_u32 m0, s60, 98304
    s_nop 0
    buffer_load_dwordx4 v21, s[28:31], s52 offen lds
    s_add_u32 m0, s60, 102400
    s_nop 0
    buffer_load_dwordx4 v20, s[28:31], s53 offen lds
    s_add_u32 m0, s60, 106496
    s_nop 0
    buffer_load_dwordx4 v21, s[28:31], s53 offen lds
    s_add_u32 m0, s60, 110592
    s_nop 0
    buffer_load_dwordx4 v22, s[28:31], s54 offen lds
    s_add_u32 s50, s50, 264192
    s_add_u32 s51, s51, 458752
    s_add_u32 s52, s52, 458752
    s_add_u32 s53, s53, 458752
    s_add_u32 s54, s54, 458752
    s_mov_b32 s46, 114688
    s_mov_b32 s47, 13
win_ldloopB:
    s_add_u32 s62, s46, s60
    s_waitcnt vmcnt(11)
    s_barrier
    s_add_u32 m0, s62, 0
    s_nop 0
    buffer_load_dwordx4 v16, s[24:27], s50 offen sc1 lds
    s_add_u32 m0, s62, 4096
    s_nop 0
    buffer_load_dwordx4 v17, s[24:27], s50 offen sc1 lds
    s_add_u32 m0, s62, 8192
    s_nop 0
    buffer_load_dwordx4 v18, s[24:27], s50 offen sc1 lds
    s_add_u32 m0, s62, 12288
    s_nop 0
    buffer_load_dwordx4 v19, s[24:27], s50 offen sc1 lds
    s_add_u32 m0, s62, 16384
    s_nop 0
    buffer_load_dwordx4 v20, s[28:31], s51 offen lds
    s_add_u32 m0, s62, 20480
    s_nop 0
    buffer_load_dwordx4 v21, s[28:31], s51 offen lds
    s_add_u32 m0, s62, 24576
    s_nop 0
    buffer_load_dwordx4 v20, s[28:31], s52 offen lds
    s_add_u32 m0, s62, 28672
    s_nop 0
    buffer_load_dwordx4 v21, s[28:31], s52 offen lds
    s_add_u32 m0, s62, 32768
    s_nop 0
    buffer_load_dwordx4 v20, s[28:31], s53 offen lds
    s_add_u32 m0, s62, 36864
    s_nop 0
    buffer_load_dwordx4 v21, s[28:31], s53 offen lds
    s_add_u32 m0, s62, 40960
    s_nop 0
    buffer_load_dwordx4 v22, s[28:31], s54 offen lds
    s_add_u32 s50, s50, 264192
    s_add_u32 s51, s51, 458752
    s_add_u32 s52, s52, 458752
    s_add_u32 s53, s53, 458752
    s_add_u32 s54, s54, 458752
    s_add_u32 s46, s46, 45056
    s_cmp_eq_u32 s46, 159744
    s_cselect_b32 s46, 24576, s46
    s_sub_u32 s47, s47, 1
    s_cmp_lg_u32 s47, 0
    s_cbranch_scc1 win_ldloopB
    s_waitcnt vmcnt(11)
    s_barrier
    s_waitcnt vmcnt(0)
    s_barrier
    s_mov_b32 s82, s40
    s_mov_b32 s83, s41
    s_lshr_b32 s40, s43, 1
    s_and_b32 s41, s43, 1
    s_lshl_b32 s40, s40, 2
    s_lshl_b32 s41, s41, 3
    s_lshr_b32 s46, s44, 3
    s_and_b32 s47, s44, 7
    s_add_u32 s40, s40, s46
    s_add_u32 s41, s41, s47
    s_mov_b32 s24, s14
    s_mov_b32 s25, s15
    s_mov_b32 s26, 8388608
    s_mov_b32 s27, 0x20000
    s_add_u32 s28, s4, 41943040
    s_addc_u32 s29, s5, 0
    s_mov_b32 s30, 7340032
    s_mov_b32 s31, 0x20000
    s_lshl_b32 s50, s40, 19
    s_mul_i32 s51, s41, 458752
    v_lshrrev_b32 v3, 3, v1
    v_and_b32 v4, 7, v1
    v_lshlrev_b32 v5, 4, v1
    s_lshl_b32 s60, s45, 10
    s_lshl_b32 s46, s45, 2
    v_lshrrev_b32 v6, 4, v1
    v_add_u32 v6, s46, v6
    v_and_b32 v6, 7, v6
    v_xor_b32 v6, v6, v4
    s_lshl_b32 s46, s45, 3
    v_add_u32 v7, s46, v3
    v_mul_u32_u24 v7, 4096, v7
    v_lshl_add_u32 v16, v6, 4, v7
    v_add_u32 v17, 131072, v16
    v_add_u32 v18, 262144, v16
    v_add_u32 v19, 393216, v16
    v_add_u32 v20, s60, v5
    v_add_u32 v21, 4096, v20
    v_add_u32 v22, 8192, v20
    s_lshl_b32 s61, s45, 9
    v_add_u32 v23, s61, v5
    v_add_u32 v23, 12288, v23
    s_add_u32 m0, s60, 0
    s_nop 0
    buffer_load_dwordx4 v16, s[24:27], s50 offen lds
    s_add_u32 m0, s60, 4096
    s_nop 0
    buffer_load_dwordx4 v17, s[24:27], s50 offen lds
    s_add_u32 m0, s60, 8192
    s_nop 0
    buffer_load_dwordx4 v18, s[24:27], s50 offen lds
    s_add_u32 m0, s60, 12288
    s_nop 0
    buffer_load_dwordx4 v19, s[24:27], s50 offen lds
    s_add_u32 s50, s50, 128
    s_add_u32 m0, s60, 30720
    s_nop 0
    buffer_load_dwordx4 v16, s[24:27], s50 offen lds
    s_add_u32 m0, s60, 34816
    s_nop 0
    buffer_load_dwordx4 v17, s[24:27], s50 offen lds
    s_add_u32 m0, s60, 38912
    s_nop 0
    buffer_load_dwordx4 v18, s[24:27], s50 offen lds
    s_add_u32 m0, s60, 43008
    s_nop 0
    buffer_load_dwordx4 v19, s[24:27], s50 offen lds
    s_add_u32 s50, s50, 128
    s_add_u32 m0, s60, 61440
    s_nop 0
    buffer_load_dwordx4 v16, s[24:27], s50 offen lds
    s_add_u32 m0, s60, 65536
    s_nop 0
    buffer_load_dwordx4 v17, s[24:27], s50 offen lds
    s_add_u32 m0, s60, 69632
    s_nop 0
    buffer_load_dwordx4 v18, s[24:27], s50 offen lds
    s_add_u32 m0, s60, 73728
    s_nop 0
    buffer_load_dwordx4 v19, s[24:27], s50 offen lds
    s_add_u32 s50, s50, 128
    s_add_u32 s36, s4, 393216
    s_addc_u32 s37, s5, 0
    s_mov_b32 s38, 262144
    s_mov_b32 s39, 0x20000
    s_lshl_b32 s46, s45, 9
    v_lshl_add_u32 v2, v1, 3, s46
    v_add_u32 v3, 159744, v2
    s_lshl_b32 s46, s82, 14
    s_lshl_b32 s47, s83, 10
    s_add_u32 s47, s47, s46
    v_lshrrev_b32 v9, 4, v1
    v_and_b32 v10, 15, v1
    v_lshlrev_b32 v10, 4, v10
    s_lshl_b32 s48, s45, 8
    v_add_u32 v10, s48, v10
    v_lshl_add_u32 v9, v9, 10, v10
    v_add_u32 v10, 161792, v10
    s_add_u32 s49, s46, 4096
    s_add_u32 s55, s46, 8192
    s_add_u32 s56, s46, 12288
    s_barrier
    s_cmp_ge_u32 s45, 2
    s_cbranch_scc1 winx_p
    ds_read_b64 v[224:225], v3
    ds_read_b64 v[226:227], v3 offset:1024
    s_waitcnt lgkmcnt(0)
    v_pk_add_f32 v[224:225], v[224:225], v[226:227]
    buffer_store_dwordx2 v[224:225], v2, s[36:39], s47 offen sc0 sc1
winx_p:
    s_mov_b32 s47, 524288
winx_poll:
    buffer_load_dwordx4 v[240:243], v9, s[36:39], s46 offen sc0 sc1
    buffer_load_dwordx4 v[244:247], v9, s[36:39], s49 offen sc0 sc1
    buffer_load_dwordx4 v[248:251], v9, s[36:39], s55 offen sc0 sc1
    buffer_load_dwordx4 v[252:255], v9, s[36:39], s56 offen sc0 sc1
    s_waitcnt vmcnt(0)
    v_max3_u32 v8, v241, v243, v245
    v_max3_u32 v11, v247, v249, v251
    v_max3_u32 v8, v8, v253, v255
    v_max_u32 v8, v8, v11
    v_cmp_eq_u32 vcc, -1, v8
    s_sub_u32 s47, s47, 1
    s_cmp_eq_u32 s47, 0
    s_cbranch_scc1 winx_polled
    s_cbranch_vccnz winx_poll
winx_polled:
    v_pk_add_f32 v[240:241], v[240:241], v[244:245]
    v_pk_add_f32 v[248:249], v[248:249], v[252:253]
    v_pk_add_f32 v[242:243], v[242:243], v[246:247]
    v_pk_add_f32 v[250:251], v[250:251], v[254:255]
    v_pk_add_f32 v[240:241], v[240:241], v[248:249]
    v_pk_add_f32 v[242:243], v[242:243], v[250:251]
    v_mov_b32 v244, v240
    v_mov_b32 v245, v241
    v_mov_b32 v246, v242
    v_mov_b32 v247, v243
    v_permlane16_swap_b32 v240, v244
    v_permlane16_swap_b32 v241, v245
    v_permlane16_swap_b32 v242, v246
    v_permlane16_swap_b32 v243, v247
    v_pk_add_f32 v[240:241], v[240:241], v[244:245]
    v_pk_add_f32 v[242:243], v[242:243], v[246:247]
    v_mov_b32 v244, v240
    v_mov_b32 v245, v241
    v_mov_b32 v246, v242
    v_mov_b32 v247, v243
    v_permlane32_swap_b32 v240, v244
    v_permlane32_swap_b32 v241, v245
    v_permlane32_swap_b32 v242, v246
    v_permlane32_swap_b32 v243, v247
    v_pk_add_f32 v[240:241], v[240:241], v[244:245]
    v_pk_add_f32 v[242:243], v[242:243], v[246:247]
    v_mul_f32 v240, 0x3a124925, v240
    v_mul_f32 v241, 0x3a124925, v241
    v_fma_f32 v241, -v240, v240, v241
    v_max_f32 v241, 0, v241
    v_add_f32 v241, 0x3727c5ac, v241
    v_rsq_f32 v241, v241
    s_nop 0
    v_mul_f32 v240, v240, v241
    v_sub_f32 v240, 0, v240
    v_mul_f32 v242, 0x3a124925, v242
    v_mul_f32 v243, 0x3a124925, v243
    v_fma_f32 v243, -v242, v242, v243
    v_max_f32 v243, 0, v243
    v_add_f32 v243, 0x3727c5ac, v243
    v_rsq_f32 v243, v243
    s_nop 0
    v_mul_f32 v242, v242, v243
    v_sub_f32 v242, 0, v242
    s_mov_b64 exec, 0xffff
    ds_write_b128 v10, v[240:243]
    s_mov_b64 exec, -1
    s_waitcnt lgkmcnt(0)
    s_barrier
    s_barrier
    s_cmp_lg_u32 s45, 0
    s_cbranch_scc1 sig_WIN
    s_add_u32 s46, s83, 56
    s_lshl_b32 s46, s46, 7
    v_mov_b32 v2, 1
    v_mov_b32 v3, 0
    s_mov_b64 exec, 1
    buffer_atomic_add v2, v3, s[32:35], s46 offen sc1
    s_mov_b64 exec, -1
sig_WIN:
    s_and_b32 s55, s41, 14
    s_cmp_lg_u32 s45, 0
    s_cbranch_scc1 dep_WIN_done
    s_add_u32 s46, s55, 56
    s_lshl_b32 s46, s46, 7
    s_mov_b32 s47, 524288
    v_and_b32 v3, 1, v1
    v_lshlrev_b32 v3, 7, v3
    v_mov_b32 v4, 16
dep_WIN_loop:
    buffer_load_dword v2, v3, s[32:35], s46 offen sc1
    s_waitcnt vmcnt(0)
    v_cmp_gt_u32 vcc, v4, v2
    s_nop 0
    s_cbranch_vccz dep_WIN_done
    s_sleep 1
    s_sub_u32 s47, s47, 1
    s_cmp_lg_u32 s47, 0
    s_cbranch_scc1 dep_WIN_loop
dep_WIN_done:
    s_barrier
    s_add_u32 m0, s60, 16384
    s_nop 0
    buffer_load_dwordx4 v20, s[28:31], s51 offen sc1 lds
    s_add_u32 m0, s60, 20480
    s_nop 0
    buffer_load_dwordx4 v21, s[28:31], s51 offen sc1 lds
    s_add_u32 m0, s60, 24576
    s_nop 0
    buffer_load_dwordx4 v22, s[28:31], s51 offen sc1 lds
    s_add_u32 m0, s61, 28672
    s_mov_b64 exec, 0xffffffff
    buffer_load_dwordx4 v23, s[28:31], s51 offen sc1 lds
    s_mov_b64 exec, -1
    s_add_u32 s51, s51, 14336
    s_add_u32 m0, s60, 47104
    s_nop 0
    buffer_load_dwordx4 v20, s[28:31], s51 offen sc1 lds
    s_add_u32 m0, s60, 51200
    s_nop 0
    buffer_load_dwordx4 v21, s[28:31], s51 offen sc1 lds
    s_add_u32 m0, s60, 55296
    s_nop 0
    buffer_load_dwordx4 v22, s[28:31], s51 offen sc1 lds
    s_add_u32 m0, s61, 59392
    s_mov_b64 exec, 0xffffffff
    buffer_load_dwordx4 v23, s[28:31], s51 offen sc1 lds
    s_mov_b64 exec, -1
    s_add_u32 s51, s51, 14336
    s_add_u32 m0, s60, 77824
    s_nop 0
    buffer_load_dwordx4 v20, s[28:31], s51 offen sc1 lds
    s_add_u32 m0, s60, 81920
    s_nop 0
    buffer_load_dwordx4 v21, s[28:31], s51 offen sc1 lds
    s_add_u32 m0, s60, 86016
    s_nop 0
    buffer_load_dwordx4 v22, s[28:31], s51 offen sc1 lds
    s_add_u32 m0, s61, 90112
    s_mov_b64 exec, 0xffffffff
    buffer_load_dwordx4 v23, s[28:31], s51 offen sc1 lds
    s_mov_b64 exec, -1
    s_add_u32 s51, s51, 14336
    s_and_b32 s64, s44, 7
    s_lshr_b32 s65, s44, 3
    s_mov_b32 s66, 3
    s_mov_b32 s67, 61440
    s_mov_b32 s68, 92160
    s_mov_b32 s69, 122880
    s_waitcnt vmcnt(8)
    s_barrier
    s_sub_u32 s70, s66, s64
    s_and_b32 s70, s70, 7
    s_cmp_lt_u32 s66, 31
    s_cselect_b32 s71, 7, 8
    s_cmp_eq_u32 s70, s71
    s_cselect_b32 s72, 128, 0
    s_cselect_b32 s73, s69, s68
    s_cmp_gt_u32 s66, 3
    s_cselect_b32 s71, 0, 8
    s_cmp_eq_u32 s70, s71
    s_cselect_b32 s72, 4294967168, s72
    s_cselect_b32 s73, s67, s73
    s_add_u32 s74, s50, s72
    s_add_u32 s62, s73, s60
    s_add_u32 m0, s62, 0
    s_nop 0
    buffer_load_dwordx4 v16, s[24:27], s74 offen lds
    s_add_u32 m0, s62, 4096
    s_nop 0
    buffer_load_dwordx4 v17, s[24:27], s74 offen lds
    s_add_u32 m0, s62, 8192
    s_nop 0
    buffer_load_dwordx4 v18, s[24:27], s74 offen lds
    s_add_u32 m0, s62, 12288
    s_nop 0
    buffer_load_dwordx4 v19, s[24:27], s74 offen lds
    s_add_u32 s50, s50, 128
    s_sub_u32 s70, s66, s65
    s_and_b32 s70, s70, 3
    s_cmp_lt_u32 s66, 31
    s_cselect_b32 s71, 3, 4
    s_cmp_eq_u32 s70, s71
    s_cselect_b32 s72, 14336, 0
    s_cselect_b32 s73, s69, s68
    s_cmp_gt_u32 s66, 3
    s_cselect_b32 s71, 0, 4
    s_cmp_eq_u32 s70, s71
    s_cselect_b32 s72, 4294952960, s72
    s_cselect_b32 s73, s67, s73
    s_add_u32 s74, s51, s72
    s_add_u32 s62, s73, s60
    s_add_u32 s63, s73, s61
    s_add_u32 m0, s62, 16384
    s_nop 0
    buffer_load_dwordx4 v20, s[28:31], s74 offen sc1 lds
    s_add_u32 m0, s62, 20480
    s_nop 0
    buffer_load_dwordx4 v21, s[28:31], s74 offen sc1 lds
    s_add_u32 m0, s62, 24576
    s_nop 0
    buffer_load_dwordx4 v22, s[28:31], s74 offen sc1 lds
    s_add_u32 m0, s63, 28672
    s_mov_b64 exec, 0xffffffff
    buffer_load_dwordx4 v23, s[28:31], s74 offen sc1 lds
    s_mov_b64 exec, -1
    s_add_u32 s51, s51, 14336
    s_add_u32 s66, s66, 1
    s_mov_b32 s67, s68
    s_mov_b32 s68, s69
    s_add_u32 s69, s69, 30720
    s_cmp_eq_u32 s69, 153600
    s_cselect_b32 s69, 0, s69
    s_waitcnt vmcnt(12)
    s_barrier
    s_sub_u32 s70, s66, s64
    s_and_b32 s70, s70, 7
    s_cmp_lt_u32 s66, 31
    s_cselect_b32 s71, 7, 8
    s_cmp_eq_u32 s70, s71
    s_cselect_b32 s72, 128, 0
    s_cselect_b32 s73, s69, s68
    s_cmp_gt_u32 s66, 3
    s_cselect_b32 s71, 0, 8
    s_cmp_eq_u32 s70, s71
    s_cselect_b32 s72, 4294967168, s72
    s_cselect_b32 s73, s67, s73
    s_add_u32 s74, s50, s72
    s_add_u32 s62, s73, s60
    s_add_u32 m0, s62, 0
    s_nop 0
    buffer_load_dwordx4 v16, s[24:27], s74 offen lds
    s_add_u32 m0, s62, 4096
    s_nop 0
    buffer_load_dwordx4 v17, s[24:27], s74 offen lds
    s_add_u32 m0, s62, 8192
    s_nop 0
    buffer_load_dwordx4 v18, s[24:27], s74 offen lds
    s_add_u32 m0, s62, 12288
    s_nop 0
    buffer_load_dwordx4 v19, s[24:27], s74 offen lds
    s_add_u32 s50, s50, 128
    s_sub_u32 s70, s66, s65
    s_and_b32 s70, s70, 3
    s_cmp_lt_u32 s66, 31
    s_cselect_b32 s71, 3, 4
    s_cmp_eq_u32 s70, s71
    s_cselect_b32 s72, 14336, 0
    s_cselect_b32 s73, s69, s68
    s_cmp_gt_u32 s66, 3
    s_cselect_b32 s71, 0, 4
    s_cmp_eq_u32 s70, s71
    s_cselect_b32 s72, 4294952960, s72
    s_cselect_b32 s73, s67, s73
    s_add_u32 s74, s51, s72
    s_add_u32 s62, s73, s60
    s_add_u32 s63, s73, s61
    s_add_u32 m0, s62, 16384
    s_nop 0
    buffer_load_dwordx4 v20, s[28:31], s74 offen sc1 lds
    s_add_u32 m0, s62, 20480
    s_nop 0
    buffer_load_dwordx4 v21, s[28:31], s74 offen sc1 lds
    s_add_u32 m0, s62, 24576
    s_nop 0
    buffer_load_dwordx4 v22, s[28:31], s74 offen sc1 lds
    s_add_u32 m0, s63, 28672
    s_mov_b64 exec, 0xffffffff
    buffer_load_dwordx4 v23, s[28:31], s74 offen sc1 lds
    s_mov_b64 exec, -1
    s_add_u32 s51, s51, 14336
    s_add_u32 s66, s66, 1
    s_mov_b32 s67, s68
    s_mov_b32 s68, s69
    s_add_u32 s69, s69, 30720
    s_cmp_eq_u32 s69, 153600
    s_cselect_b32 s69, 0, s69
    s_waitcnt vmcnt(16)
    s_barrier
    s_sub_u32 s70, s66, s64
    s_and_b32 s70, s70, 7
    s_cmp_lt_u32 s66, 31
    s_cselect_b32 s71, 7, 8
    s_cmp_eq_u32 s70, s71
    s_cselect_b32 s72, 128, 0
    s_cselect_b32 s73, s69, s68
    s_cmp_gt_u32 s66, 3
    s_cselect_b32 s71, 0, 8
    s_cmp_eq_u32 s70, s71
    s_cselect_b32 s72, 4294967168, s72
    s_cselect_b32 s73, s67, s73
    s_add_u32 s74, s50, s72
    s_add_u32 s62, s73, s60
    s_add_u32 m0, s62, 0
    s_nop 0
    buffer_load_dwordx4 v16, s[24:27], s74 offen lds
    s_add_u32 m0, s62, 4096
    s_nop 0
    buffer_load_dwordx4 v17, s[24:27], s74 offen lds
    s_add_u32 m0, s62, 8192
    s_nop 0
    buffer_load_dwordx4 v18, s[24:27], s74 offen lds
    s_add_u32 m0, s62, 12288
    s_nop 0
    buffer_load_dwordx4 v19, s[24:27], s74 offen lds
    s_add_u32 s50, s50, 128
    s_sub_u32 s70, s66, s65
    s_and_b32 s70, s70, 3
    s_cmp_lt_u32 s66, 31
    s_cselect_b32 s71, 3, 4
    s_cmp_eq_u32 s70, s71
    s_cselect_b32 s72, 14336, 0
    s_cselect_b32 s73, s69, s68
    s_cmp_gt_u32 s66, 3
    s_cselect_b32 s71, 0, 4
    s_cmp_eq_u32 s70, s71
    s_cselect_b32 s72, 4294952960, s72
    s_cselect_b32 s73, s67, s73
    s_add_u32 s74, s51, s72
    s_add_u32 s62, s73, s60
    s_add_u32 s63, s73, s61
    s_add_u32 m0, s62, 16384
    s_nop 0
    buffer_load_dwordx4 v20, s[28:31], s74 offen sc1 lds
    s_add_u32 m0, s62, 20480
    s_nop 0
    buffer_load_dwordx4 v21, s[28:31], s74 offen sc1 lds
    s_add_u32 m0, s62, 24576
    s_nop 0
    buffer_load_dwordx4 v22, s[28:31], s74 offen sc1 lds
    s_add_u32 m0, s63, 28672
    s_mov_b64 exec, 0xffffffff
    buffer_load_dwordx4 v23, s[28:31], s74 offen sc1 lds
    s_mov_b64 exec, -1
    s_add_u32 s51, s51, 14336
    s_add_u32 s66, s66, 1
    s_mov_b32 s67, s68
    s_mov_b32 s68, s69
    s_add_u32 s69, s69, 30720
    s_cmp_eq_u32 s69, 153600
    s_cselect_b32 s69, 0, s69
wsp_ldloop:
    s_sub_u32 s70, s66, 2
    s_sub_u32 s71, s70, s64
    s_and_b32 s71, s71, 7
    s_sub_u32 s70, s70, s65
    s_and_b32 s70, s70, 3
    s_min_u32 s70, s70, s71
    s_cmp_eq_u32 s70, 0
    s_cbranch_scc1 wsp_ldw1
    s_waitcnt vmcnt(16)
    s_branch wsp_ldw2
wsp_ldw1:
    s_waitcnt vmcnt(8)
wsp_ldw2:
    s_barrier
    s_sub_u32 s70, s66, s64
    s_and_b32 s70, s70, 7
    s_cmp_lt_u32 s66, 31
    s_cselect_b32 s71, 7, 8
    s_cmp_eq_u32 s70, s71
    s_cselect_b32 s72, 128, 0
    s_cselect_b32 s73, s69, s68
    s_cmp_gt_u32 s66, 3
    s_cselect_b32 s71, 0, 8
    s_cmp_eq_u32 s70, s71
    s_cselect_b32 s72, 4294967168, s72
    s_cselect_b32 s73, s67, s73
    s_add_u32 s74, s50, s72
    s_add_u32 s62, s73, s60
    s_add_u32 m0, s62, 0
    s_nop 0
    buffer_load_dwordx4 v16, s[24:27], s74 offen lds
    s_add_u32 m0, s62, 4096
    s_nop 0
    buffer_load_dwordx4 v17, s[24:27], s74 offen lds
    s_add_u32 m0, s62, 8192
    s_nop 0
    buffer_load_dwordx4 v18, s[24:27], s74 offen lds
    s_add_u32 m0, s62, 12288
    s_nop 0
    buffer_load_dwordx4 v19, s[24:27], s74 offen lds
    s_add_u32 s50, s50, 128
    s_sub_u32 s70, s66, s65
    s_and_b32 s70, s70, 3
    s_cmp_lt_u32 s66, 31
    s_cselect_b32 s71, 3, 4
    s_cmp_eq_u32 s70, s71
    s_cselect_b32 s72, 14336, 0
    s_cselect_b32 s73, s69, s68
    s_cmp_gt_u32 s66, 3
    s_cselect_b32 s71, 0, 4
    s_cmp_eq_u32 s70, s71
    s_cselect_b32 s72, 4294952960, s72
    s_cselect_b32 s73, s67, s73
    s_add_u32 s74, s51, s72
    s_add_u32 s62, s73, s60
    s_add_u32 s63, s73, s61
    s_add_u32 m0, s62, 16384
    s_nop 0
    buffer_load_dwordx4 v20, s[28:31], s74 offen sc1 lds
    s_add_u32 m0, s62, 20480
    s_nop 0
    buffer_load_dwordx4 v21, s[28:31], s74 offen sc1 lds
    s_add_u32 m0, s62, 24576
    s_nop 0
    buffer_load_dwordx4 v22, s[28:31], s74 offen sc1 lds
    s_add_u32 m0, s63, 28672
    s_mov_b64 exec, 0xffffffff
    buffer_load_dwordx4 v23, s[28:31], s74 offen sc1 lds
    s_mov_b64 exec, -1
    s_add_u32 s51, s51, 14336
    s_add_u32 s66, s66, 1
    s_mov_b32 s67, s68
    s_mov_b32 s68, s69
    s_add_u32 s69, s69, 30720
    s_cmp_eq_u32 s69, 153600
    s_cselect_b32 s69, 0, s69
    s_cmp_lt_u32 s66, 32
    s_cbranch_scc1 wsp_ldloop
    s_waitcnt vmcnt(8)
    s_barrier
    s_waitcnt vmcnt(0)
    s_barrier
    s_waitcnt vmcnt(0)
    s_barrier
    s_mov_b32 s83, s40
    s_lshr_b32 s40, s43, 1
    s_and_b32 s41, s43, 1
    s_lshl_b32 s40, s40, 3
    s_lshl_b32 s41, s41, 2
    s_lshr_b32 s46, s44, 2
    s_and_b32 s47, s44, 3
    s_add_u32 s40, s40, s46
    s_add_u32 s41, s41, s47
    s_add_u32 s24, s4, 49283072
    s_addc_u32 s25, s5, 0
    s_mov_b32 s26, 7397376
    s_mov_b32 s27, 0x20000
    s_mov_b32 s28, s18
    s_mov_b32 s29, s19
    s_mov_b32 s30, 3670016
    s_mov_b32 s31, 0x20000
    s_lshl_b32 s50, s40, 10
    s_lshl_b32 s51, s41, 8
    v_lshrrev_b32 v3, 3, v1
    v_and_b32 v4, 7, v1
    v_lshlrev_b32 v5, 4, v1
    s_lshl_b32 s60, s45, 10
    s_mul_i32 s46, s45, 33024
    v_add_u32 v16, s46, v5
    v_add_u32 v17, 132096, v16
    v_bfe_u32 v6, v1, 4, 1
    v_lshlrev_b32 v6, 2, v6
    v_xor_b32 v6, v6, v4
    s_lshl_b32 s46, s45, 3
    v_add_u32 v7, s46, v3
    v_mul_u32_u24 v7, 2048, v7
    v_lshl_add_u32 v8, v6, 4, v7
    v_add_u32 v18, 0, v8
    v_add_u32 v19, 65536, v8
    v_add_u32 v20, 128, v8
    v_add_u32 v21, 65664, v8
    s_add_u32 m0, s60, 81920
    s_nop 0
    buffer_load_dwordx4 v18, s[28:31], s51 offen lds
    s_add_u32 m0, s60, 86016
    s_nop 0
    buffer_load_dwordx4 v19, s[28:31], s51 offen lds
    s_add_u32 m0, s60, 90112
    s_nop 0
    buffer_load_dwordx4 v20, s[28:31], s51 offen lds
    s_add_u32 m0, s60, 94208
    s_nop 0
    buffer_load_dwordx4 v21, s[28:31], s51 offen lds
    s_add_u32 s51, s51, 131072
    s_add_u32 m0, s60, 106496
    s_nop 0
    buffer_load_dwordx4 v18, s[28:31], s51 offen lds
    s_add_u32 m0, s60, 110592
    s_nop 0
    buffer_load_dwordx4 v19, s[28:31], s51 offen lds
    s_add_u32 m0, s60, 114688
    s_nop 0
    buffer_load_dwordx4 v20, s[28:31], s51 offen lds
    s_add_u32 m0, s60, 118784
    s_nop 0
    buffer_load_dwordx4 v21, s[28:31], s51 offen lds
    s_add_u32 s51, s51, 131072
    s_add_u32 m0, s60, 131072
    s_nop 0
    buffer_load_dwordx4 v18, s[28:31], s51 offen lds
    s_add_u32 m0, s60, 135168
    s_nop 0
    buffer_load_dwordx4 v19, s[28:31], s51 offen lds
    s_add_u32 m0, s60, 139264
    s_nop 0
    buffer_load_dwordx4 v20, s[28:31], s51 offen lds
    s_add_u32 m0, s60, 143360
    s_nop 0
    buffer_load_dwordx4 v21, s[28:31], s51 offen lds
    s_add_u32 s51, s51, 131072
    s_barrier
    s_cmp_lg_u32 s45, 0
    s_cbranch_scc1 sig_WSP
    s_add_u32 s46, s83, 72
    s_lshl_b32 s46, s46, 7
    v_mov_b32 v2, 1
    v_mov_b32 v3, 0
    s_mov_b64 exec, 1
    buffer_atomic_add v2, v3, s[32:35], s46 offen sc1
    s_mov_b64 exec, -1
sig_WSP:
    s_lshr_b32 s55, s40, 1
    s_cmp_lg_u32 s45, 0
    s_cbranch_scc1 dep_WSP_done
    s_add_u32 s46, s55, 72
    s_lshl_b32 s46, s46, 7
    s_mov_b32 s47, 524288
    v_mov_b32 v3, 0
    v_mov_b32 v4, 16
dep_WSP_loop:
    buffer_load_dword v2, v3, s[32:35], s46 offen sc1
    s_waitcnt vmcnt(0)
    v_cmp_gt_u32 vcc, v4, v2
    s_nop 0
    s_cbranch_vccz dep_WSP_done
    s_sleep 1
    s_sub_u32 s47, s47, 1
    s_cmp_lg_u32 s47, 0
    s_cbranch_scc1 dep_WSP_loop
dep_WSP_done:
    s_barrier
    s_add_u32 m0, s60, 73728
    s_nop 0
    buffer_load_dwordx4 v16, s[24:27], s50 offen sc1 lds
    s_add_u32 m0, s60, 77824
    s_nop 0
    buffer_load_dwordx4 v17, s[24:27], s50 offen sc1 lds
    s_add_u32 s50, s50, 264192
    s_add_u32 m0, s60, 98304
    s_nop 0
    buffer_load_dwordx4 v16, s[24:27], s50 offen sc1 lds
    s_add_u32 m0, s60, 102400
    s_nop 0
    buffer_load_dwordx4 v17, s[24:27], s50 offen sc1 lds
    s_add_u32 s50, s50, 264192
    s_add_u32 m0, s60, 122880
    s_nop 0
    buffer_load_dwordx4 v16, s[24:27], s50 offen sc1 lds
    s_add_u32 m0, s60, 126976
    s_nop 0
    buffer_load_dwordx4 v17, s[24:27], s50 offen sc1 lds
    s_add_u32 s50, s50, 264192
    s_and_b32 s64, s44, 3
    s_lshr_b32 s65, s44, 2
    s_mov_b32 s66, 3
    s_mov_b32 s67, 122880
    s_mov_b32 s68, 0
    s_mov_b32 s69, 24576
    s_waitcnt vmcnt(4)
    s_barrier
    s_sub_u32 s70, s66, s64
    s_and_b32 s70, s70, 3
    s_cmp_lt_u32 s66, 27
    s_cselect_b32 s71, 3, 4
    s_cmp_eq_u32 s70, s71
    s_cselect_b32 s72, 264192, 0
    s_cselect_b32 s73, s69, s68
    s_cmp_gt_u32 s66, 3
    s_cselect_b32 s71, 0, 4
    s_cmp_eq_u32 s70, s71
    s_cselect_b32 s72, 4294703104, s72
    s_cselect_b32 s73, s67, s73
    s_add_u32 s74, s50, s72
    s_add_u32 s62, s73, s60
    s_add_u32 m0, s62, 0
    s_nop 0
    buffer_load_dwordx4 v16, s[24:27], s74 offen sc1 lds
    s_add_u32 m0, s62, 4096
    s_nop 0
    buffer_load_dwordx4 v17, s[24:27], s74 offen sc1 lds
    s_add_u32 s50, s50, 264192
    s_sub_u32 s70, s66, s65
    s_and_b32 s70, s70, 7
    s_cmp_lt_u32 s66, 27
    s_cselect_b32 s71, 7, 8
    s_cmp_eq_u32 s70, s71
    s_cselect_b32 s72, 131072, 0
    s_cselect_b32 s73, s69, s68
    s_cmp_gt_u32 s66, 3
    s_cselect_b32 s71, 0, 8
    s_cmp_eq_u32 s70, s71
    s_cselect_b32 s72, 4294836224, s72
    s_cselect_b32 s73, s67, s73
    s_add_u32 s74, s51, s72
    s_add_u32 s62, s73, s60
    s_add_u32 m0, s62, 8192
    s_nop 0
    buffer_load_dwordx4 v18, s[28:31], s74 offen lds
    s_add_u32 m0, s62, 12288
    s_nop 0
    buffer_load_dwordx4 v19, s[28:31], s74 offen lds
    s_add_u32 m0, s62, 16384
    s_nop 0
    buffer_load_dwordx4 v20, s[28:31], s74 offen lds
    s_add_u32 m0, s62, 20480
    s_nop 0
    buffer_load_dwordx4 v21, s[28:31], s74 offen lds
    s_add_u32 s51, s51, 131072
    s_add_u32 s66, s66, 1
    s_mov_b32 s67, s68
    s_mov_b32 s68, s69
    s_add_u32 s69, s69, 24576
    s_cmp_eq_u32 s69, 147456
    s_cselect_b32 s69, 0, s69
    s_waitcnt vmcnt(8)
    s_barrier
    s_sub_u32 s70, s66, s64
    s_and_b32 s70, s70, 3
    s_cmp_lt_u32 s66, 27
    s_cselect_b32 s71, 3, 4
    s_cmp_eq_u32 s70, s71
    s_cselect_b32 s72, 264192, 0
    s_cselect_b32 s73, s69, s68
    s_cmp_gt_u32 s66, 3
    s_cselect_b32 s71, 0, 4
    s_cmp_eq_u32 s70, s71
    s_cselect_b32 s72, 4294703104, s72
    s_cselect_b32 s73, s67, s73
    s_add_u32 s74, s50, s72
    s_add_u32 s62, s73, s60
    s_add_u32 m0, s62, 0
    s_nop 0
    buffer_load_dwordx4 v16, s[24:27], s74 offen sc1 lds
    s_add_u32 m0, s62, 4096
    s_nop 0
    buffer_load_dwordx4 v17, s[24:27], s74 offen sc1 lds
    s_add_u32 s50, s50, 264192
    s_sub_u32 s70, s66, s65
    s_and_b32 s70, s70, 7
    s_cmp_lt_u32 s66, 27
    s_cselect_b32 s71, 7, 8
    s_cmp_eq_u32 s70, s71
    s_cselect_b32 s72, 131072, 0
    s_cselect_b32 s73, s69, s68
    s_cmp_gt_u32 s66, 3
    s_cselect_b32 s71, 0, 8
    s_cmp_eq_u32 s70, s71
    s_cselect_b32 s72, 4294836224, s72
    s_cselect_b32 s73, s67, s73
    s_add_u32 s74, s51, s72
    s_add_u32 s62, s73, s60
    s_add_u32 m0, s62, 8192
    s_nop 0
    buffer_load_dwordx4 v18, s[28:31], s74 offen lds
    s_add_u32 m0, s62, 12288
    s_nop 0
    buffer_load_dwordx4 v19, s[28:31], s74 offen lds
    s_add_u32 m0, s62, 16384
    s_nop 0
    buffer_load_dwordx4 v20, s[28:31], s74 offen lds
    s_add_u32 m0, s62, 20480
    s_nop 0
    buffer_load_dwordx4 v21, s[28:31], s74 offen lds
    s_add_u32 s51, s51, 131072
    s_add_u32 s66, s66, 1
    s_mov_b32 s67, s68
    s_mov_b32 s68, s69
    s_add_u32 s69, s69, 24576
    s_cmp_eq_u32 s69, 147456
    s_cselect_b32 s69, 0, s69
    s_waitcnt vmcnt(12)
    s_barrier
    s_sub_u32 s70, s66, s64
    s_and_b32 s70, s70, 3
    s_cmp_lt_u32 s66, 27
    s_cselect_b32 s71, 3, 4
    s_cmp_eq_u32 s70, s71
    s_cselect_b32 s72, 264192, 0
    s_cselect_b32 s73, s69, s68
    s_cmp_gt_u32 s66, 3
    s_cselect_b32 s71, 0, 4
    s_cmp_eq_u32 s70, s71
    s_cselect_b32 s72, 4294703104, s72
    s_cselect_b32 s73, s67, s73
    s_add_u32 s74, s50, s72
    s_add_u32 s62, s73, s60
    s_add_u32 m0, s62, 0
    s_nop 0
    buffer_load_dwordx4 v16, s[24:27], s74 offen sc1 lds
    s_add_u32 m0, s62, 4096
    s_nop 0
    buffer_load_dwordx4 v17, s[24:27], s74 offen sc1 lds
    s_add_u32 s50, s50, 264192
    s_sub_u32 s70, s66, s65
    s_and_b32 s70, s70, 7
    s_cmp_lt_u32 s66, 27
    s_cselect_b32 s71, 7, 8
    s_cmp_eq_u32 s70, s71
    s_cselect_b32 s72, 131072, 0
    s_cselect_b32 s73, s69, s68
    s_cmp_gt_u32 s66, 3
    s_cselect_b32 s71, 0, 8
    s_cmp_eq_u32 s70, s71
    s_cselect_b32 s72, 4294836224, s72
    s_cselect_b32 s73, s67, s73
    s_add_u32 s74, s51, s72
    s_add_u32 s62, s73, s60
    s_add_u32 m0, s62, 8192
    s_nop 0
    buffer_load_dwordx4 v18, s[28:31], s74 offen lds
    s_add_u32 m0, s62, 12288
    s_nop 0
    buffer_load_dwordx4 v19, s[28:31], s74 offen lds
    s_add_u32 m0, s62, 16384
    s_nop 0
    buffer_load_dwordx4 v20, s[28:31], s74 offen lds
    s_add_u32 m0, s62, 20480
    s_nop 0
    buffer_load_dwordx4 v21, s[28:31], s74 offen lds
    s_add_u32 s51, s51, 131072
    s_add_u32 s66, s66, 1
    s_mov_b32 s67, s68
    s_mov_b32 s68, s69
    s_add_u32 s69, s69, 24576
    s_cmp_eq_u32 s69, 147456
    s_cselect_b32 s69, 0, s69
wout_ldloop:
    s_sub_u32 s70, s66, 2
    s_sub_u32 s71, s70, s64
    s_and_b32 s71, s71, 3
    s_sub_u32 s70, s70, s65
    s_and_b32 s70, s70, 7
    s_min_u32 s70, s70, s71
    s_cmp_eq_u32 s70, 0
    s_cbranch_scc1 wout_ldw1
    s_waitcnt vmcnt(12)
    s_branch wout_ldw2
wout_ldw1:
    s_waitcnt vmcnt(6)
wout_ldw2:
    s_barrier
    s_sub_u32 s70, s66, s64
    s_and_b32 s70, s70, 3
    s_cmp_lt_u32 s66, 27
    s_cselect_b32 s71, 3, 4
    s_cmp_eq_u32 s70, s71
    s_cselect_b32 s72, 264192, 0
    s_cselect_b32 s73, s69, s68
    s_cmp_gt_u32 s66, 3
    s_cselect_b32 s71, 0, 4
    s_cmp_eq_u32 s70, s71
    s_cselect_b32 s72, 4294703104, s72
    s_cselect_b32 s73, s67, s73
    s_add_u32 s74, s50, s72
    s_add_u32 s62, s73, s60
    s_add_u32 m0, s62, 0
    s_nop 0
    buffer_load_dwordx4 v16, s[24:27], s74 offen sc1 lds
    s_add_u32 m0, s62, 4096
    s_nop 0
    buffer_load_dwordx4 v17, s[24:27], s74 offen sc1 lds
    s_add_u32 s50, s50, 264192
    s_sub_u32 s70, s66, s65
    s_and_b32 s70, s70, 7
    s_cmp_lt_u32 s66, 27
    s_cselect_b32 s71, 7, 8
    s_cmp_eq_u32 s70, s71
    s_cselect_b32 s72, 131072, 0
    s_cselect_b32 s73, s69, s68
    s_cmp_gt_u32 s66, 3
    s_cselect_b32 s71, 0, 8
    s_cmp_eq_u32 s70, s71
    s_cselect_b32 s72, 4294836224, s72
    s_cselect_b32 s73, s67, s73
    s_add_u32 s74, s51, s72
    s_add_u32 s62, s73, s60
    s_add_u32 m0, s62, 8192
    s_nop 0
    buffer_load_dwordx4 v18, s[28:31], s74 offen lds
    s_add_u32 m0, s62, 12288
    s_nop 0
    buffer_load_dwordx4 v19, s[28:31], s74 offen lds
    s_add_u32 m0, s62, 16384
    s_nop 0
    buffer_load_dwordx4 v20, s[28:31], s74 offen lds
    s_add_u32 m0, s62, 20480
    s_nop 0
    buffer_load_dwordx4 v21, s[28:31], s74 offen lds
    s_add_u32 s51, s51, 131072
    s_add_u32 s66, s66, 1
    s_mov_b32 s67, s68
    s_mov_b32 s68, s69
    s_add_u32 s69, s69, 24576
    s_cmp_eq_u32 s69, 147456
    s_cselect_b32 s69, 0, s69
    s_cmp_lt_u32 s66, 28
    s_cbranch_scc1 wout_ldloop
    s_waitcnt vmcnt(6)
    s_barrier
    s_waitcnt vmcnt(0)
    s_barrier
    s_waitcnt vmcnt(0)
    s_barrier
adaLN_cond__mha_block__mixer_gmlp__prompt_kernel_exit:
    s_endpgm
.section .rodata,"a"
.p2align 6
.amdhsa_kernel adaLN_cond__mha_block__mixer_gmlp__prompt_kernel
  .amdhsa_next_free_vgpr 256
  .amdhsa_next_free_sgpr 102
  .amdhsa_accum_offset 256
  .amdhsa_group_segment_fixed_size 0
  .amdhsa_kernarg_size 104
  .amdhsa_user_sgpr_count 2
  .amdhsa_user_sgpr_kernarg_segment_ptr 1
  .amdhsa_system_sgpr_workgroup_id_x 1
.end_amdhsa_kernel
```
